```python
import torch

def _softmax(x, axis=-1):
    return torch.softmax(x, dim=axis)
def _gelu(x):
    return torch.nn.functional.gelu(x, approximate="tanh")
def _silu(x):
    return torch.nn.functional.silu(x)
def _sigmoid(x):
    return torch.sigmoid(x)
def _layernorm(x, axis=-1, eps=1e-5):
    m = x.mean(dim=axis, keepdim=True)
    v = x.var(dim=axis, keepdim=True, unbiased=False)
    return (x - m) / torch.sqrt(v + eps)
def _scatter_add(tgt, idx, src, axis=0):
    return tgt.clone().index_add_(axis, idx, src)
def _segment_sum(src, seg, n):
    out = torch.zeros((n,) + src.shape[1:], dtype=src.dtype)
    return out.index_add_(0, seg, src)
def _pad(x, pw):
    flat = tuple(v for pair in reversed(pw) for v in pair)
    return torch.nn.functional.pad(x, flat)

kernel_name = 'sequential_preLN__grouped_kv_mqa__glu_gated_glu__prompt'

def setup_inputs():

    _w = (lambda a: (lambda t: t.to(torch.bfloat16) if t.is_floating_point() else t)(torch.as_tensor(a)))
    def _A_setup():
        B, S, D, H = 1, 2048, 1024, 32
        Dh = D // H
        return {
            "x": _w((lambda *s: torch.randn(*s, dtype=torch.bfloat16) * 0.05)(B, S, D)),
            "wq": _w((lambda *s: torch.randn(*s, dtype=torch.bfloat16) * 0.05)(D, H * Dh)),
            "wk": _w((lambda *s: torch.randn(*s, dtype=torch.bfloat16) * 0.05)(D, Dh)),
            "wv": _w((lambda *s: torch.randn(*s, dtype=torch.bfloat16) * 0.05)(D, Dh)),
            "wo": _w((lambda *s: torch.randn(*s, dtype=torch.bfloat16) * 0.05)(H * Dh, D)),
        }
    _A_in = _A_setup()

    def _B_setup():
        B, S, D, F = 1, 2048, 1024, 3584
        return {
            "x": _w((lambda *s: torch.randn(*s, dtype=torch.bfloat16) * 0.05)(B, S, D)),
            "w_gate": _w((lambda *s: torch.randn(*s, dtype=torch.bfloat16) * 0.05)(D, F)),
            "w_up": _w((lambda *s: torch.randn(*s, dtype=torch.bfloat16) * 0.05)(D, F)),
            "w_down": _w((lambda *s: torch.randn(*s, dtype=torch.bfloat16) * 0.05)(F, D)),
        }
    _B_in = _B_setup()

    return {
        "A_x": _A_in["x"],
        "A_wq": _A_in["wq"],
        "A_wk": _A_in["wk"],
        "A_wv": _A_in["wv"],
        "A_wo": _A_in["wo"],
        "B_x": _B_in["x"],
        "B_w_gate": _B_in["w_gate"],
        "B_w_up": _B_in["w_up"],
        "B_w_down": _B_in["w_down"],
    }

def reference(A_x, A_wq, A_wk, A_wv, A_wo, B_x, B_w_gate, B_w_up, B_w_down):
    def _A_ref(x, wq, wk, wv, wo):
        B, S, D = x.shape
        H = 32
        Dh = D // H
        q = (lambda x, *d: x.permute(*d))((x @ wq).reshape(B, S, H, Dh), 0, 2, 1, 3)
        k = x @ wk
        v = x @ wv
        scores = torch.einsum("bhqd,bkd->bhqk", q, k) * (Dh ** -0.5)
        p = _softmax(scores, axis=-1)
        o = torch.einsum("bhqk,bkd->bhqd", p, v)
        return (lambda x, *d: x.permute(*d))(o, 0, 2, 1, 3).reshape(B, S, H * Dh) @ wo

    def _B_ref(x, w_gate, w_up, w_down):
        g = torch.einsum("bsd,df->bsf", x, w_gate)
        u = torch.einsum("bsd,df->bsf", x, w_up)
        h = _sigmoid(g) * u
        return torch.einsum("bsf,fd->bsd", h, w_down)

    x = A_x
    h = x + _A_ref(_layernorm(x, axis=-1), A_wq, A_wk, A_wv, A_wo)
    h2 = h + _B_ref(_layernorm(h, axis=-1), B_w_gate, B_w_up, B_w_down)
    return h2
```

```asm
; @launch grid=(256,1,1) block=(256,1,1) lds=163840
.amdgcn_target "amdgcn-amd-amdhsa--gfx950"
.text
.globl sequential_preLN__grouped_kv_mqa__glu_gated_glu__prompt_kernel
.p2align 8
.type sequential_preLN__grouped_kv_mqa__glu_gated_glu__prompt_kernel,@function
sequential_preLN__grouped_kv_mqa__glu_gated_glu__prompt_kernel:
    s_cmp_ge_u32 s2, 256
    s_cbranch_scc1 F_end
    s_load_dwordx16 s[4:19], s[0:1], 0
    s_load_dwordx8 s[20:27], s[0:1], 64
    v_lshrrev_b32 v1, 6, v0
    v_and_b32 v0, 63, v0
    v_readfirstlane_b32 s52, v1
    s_and_b32 s56, s2, 7
    s_lshr_b32 s57, s2, 3
    s_lshr_b32 s53, s56, 1
    s_lshl_b32 s53, s53, 2
    s_and_b32 s54, s57, 3
    s_add_u32 s53, s53, s54
    s_and_b32 s54, s56, 1
    s_lshl_b32 s54, s54, 3
    s_lshr_b32 s57, s57, 2
    s_add_u32 s54, s54, s57
    s_lshl_b32 s55, s53, 2
    s_add_u32 s55, s55, s52
    s_lshl_b32 s55, s55, 5
    v_lshlrev_b32 v1, 4, v0
    v_cmp_eq_u32 vcc, 0, v0
    v_mov_b32 v3, 0x7ffffff0
    s_nop 0
    v_cndmask_b32 v2, v3, 0, vcc
    v_mov_b32 v3, 1
    v_lshrrev_b32 v4, 3, v0
    v_lshrrev_b32 v5, 4, v0
    v_and_b32 v6, 7, v0
    v_xor_b32 v7, v5, v6
    v_lshlrev_b32 v7, 4, v7
    v_lshl_add_u32 v7, v4, 11, v7
    v_xor_b32 v8, 64, v7
    v_add_u32 v12, 4096, v7
    v_add_u32 v13, 19456, v8
    v_add_u32 v18, 2176, v7
    v_add_u32 v19, 17536, v8
    v_lshrrev_b32 v9, 5, v0
    v_lshlrev_b32 v9, 1, v9
    v_xor_b32 v9, v9, v0
    v_lshlrev_b32 v20, 4, v9
    v_add_u32 v14, 34816, v7
    v_add_u32 v15, 50176, v8
    v_and_b32 v5, 1, v5
    v_lshlrev_b32 v5, 1, v5
    v_xor_b32 v5, v5, v6
    v_lshlrev_b32 v5, 4, v5
    v_lshl_add_u32 v16, v4, 11, v5
    v_xor_b32 v17, 64, v16
    v_add_u32 v17, 15360, v17
    s_lshr_b32 s56, s54, 1
    s_lshl_b32 s61, s53, 3
    s_add_u32 s61, s61, s56
    s_lshl_b32 s61, s61, 4
    s_lshl_b32 s56, s61, 11
    s_lshl_b32 s57, s52, 9
    s_add_u32 s56, s56, s57
    s_add_u32 s57, s52, 2
    s_mul_i32 s64, s57, 24576
    s_mov_b32 m0, s64
    s_mul_i32 s62, s53, 512
    s_mul_i32 s63, s54, 256
    s_add_u32 s62, s62, s63
    s_and_b32 s62, s62, 2047
    s_mul_i32 s66, s52, 6144
    s_lshl_b32 s72, s52, 14
    s_bfe_u32 s73, s54, 0x20001
    s_lshl_b32 s73, s73, 14
    s_and_b32 s57, s55, 0x1e0
    s_lshl_b32 s57, s57, 5
    s_add_u32 s73, s73, s57
    v_lshlrev_b32 v10, 7, v0
    s_waitcnt lgkmcnt(0)
    s_sub_u32 s28, s4, 0x1000
    s_subb_u32 s29, s5, 0
    s_mov_b32 s30, 0x401000
    s_mov_b32 s31, 0x20000
    s_bitcmp0_b32 s54, 0
    s_cselect_b64 s[32:33], s[8:9], s[10:11]
    s_mov_b32 s34, 65536
    s_mov_b32 s35, 0x20000
    s_mov_b64 exec, 0xff
    buffer_load_dword v255, v10, s[32:35], s73 offen
    s_mov_b64 exec, -1
    buffer_load_dwordx4 v12, s[28:31], s56 offen offset:0 lds
    buffer_load_dwordx4 v13, s[28:31], s56 offen offset:1024 lds
    buffer_load_dwordx4 v18, s[28:31], s56 offen offset:2048 lds
    buffer_load_dwordx4 v19, s[28:31], s56 offen offset:3072 lds
    s_add_u32 m0, m0, 4096
    s_add_u32 s56, s56, 256
    buffer_load_dwordx4 v12, s[28:31], s56 offen offset:0 lds
    buffer_load_dwordx4 v13, s[28:31], s56 offen offset:1024 lds
    buffer_load_dwordx4 v18, s[28:31], s56 offen offset:2048 lds
    buffer_load_dwordx4 v19, s[28:31], s56 offen offset:3072 lds
    s_getpc_b64 s[0:1]
    s_lshr_b32 s56, s2, 3
    s_lshl_b32 s56, s56, 2
    s_add_u32 s56, s56, s52
    s_lshl_b32 s56, s56, 7
    s_add_u32 s0, s0, s56
    s_addc_u32 s1, s1, 0
    s_and_b32 s0, s0, 0xffffff80
    s_load_dword s60, s[0:1], 0
    s_load_dword s59, s[0:1], 64
    s_lshl_b32 s56, s55, 11
    s_lshl_b32 s57, s52, 15
    s_lshl_b32 s58, s54, 7
    s_add_u32 s57, s57, s58
    s_add_u32 s36, s4, s56
    s_addc_u32 s37, s5, 0
    s_sub_u32 s36, s36, 0x1000
    s_subb_u32 s37, s37, 0
    s_mov_b32 s38, 0x11000
    s_mov_b32 s39, 0x20000
    s_add_u32 s40, s6, s57
    s_addc_u32 s41, s7, 0
    s_sub_u32 s42, 2097152, s57
    s_mov_b32 s43, 0x20000
    s_mov_b64 s[44:45], s[6:7]
    s_mov_b32 s46, 0x200000
    s_mov_b32 s47, 0x20000
    s_lshr_b32 s56, s2, 3
    s_lshl_b32 s56, s56, 2
    s_add_u32 s56, s56, s52
    s_lshl_b32 s56, s56, 14
    s_and_b32 s57, s54, 8
    s_lshl_b32 s57, s57, 7
    s_add_u32 s56, s56, s57
    v_lshlrev_b32 v10, 11, v0
    s_mov_b64 exec, 0xff
    buffer_load_dword v255, v10, s[44:47], s56 offen offset:384
    s_lshl_b32 s56, s2, 2
    s_add_u32 s56, s56, s52
    s_lshl_b32 s56, s56, 11
    s_mov_b64 exec, 0xffff
    v_lshlrev_b32 v10, 7, v0
    buffer_load_dword v255, v10, s[44:47], s56 offen
    s_mov_b64 exec, -1
    s_mov_b64 s[44:45], s[12:13]
    s_mov_b32 s46, 0x200000
    s_mov_b32 s47, 0x20000
    s_add_u32 s48, s26, 0x2200000
    s_addc_u32 s49, s27, 0
    s_mov_b32 s50, 0x180000
    s_mov_b32 s51, 0x20000
    s_add_u32 s28, s26, 0x400000
    s_addc_u32 s29, s27, 0
    s_mov_b32 s30, 0x40000
    s_mov_b32 s31, 0x20000
    v_and_b32 v4, 15, v0
    v_lshrrev_b32 v5, 1, v4
    v_lshrrev_b32 v6, 4, v0
    v_xor_b32 v5, v5, v6
    v_lshlrev_b32 v5, 4, v5
    v_lshl_add_u32 v5, v4, 7, v5
    v_xor_b32 v7, 64, v5
    v_add_u32 v22, s66, v5
    v_add_u32 v23, s66, v7
    v_add_u32 v28, s64, v5
    v_add_u32 v29, s64, v7
    v_lshrrev_b32 v4, 5, v0
    v_and_b32 v5, 3, v0
    v_lshlrev_b32 v5, 3, v5
    v_bfe_u32 v6, v0, 2, 2
    v_bfe_u32 v7, v0, 4, 1
    v_lshl_add_u32 v6, v7, 3, v6
    v_lshl_add_u32 v8, v4, 10, v5
    v_lshl_add_u32 v8, v6, 6, v8
    v_lshl_add_u32 v8, v7, 5, v8
    v_add_u32 v30, s64, v8
    v_xor_b32 v31, 32, v30
    v_mul_u32_u24 v4, 6144, v4
    v_add_u32 v4, v4, v5
    v_lshl_add_u32 v4, v6, 7, v4
    v_bfe_u32 v8, v0, 3, 2
    v_xor_b32 v8, s52, v8
    v_lshl_add_u32 v24, v8, 5, v4
    v_xor_b32 v25, 32, v24
    v_xor_b32 v26, 64, v24
    v_xor_b32 v27, 0x60, v24
    v_mov_b32 v36, 0x3f803f80
    v_mov_b32 v37, 0x3f803f80
    v_mov_b32 v38, 0x3f803f80
    v_mov_b32 v39, 0x3f803f80
    v_pk_mov_b32 v[48:49], 0, 0
    v_pk_mov_b32 v[50:51], 0, 0
    v_pk_mov_b32 v[52:53], 0, 0
    v_pk_mov_b32 v[54:55], 0, 0
    v_pk_mov_b32 v[56:57], 0, 0
    v_pk_mov_b32 v[58:59], 0, 0
    v_pk_mov_b32 v[60:61], 0, 0
    v_pk_mov_b32 v[62:63], 0, 0
    v_pk_mov_b32 v[64:65], 0, 0
    v_pk_mov_b32 v[66:67], 0, 0
    v_pk_mov_b32 v[68:69], 0, 0
    v_pk_mov_b32 v[70:71], 0, 0
    v_pk_mov_b32 v[72:73], 0, 0
    v_pk_mov_b32 v[74:75], 0, 0
    v_pk_mov_b32 v[76:77], 0, 0
    v_pk_mov_b32 v[78:79], 0, 0
    v_pk_mov_b32 v[80:81], 0, 0
    v_pk_mov_b32 v[82:83], 0, 0
    s_or_b32 s56, s2, s52
    s_cbranch_scc1 F_noclr
    s_movk_i32 s56, 16384
    buffer_store_dwordx4 v[48:51], v1, s[48:51], s56 offen offset:0 sc1
    buffer_store_dwordx4 v[48:51], v1, s[48:51], s56 offen offset:1024 sc1
    buffer_store_dwordx4 v[48:51], v1, s[48:51], s56 offen offset:2048 sc1
    buffer_store_dwordx4 v[48:51], v1, s[48:51], s56 offen offset:3072 sc1
F_noclr:
    v_pk_mov_b32 v[176:177], 0, 0
    v_pk_mov_b32 v[178:179], 0, 0
    v_pk_mov_b32 v[180:181], 0, 0
    v_pk_mov_b32 v[182:183], 0, 0
    v_pk_mov_b32 v[184:185], 0, 0
    v_pk_mov_b32 v[186:187], 0, 0
    v_pk_mov_b32 v[188:189], 0, 0
    v_pk_mov_b32 v[190:191], 0, 0
    v_pk_mov_b32 v[192:193], 0, 0
    v_pk_mov_b32 v[194:195], 0, 0
    v_pk_mov_b32 v[196:197], 0, 0
    v_pk_mov_b32 v[198:199], 0, 0
    v_pk_mov_b32 v[200:201], 0, 0
    v_pk_mov_b32 v[202:203], 0, 0
    v_pk_mov_b32 v[204:205], 0, 0
    v_pk_mov_b32 v[206:207], 0, 0
    v_pk_mov_b32 v[208:209], 0, 0
    v_pk_mov_b32 v[210:211], 0, 0
    v_pk_mov_b32 v[212:213], 0, 0
    v_pk_mov_b32 v[214:215], 0, 0
    v_pk_mov_b32 v[224:225], 0, 0
    v_pk_mov_b32 v[226:227], 0, 0
    v_pk_mov_b32 v[228:229], 0, 0
    v_pk_mov_b32 v[230:231], 0, 0
    v_accvgpr_write_b32 a88, 0
    v_accvgpr_write_b32 a89, 0
    v_accvgpr_write_b32 a90, 0
    v_accvgpr_write_b32 a91, 0
    v_accvgpr_write_b32 a92, 0
    v_accvgpr_write_b32 a93, 0
    v_accvgpr_write_b32 a94, 0
    v_accvgpr_write_b32 a95, 0
    v_lshrrev_b32 v4, 2, v0
    v_and_b32 v4, 4, v4
    v_xor_b32 v4, v4, v0
    v_and_b32 v4, 7, v4
    v_cmp_eq_u32 vcc, 0, v4
    v_lshrrev_b32 v4, 3, v0
    v_and_b32 v5, 6, v4
    v_cndmask_b32 v232, 0, v36, vcc
    v_mov_b32 v233, v232
    v_mov_b32 v234, v232
    v_mov_b32 v235, v232
    v_and_b32 v6, 7, v0
    v_xor_b32 v5, v5, v6
    v_lshlrev_b32 v5, 4, v5
    v_lshl_add_u32 v236, v4, 11, v5
    v_add_u32 v237, 15360, v236
    v_add_u32 v238, 30720, v236
    v_add_u32 v239, 46080, v236
    s_lshl_b32 s68, s52, 16
    s_lshl_b32 s57, s54, 7
    s_add_u32 s68, s68, s57
    s_lshl_b32 s69, s52, 12
    s_lshl_b32 s3, s55, 6
    s_add_u32 s3, s3, s57
    s_lshl_b32 s67, s54, 1
    s_lshr_b32 s56, s52, 1
    s_add_u32 s67, s67, s56
    v_mul_u32_u24 v4, 9363, v0
    v_lshrrev_b32 v4, 16, v4
    v_mul_u32_u24 v5, 6272, v4
    v_cmp_gt_u32 vcc, 14, v0
    v_lshl_add_u32 v240, v0, 7, v5
    s_lshr_b32 s56, s2, 3
    v_cndmask_b32 v240, -1, v240, vcc
    v_and_b32 v240, 0x7fffff80, v240
    s_lshl_b32 s56, s56, 2
    s_add_u32 s56, s56, s52
    s_mul_i32 s71, s56, 14336
    s_and_b32 s56, s2, 7
    s_mul_i32 s56, s56, 896
    s_add_u32 s71, s71, s56
    v_and_b32 v4, 15, v0
    v_bfe_u32 v5, v0, 4, 1
    v_lshrrev_b32 v6, 5, v0
    v_lshrrev_b32 v7, 4, v0
    v_lshlrev_b32 v246, 3, v4
    s_lshl_b32 s56, s52, 13
    s_add_u32 s56, s56, 131072
    v_add_u32 v248, s56, v1
    v_xor_b32 v249, 0x2000, v248
    v_lshrrev_b32 v8, 1, v4
    v_xor_b32 v8, v8, v6
    v_lshlrev_b32 v8, 4, v8
    v_lshl_add_u32 v8, v4, 7, v8
    v_lshl_add_u32 v8, v5, 3, v8
    v_add_u32 v250, s56, v8
    s_and_b32 s57, s52, 2
    s_lshl_b32 s57, s57, 6
    s_add_u32 s56, s56, s57
    s_add_u32 s56, s56, 4096
    v_lshl_add_u32 v247, v6, 4, s56
    v_add_u32 v253, 8192, v1
    v_lshl_add_u32 v243, v7, 2, v246
    v_lshlrev_b32 v4, 4, v4
    v_lshl_add_u32 v242, v5, 15, v4
    v_lshl_add_u32 v242, v6, 8, v242
    s_lshl_b32 s56, s52, 6
    s_add_u32 s56, s56, 162816
    v_lshl_add_u32 v244, v7, 4, s56
    v_lshlrev_b32 v245, 5, v246
    s_bitcmp1_b32 s54, 0
    s_cselect_b32 s56, 9, 10
    s_cselect_b32 s57, 8, 9
    v_lshl_add_u32 v34, v5, s56, v4
    v_lshl_add_u32 v34, v6, s57, v34
    s_mul_i32 s56, s52, 5120
    s_add_u32 s56, s56, 142336
    v_add_u32 v35, s56, v1
    v_and_b32 v4, 3, v0
    v_cmp_eq_u32 s[0:1], 1, v4
    v_cmp_eq_u32 s[14:15], 2, v4
    v_cmp_eq_u32 s[74:75], 3, v4
    v_bfe_u32 v4, v0, 2, 2
    v_cmp_eq_u32 vcc, v4, v7
    v_and_b32 v9, 6, v0
    s_waitcnt lgkmcnt(0)
    v_cmp_eq_u32 s[58:59], 0, v9
    s_nop 1
    v_cndmask_b32 v232, 0, v36, s[58:59]
    v_cndmask_b32 v233, 0, v36, s[58:59]
    v_cmp_eq_u32 s[58:59], 4, v9
    v_and_b32 v252, 1, v0
    v_mul_u32_u24 v252, 0xaaaa, v252
    v_cndmask_b32 v234, 0, v36, s[58:59]
    v_cndmask_b32 v235, 0, v36, s[58:59]
    v_add_u32 v252, 0x4444, v252
    s_add_u32 m0, m0, 4096
    s_nop 0
    buffer_load_dwordx4 v20, s[32:35], s72 offen offset:0 lds
    buffer_load_dwordx4 v20, s[32:35], s72 offen offset:1024 lds
    buffer_load_dwordx4 v20, s[32:35], s72 offen offset:2048 lds
    buffer_load_dwordx4 v20, s[32:35], s72 offen offset:3072 lds
    s_add_u32 m0, m0, 4096
    s_add_u32 s72, s72, 4096
    buffer_load_dwordx4 v20, s[32:35], s72 offen offset:0 lds
    buffer_load_dwordx4 v20, s[32:35], s72 offen offset:1024 lds
    buffer_load_dwordx4 v20, s[32:35], s72 offen offset:2048 lds
    buffer_load_dwordx4 v20, s[32:35], s72 offen offset:3072 lds
    s_add_u32 m0, m0, 4096
    s_add_u32 s72, s72, 4096
    buffer_load_dwordx4 v20, s[32:35], s72 offen offset:0 lds
    buffer_load_dwordx4 v20, s[32:35], s72 offen offset:1024 lds
    buffer_load_dwordx4 v20, s[32:35], s72 offen offset:2048 lds
    buffer_load_dwordx4 v20, s[32:35], s72 offen offset:3072 lds
    s_add_u32 m0, m0, 4096
    s_add_u32 s72, s72, 4096
    buffer_load_dwordx4 v20, s[32:35], s72 offen offset:0 lds
    buffer_load_dwordx4 v20, s[32:35], s72 offen offset:1024 lds
    buffer_load_dwordx4 v20, s[32:35], s72 offen offset:2048 lds
    buffer_load_dwordx4 v20, s[32:35], s72 offen offset:3072 lds
    s_mov_b64 s[32:33], s[24:25]
    s_mov_b32 s34, 0x100
    s_mov_b32 s35, 0x20000
    s_waitcnt vmcnt(12)
    ds_read_b128 a[128:131], v28 offset:0
    ds_read_b64_tr_b16 a[160:161], v30 offset:8192
    ds_read_b64_tr_b16 a[162:163], v30 offset:8448
    ds_read_b64_tr_b16 a[164:165], v31 offset:8192
    ds_read_b64_tr_b16 a[166:167], v31 offset:8448
    ds_read_b128 a[132:135], v29 offset:0
    ds_read_b64_tr_b16 a[168:169], v30 offset:10240
    ds_read_b64_tr_b16 a[170:171], v30 offset:10496
    ds_read_b64_tr_b16 a[172:173], v31 offset:10240
    ds_read_b64_tr_b16 a[174:175], v31 offset:10496
    s_waitcnt lgkmcnt(9)
    v_mfma_f32_16x16x32_bf16 v[100:103], v[36:39], a[128:131], 0
    s_waitcnt vmcnt(8)
    ds_read_b128 a[136:139], v28 offset:2048
    v_mfma_f32_16x16x32_bf16 v[104:107], a[128:131], a[128:131], 0
    ds_read_b64_tr_b16 a[176:177], v30 offset:12288
    s_mov_b32 m0, s66
    s_lshl_b32 s63, s62, 10
    buffer_load_dwordx4 v12, s[36:39], s62 offen offset:0 lds
    s_waitcnt lgkmcnt(9)
    v_mfma_f32_16x16x32_bf16 v[84:87], a[160:163], a[128:131], 0
    ds_read_b64_tr_b16 a[178:179], v30 offset:12544
    v_mfma_f32_16x16x32_bf16 v[92:95], a[160:163], v[36:39], 0
    ds_read_b64_tr_b16 a[180:181], v31 offset:12288
    s_waitcnt lgkmcnt(9)
    v_mfma_f32_16x16x32_bf16 v[88:91], a[164:167], a[128:131], 0
    ds_read_b64_tr_b16 a[182:183], v31 offset:12544
    v_mfma_f32_16x16x32_bf16 v[96:99], a[164:167], v[36:39], 0
    ds_read_b128 a[140:143], v29 offset:2048
    buffer_load_dwordx4 v13, s[36:39], s62 offen offset:1024 lds
    s_waitcnt lgkmcnt(10)
    v_mfma_f32_16x16x32_bf16 v[100:103], v[36:39], a[132:135], v[100:103]
    ds_read_b64_tr_b16 a[184:185], v30 offset:14336
    v_mfma_f32_16x16x32_bf16 v[104:107], a[132:135], a[132:135], v[104:107]
    ds_read_b64_tr_b16 a[186:187], v30 offset:14592
    s_waitcnt lgkmcnt(10)
    v_mfma_f32_16x16x32_bf16 v[84:87], a[168:171], a[132:135], v[84:87]
    ds_read_b64_tr_b16 a[188:189], v31 offset:14336
    v_mfma_f32_16x16x32_bf16 v[92:95], a[168:171], v[36:39], v[92:95]
    ds_read_b64_tr_b16 a[190:191], v31 offset:14592
    buffer_load_dwordx4 v14, s[36:39], s62 offen offset:2048 lds
    s_waitcnt lgkmcnt(10)
    v_mfma_f32_16x16x32_bf16 v[88:91], a[172:175], a[132:135], v[88:91]
    v_mfma_f32_16x16x32_bf16 v[96:99], a[172:175], v[36:39], v[96:99]
    s_waitcnt lgkmcnt(9)
    v_mfma_f32_16x16x32_bf16 v[100:103], v[36:39], a[136:139], v[100:103]
    s_waitcnt vmcnt(7)
    ds_read_b128 a[144:147], v28 offset:4096
    v_mfma_f32_16x16x32_bf16 v[104:107], a[136:139], a[136:139], v[104:107]
    ds_read_b64_tr_b16 a[192:193], v30 offset:16384
    buffer_load_dwordx4 v15, s[36:39], s62 offen offset:3072 lds
    s_waitcnt lgkmcnt(9)
    v_mfma_f32_16x16x32_bf16 v[84:87], a[176:179], a[136:139], v[84:87]
    ds_read_b64_tr_b16 a[194:195], v30 offset:16640
    v_mfma_f32_16x16x32_bf16 v[92:95], a[176:179], v[36:39], v[92:95]
    ds_read_b64_tr_b16 a[196:197], v31 offset:16384
    s_waitcnt lgkmcnt(9)
    v_mfma_f32_16x16x32_bf16 v[88:91], a[180:183], a[136:139], v[88:91]
    ds_read_b64_tr_b16 a[198:199], v31 offset:16640
    v_mfma_f32_16x16x32_bf16 v[96:99], a[180:183], v[36:39], v[96:99]
    ds_read_b128 a[148:151], v29 offset:4096
    s_add_u32 m0, m0, 4096
    s_add_u32 s62, s62, 128
    buffer_load_dwordx4 v16, s[40:43], s63 offen offset:0 lds
    s_waitcnt lgkmcnt(10)
    v_mfma_f32_16x16x32_bf16 v[100:103], v[36:39], a[140:143], v[100:103]
    ds_read_b64_tr_b16 a[200:201], v30 offset:18432
    v_mfma_f32_16x16x32_bf16 v[104:107], a[140:143], a[140:143], v[104:107]
    ds_read_b64_tr_b16 a[202:203], v30 offset:18688
    s_waitcnt lgkmcnt(10)
    v_mfma_f32_16x16x32_bf16 v[84:87], a[184:187], a[140:143], v[84:87]
    ds_read_b64_tr_b16 a[204:205], v31 offset:18432
    v_mfma_f32_16x16x32_bf16 v[92:95], a[184:187], v[36:39], v[92:95]
    ds_read_b64_tr_b16 a[206:207], v31 offset:18688
    buffer_load_dwordx4 v17, s[40:43], s63 offen offset:1024 lds
    s_waitcnt lgkmcnt(10)
    v_mfma_f32_16x16x32_bf16 v[88:91], a[188:191], a[140:143], v[88:91]
    v_mfma_f32_16x16x32_bf16 v[96:99], a[188:191], v[36:39], v[96:99]
    s_waitcnt lgkmcnt(9)
    v_mfma_f32_16x16x32_bf16 v[100:103], v[36:39], a[144:147], v[100:103]
    s_waitcnt vmcnt(6)
    ds_read_b128 a[152:155], v28 offset:6144
    v_mfma_f32_16x16x32_bf16 v[104:107], a[144:147], a[144:147], v[104:107]
    ds_read_b64_tr_b16 a[208:209], v30 offset:20480
    s_and_b32 s62, s62, 2047
    s_add_u32 m0, s66, 24576
    s_lshl_b32 s63, s62, 10
    buffer_load_dwordx4 v12, s[36:39], s62 offen offset:0 lds
    s_waitcnt lgkmcnt(9)
    v_mfma_f32_16x16x32_bf16 v[84:87], a[192:195], a[144:147], v[84:87]
    ds_read_b64_tr_b16 a[210:211], v30 offset:20736
    v_mfma_f32_16x16x32_bf16 v[92:95], a[192:195], v[36:39], v[92:95]
    ds_read_b64_tr_b16 a[212:213], v31 offset:20480
    s_waitcnt lgkmcnt(9)
    v_mfma_f32_16x16x32_bf16 v[88:91], a[196:199], a[144:147], v[88:91]
    ds_read_b64_tr_b16 a[214:215], v31 offset:20736
    v_mfma_f32_16x16x32_bf16 v[96:99], a[196:199], v[36:39], v[96:99]
    ds_read_b128 a[156:159], v29 offset:6144
    buffer_load_dwordx4 v13, s[36:39], s62 offen offset:1024 lds
    s_waitcnt lgkmcnt(10)
    v_mfma_f32_16x16x32_bf16 v[100:103], v[36:39], a[148:151], v[100:103]
    ds_read_b64_tr_b16 a[216:217], v30 offset:22528
    v_mfma_f32_16x16x32_bf16 v[104:107], a[148:151], a[148:151], v[104:107]
    ds_read_b64_tr_b16 a[218:219], v30 offset:22784
    s_waitcnt lgkmcnt(10)
    v_mfma_f32_16x16x32_bf16 v[84:87], a[200:203], a[148:151], v[84:87]
    ds_read_b64_tr_b16 a[220:221], v31 offset:22528
    v_mfma_f32_16x16x32_bf16 v[92:95], a[200:203], v[36:39], v[92:95]
    ds_read_b64_tr_b16 a[222:223], v31 offset:22784
    buffer_load_dwordx4 v14, s[36:39], s62 offen offset:2048 lds
    s_waitcnt lgkmcnt(10)
    v_mfma_f32_16x16x32_bf16 v[88:91], a[204:207], a[148:151], v[88:91]
    v_mfma_f32_16x16x32_bf16 v[96:99], a[204:207], v[36:39], v[96:99]
    s_waitcnt lgkmcnt(9)
    v_mfma_f32_16x16x32_bf16 v[100:103], v[36:39], a[152:155], v[100:103]
    v_mfma_f32_16x16x32_bf16 v[104:107], a[152:155], a[152:155], v[104:107]
    buffer_load_dwordx4 v15, s[36:39], s62 offen offset:3072 lds
    s_waitcnt lgkmcnt(7)
    v_mfma_f32_16x16x32_bf16 v[84:87], a[208:211], a[152:155], v[84:87]
    v_mfma_f32_16x16x32_bf16 v[92:95], a[208:211], v[36:39], v[92:95]
    s_waitcnt lgkmcnt(5)
    v_mfma_f32_16x16x32_bf16 v[88:91], a[212:215], a[152:155], v[88:91]
    v_mfma_f32_16x16x32_bf16 v[96:99], a[212:215], v[36:39], v[96:99]
    s_add_u32 m0, m0, 4096
    s_add_u32 s62, s62, 128
    buffer_load_dwordx4 v16, s[40:43], s63 offen offset:0 lds
    s_waitcnt lgkmcnt(4)
    v_mfma_f32_16x16x32_bf16 v[100:103], v[36:39], a[156:159], v[100:103]
    v_mfma_f32_16x16x32_bf16 v[104:107], a[156:159], a[156:159], v[104:107]
    s_waitcnt lgkmcnt(2)
    v_mfma_f32_16x16x32_bf16 v[84:87], a[216:219], a[156:159], v[84:87]
    v_mfma_f32_16x16x32_bf16 v[92:95], a[216:219], v[36:39], v[92:95]
    buffer_load_dwordx4 v17, s[40:43], s63 offen offset:1024 lds
    s_waitcnt lgkmcnt(0)
    v_mfma_f32_16x16x32_bf16 v[88:91], a[220:223], a[156:159], v[88:91]
    v_mfma_f32_16x16x32_bf16 v[96:99], a[220:223], v[36:39], v[96:99]
    s_or_b32 s56, s2, s52
    s_cbranch_scc1 F_nordy
    buffer_store_dword v3, v2, s[32:35], 0 offen sc1
F_nordy:
    s_and_b32 s62, s62, 2047
    v_cndmask_b32 v104, v104, v105, s[0:1]
    v_cndmask_b32 v104, v104, v106, s[14:15]
    v_cndmask_b32 v104, v104, v107, s[74:75]
    v_cndmask_b32 v101, 0, v104, vcc
    s_cmp_eq_u32 s52, 0
    s_cbranch_scc1 F_p0fin
    ds_write_b128 v35, v[100:103] offset:4096
    ds_write_b128 v35, v[84:87] offset:0
    ds_write_b128 v35, v[92:95] offset:2048
    ds_write_b128 v35, v[88:91] offset:1024
    ds_write_b128 v35, v[96:99] offset:3072
    s_waitcnt lgkmcnt(0)
    s_barrier
    s_branch F_p1
F_p0fin:
    s_mov_b32 s57, 0x3a800000
    s_barrier
    ds_read_b128 v[160:163], v35 offset:9216
    ds_read_b128 v[164:167], v35 offset:14336
    ds_read_b128 v[168:171], v35 offset:19456
    ds_read_b128 v[112:115], v35 offset:5120
    ds_read_b128 v[116:119], v35 offset:10240
    ds_read_b128 v[120:123], v35 offset:15360
    ds_read_b128 v[136:139], v35 offset:7168
    ds_read_b128 v[140:143], v35 offset:12288
    ds_read_b128 v[144:147], v35 offset:17408
    ds_read_b128 v[124:127], v35 offset:6144
    ds_read_b128 v[128:131], v35 offset:11264
    ds_read_b128 v[132:135], v35 offset:16384
    ds_read_b128 v[148:151], v35 offset:8192
    ds_read_b128 v[152:155], v35 offset:13312
    ds_read_b128 v[156:159], v35 offset:18432
    s_waitcnt lgkmcnt(14)
    v_pk_add_f32 v[100:101], v[100:101], v[160:161]
    s_waitcnt lgkmcnt(12)
    v_pk_add_f32 v[164:165], v[164:165], v[168:169]
    v_pk_add_f32 v[102:103], v[102:103], v[162:163]
    v_pk_add_f32 v[166:167], v[166:167], v[170:171]
    v_pk_add_f32 v[100:101], v[100:101], v[164:165]
    v_pk_add_f32 v[102:103], v[102:103], v[166:167]
    v_mov_b32 v4, v101
    s_nop 1
    v_permlane16_swap_b32 v101, v4
    v_add_f32 v101, v101, v4
    v_mov_b32 v4, v101
    s_nop 1
    v_permlane32_swap_b32 v101, v4
    v_add_f32 v101, v101, v4
    v_mul_f32 v104, s57, v100
    v_mul_f32 v4, v104, v104
    v_fma_f32 v4, v101, s57, -v4
    v_max_f32 v4, 0, v4
    v_add_f32 v4, 0x3727c5ac, v4
    v_rsq_f32 v105, v4
    s_lshr_b32 s56, s61, 5
    s_lshl_b32 s56, s56, 12
    s_bfe_u32 s57, s61, 0x10004
    s_waitcnt lgkmcnt(11)
    v_pk_add_f32 v[84:85], v[84:85], v[112:113]
    s_waitcnt lgkmcnt(9)
    v_pk_add_f32 v[116:117], v[116:117], v[120:121]
    v_pk_add_f32 v[86:87], v[86:87], v[114:115]
    v_pk_add_f32 v[118:119], v[118:119], v[122:123]
    v_pk_add_f32 v[84:85], v[84:85], v[116:117]
    v_pk_add_f32 v[86:87], v[86:87], v[118:119]
    s_waitcnt lgkmcnt(8)
    v_pk_add_f32 v[92:93], v[92:93], v[136:137]
    s_waitcnt lgkmcnt(6)
    v_pk_add_f32 v[140:141], v[140:141], v[144:145]
    v_pk_add_f32 v[94:95], v[94:95], v[138:139]
    v_pk_add_f32 v[142:143], v[142:143], v[146:147]
    v_pk_add_f32 v[92:93], v[92:93], v[140:141]
    v_pk_add_f32 v[94:95], v[94:95], v[142:143]
    v_pk_fma_f32 v[84:85], v[92:93], v[104:105], v[84:85] op_sel_hi:[1,0,1] neg_lo:[0,1,0] neg_hi:[0,1,0]
    v_pk_fma_f32 v[86:87], v[94:95], v[104:105], v[86:87] op_sel_hi:[1,0,1] neg_lo:[0,1,0] neg_hi:[0,1,0]
    v_pk_mul_f32 v[84:85], v[84:85], v[104:105] op_sel:[0,1]
    v_pk_mul_f32 v[86:87], v[86:87], v[104:105] op_sel:[0,1]
    v_cvt_pk_bf16_f32 v108, v84, v85
    v_cvt_pk_bf16_f32 v109, v86, v87
    s_waitcnt lgkmcnt(5)
    v_pk_add_f32 v[88:89], v[88:89], v[124:125]
    s_waitcnt lgkmcnt(3)
    v_pk_add_f32 v[128:129], v[128:129], v[132:133]
    v_pk_add_f32 v[90:91], v[90:91], v[126:127]
    v_pk_add_f32 v[130:131], v[130:131], v[134:135]
    v_pk_add_f32 v[88:89], v[88:89], v[128:129]
    v_pk_add_f32 v[90:91], v[90:91], v[130:131]
    s_waitcnt lgkmcnt(2)
    v_pk_add_f32 v[96:97], v[96:97], v[148:149]
    s_waitcnt lgkmcnt(0)
    v_pk_add_f32 v[152:153], v[152:153], v[156:157]
    v_pk_add_f32 v[98:99], v[98:99], v[150:151]
    v_pk_add_f32 v[154:155], v[154:155], v[158:159]
    v_pk_add_f32 v[96:97], v[96:97], v[152:153]
    v_pk_add_f32 v[98:99], v[98:99], v[154:155]
    v_pk_fma_f32 v[88:89], v[96:97], v[104:105], v[88:89] op_sel_hi:[1,0,1] neg_lo:[0,1,0] neg_hi:[0,1,0]
    v_pk_fma_f32 v[90:91], v[98:99], v[104:105], v[90:91] op_sel_hi:[1,0,1] neg_lo:[0,1,0] neg_hi:[0,1,0]
    v_pk_mul_f32 v[88:89], v[88:89], v[104:105] op_sel:[0,1]
    v_pk_mul_f32 v[90:91], v[90:91], v[104:105] op_sel:[0,1]
    v_cvt_pk_bf16_f32 v110, v88, v89
    v_cvt_pk_bf16_f32 v111, v90, v91
    s_bitcmp1_b32 s54, 0
    s_cbranch_scc1 F_p0v
    s_lshl_b32 s57, s57, 8
    s_add_u32 s56, s56, s57
    buffer_store_dwordx4 v[108:111], v34, s[28:31], s56 offen sc1
    s_lshl_b32 s56, s61, 3
    s_mov_b64 exec, 0xffff
    buffer_store_dwordx2 v[104:105], v246, s[48:51], s56 offen offset:0 sc1
    s_mov_b64 exec, -1
    s_branch F_p1
F_p0v:
    v_lshrrev_b32 v5, 4, v0
    v_add_u32 v4, v5, v246
    v_lshlrev_b32 v4, 3, v4
    v_add_u32 v4, 147456, v4
    ds_write_b64 v4, v[108:109]
    ds_write_b64 v4, v[110:111] offset:32
    v_lshrrev_b32 v7, 2, v0
    v_lshlrev_b32 v7, 6, v7
    v_and_b32 v8, 3, v0
    v_lshl_add_u32 v7, v8, 3, v7
    v_add_u32 v7, 147456, v7
    ds_read_b64_tr_b16 v[84:85], v7
    ds_read_b64_tr_b16 v[86:87], v7 offset:32
    s_lshl_b32 s57, s57, 10
    s_add_u32 s56, s56, s57
    s_waitcnt lgkmcnt(0)
    v_permlane32_swap_b32 v84, v86
    v_permlane32_swap_b32 v85, v87
    buffer_store_dwordx4 v[84:87], v34, s[28:31], s56 offen offset:2048 sc1
F_p1:
    s_lshl_b32 s56, s2, 2
    s_add_u32 s56, s56, s52
    s_lshl_b32 s56, s56, 10
    s_add_u32 s56, s56, 524288
    buffer_store_dwordx4 v[48:51], v1, s[48:51], s56 offen sc1
    s_cmp_ge_u32 s2, 2
    s_cbranch_scc1 F_nogz
    s_sub_u32 s56, s56, 131072
    buffer_store_dwordx4 v[48:51], v1, s[48:51], s56 offen sc1
F_nogz:
    s_cmp_lg_u32 s52, 0
    s_cbranch_scc1 F_nor
    buffer_load_dword v9, v2, s[32:35], 0 offen sc1
F_nor:
    s_add_u32 m0, s66, 49152
    s_lshl_b32 s63, s62, 10
    buffer_load_dwordx4 v12, s[36:39], s62 offen offset:0 lds
    buffer_load_dwordx4 v13, s[36:39], s62 offen offset:1024 lds
    buffer_load_dwordx4 v14, s[36:39], s62 offen offset:2048 lds
    buffer_load_dwordx4 v15, s[36:39], s62 offen offset:3072 lds
    s_add_u32 m0, m0, 4096
    s_add_u32 s62, s62, 128
    buffer_load_dwordx4 v16, s[40:43], s63 offen offset:0 lds
    buffer_load_dwordx4 v17, s[40:43], s63 offen offset:1024 lds
    s_and_b32 s62, s62, 2047
    s_add_u32 m0, s66, 73728
    s_lshl_b32 s63, s62, 10
    buffer_load_dwordx4 v12, s[36:39], s62 offen offset:0 lds
    buffer_load_dwordx4 v13, s[36:39], s62 offen offset:1024 lds
    buffer_load_dwordx4 v14, s[36:39], s62 offen offset:2048 lds
    buffer_load_dwordx4 v15, s[36:39], s62 offen offset:3072 lds
    s_add_u32 m0, m0, 4096
    s_add_u32 s62, s62, 128
    buffer_load_dwordx4 v16, s[40:43], s63 offen offset:0 lds
    buffer_load_dwordx4 v17, s[40:43], s63 offen offset:1024 lds
    s_and_b32 s62, s62, 2047
    v_pk_mov_b32 v[144:145], 0, 0
    v_pk_mov_b32 v[146:147], 0, 0
    v_pk_mov_b32 v[148:149], 0, 0
    v_pk_mov_b32 v[150:151], 0, 0
    v_pk_mov_b32 v[152:153], 0, 0
    v_pk_mov_b32 v[154:155], 0, 0
    v_pk_mov_b32 v[156:157], 0, 0
    v_pk_mov_b32 v[158:159], 0, 0
    v_pk_mov_b32 v[160:161], 0, 0
    v_pk_mov_b32 v[162:163], 0, 0
    v_pk_mov_b32 v[164:165], 0, 0
    v_pk_mov_b32 v[166:167], 0, 0
    v_pk_mov_b32 v[168:169], 0, 0
    v_pk_mov_b32 v[170:171], 0, 0
    v_pk_mov_b32 v[172:173], 0, 0
    v_pk_mov_b32 v[174:175], 0, 0
    s_waitcnt vmcnt(19)
    s_barrier
    ds_read_b64_tr_b16 a[144:145], v24 offset:4096
    ds_read_b64_tr_b16 a[146:147], v24 offset:4608
    ds_read_b64_tr_b16 a[148:149], v24 offset:16384
    ds_read_b64_tr_b16 a[150:151], v24 offset:16896
    ds_read_b128 a[128:131], v22 offset:0
    ds_read_b128 a[132:135], v23 offset:0
    ds_read_b128 a[136:139], v22 offset:2048
    ds_read_b128 a[140:143], v23 offset:2048
    ds_read_b64_tr_b16 a[152:153], v25 offset:4096
    ds_read_b64_tr_b16 a[154:155], v25 offset:4608
    ds_read_b64_tr_b16 a[156:157], v25 offset:16384
    ds_read_b64_tr_b16 a[158:159], v25 offset:16896
    ds_read_b64_tr_b16 a[160:161], v26 offset:4096
    ds_read_b64_tr_b16 a[162:163], v26 offset:4608
    ds_read_b64_tr_b16 a[164:165], v26 offset:16384
    ds_read_b64_tr_b16 a[166:167], v26 offset:16896
    ds_read_b64_tr_b16 a[168:169], v27 offset:4096
    ds_read_b64_tr_b16 a[170:171], v27 offset:4608
    ds_read_b64_tr_b16 a[172:173], v27 offset:16384
    ds_read_b64_tr_b16 a[174:175], v27 offset:16896
    v_mov_b32 v28, v22
    v_mov_b32 v29, v23
    v_mov_b32 v30, v24
    v_mov_b32 v31, v25
    v_mov_b32 v32, v26
    v_mov_b32 v33, v27
    s_mov_b32 s65, 49152
    s_add_u32 s64, s66, 98304
    s_and_b32 s61, s2, 15
    s_lshl_b32 s61, s61, 8
    s_add_u32 s61, s61, 16384
    s_mov_b32 s60, 1048576
    s_lshl_b32 s58, s52, 8
    s_add_u32 s58, s58, 6
    s_mov_b32 s59, 6
    s_mov_b32 s56, s66
F_p1loop:
    s_waitcnt vmcnt(12) lgkmcnt(12)
    s_barrier
    v_mfma_f32_16x16x32_bf16 v[80:83], a[144:147], v[36:39], v[80:83]
    ds_read_b64_tr_b16 a[192:193], v30 offset:28672
    ds_read_b64_tr_b16 a[194:195], v30 offset:29184
    s_add_u32 m0, s64, 0
    v_mfma_f32_16x16x32_bf16 v[80:83], a[148:151], v[36:39], v[80:83]
    ds_read_b64_tr_b16 a[196:197], v30 offset:40960
    ds_read_b64_tr_b16 a[198:199], v30 offset:41472
    s_lshl_b32 s63, s62, 10
    v_mfma_f32_16x16x32_bf16 v[48:51], a[144:147], a[128:131], v[48:51]
    ds_read_b128 a[176:179], v28 offset:24576
    buffer_load_dwordx4 v12, s[36:39], s62 offen offset:0 lds
    v_mfma_f32_16x16x32_bf16 v[48:51], a[148:151], a[132:135], v[48:51]
    ds_read_b128 a[180:183], v29 offset:24576
    v_add_u32 v30, s65, v24
    v_mfma_f32_16x16x32_bf16 v[52:55], a[148:151], a[140:143], v[52:55]
    ds_read_b128 a[184:187], v28 offset:26624
    v_mfma_f32_16x16x32_bf16 v[52:55], a[144:147], a[136:139], v[52:55]
    ds_read_b128 a[188:191], v29 offset:26624
    buffer_load_dwordx4 v13, s[36:39], s62 offen offset:1024 lds
    s_waitcnt lgkmcnt(14)
    v_mfma_f32_16x16x32_bf16 v[60:63], a[152:155], a[136:139], v[60:63]
    ds_read_b64_tr_b16 a[200:201], v31 offset:28672
    v_add_u32 v28, s65, v22
    v_mfma_f32_16x16x32_bf16 v[60:63], a[156:159], a[140:143], v[60:63]
    ds_read_b64_tr_b16 a[202:203], v31 offset:29184
    v_add_u32 v29, s65, v23
    v_mfma_f32_16x16x32_bf16 v[56:59], a[156:159], a[132:135], v[56:59]
    ds_read_b64_tr_b16 a[204:205], v31 offset:40960
    buffer_load_dwordx4 v14, s[36:39], s62 offen offset:2048 lds
    v_mfma_f32_16x16x32_bf16 v[56:59], a[152:155], a[128:131], v[56:59]
    ds_read_b64_tr_b16 a[206:207], v31 offset:41472
    v_mfma_f32_16x16x32_bf16 v[64:67], a[160:163], a[128:131], v[64:67]
    ds_read_b64_tr_b16 a[208:209], v32 offset:28672
    v_add_u32 v31, s65, v25
    s_waitcnt lgkmcnt(14)
    v_mfma_f32_16x16x32_bf16 v[64:67], a[164:167], a[132:135], v[64:67]
    ds_read_b64_tr_b16 a[210:211], v32 offset:29184
    buffer_load_dwordx4 v15, s[36:39], s62 offen offset:3072 lds
    v_mfma_f32_16x16x32_bf16 v[68:71], a[164:167], a[140:143], v[68:71]
    ds_read_b64_tr_b16 a[212:213], v32 offset:40960
    s_add_u32 m0, m0, 4096
    v_mfma_f32_16x16x32_bf16 v[68:71], a[160:163], a[136:139], v[68:71]
    ds_read_b64_tr_b16 a[214:215], v32 offset:41472
    s_add_u32 s62, s62, 128
    v_mfma_f32_16x16x32_bf16 v[76:79], a[168:171], a[136:139], v[76:79]
    ds_read_b64_tr_b16 a[216:217], v33 offset:28672
    buffer_load_dwordx4 v16, s[40:43], s63 offen offset:0 lds
    s_waitcnt lgkmcnt(14)
    v_mfma_f32_16x16x32_bf16 v[76:79], a[172:175], a[140:143], v[76:79]
    ds_read_b64_tr_b16 a[218:219], v33 offset:29184
    v_add_u32 v32, s65, v26
    v_mfma_f32_16x16x32_bf16 v[72:75], a[172:175], a[132:135], v[72:75]
    ds_read_b64_tr_b16 a[220:221], v33 offset:40960
    s_and_b32 s62, s62, 2047
    v_mfma_f32_16x16x32_bf16 v[72:75], a[168:171], a[128:131], v[72:75]
    ds_read_b64_tr_b16 a[222:223], v33 offset:41472
    buffer_load_dwordx4 v17, s[40:43], s63 offen offset:1024 lds
    v_add_u32 v33, s65, v27
    s_waitcnt vmcnt(12) lgkmcnt(12)
    s_barrier
    s_cmp_lg_u32 s59, s58
    s_cbranch_scc1 F_noarr
F_rchk:
    v_readfirstlane_b32 s57, v9
    s_sub_u32 s60, s60, 1
    s_cselect_b32 s57, 1, s57
    s_cmp_lg_u32 s57, 0
    s_cbranch_scc1 F_arr
    buffer_load_dword v9, v2, s[32:35], 0 offen sc1
    s_waitcnt vmcnt(0)
    s_branch F_rchk
F_arr:
    buffer_atomic_add v3, v2, s[48:51], s61 offen
F_noarr:
    v_mfma_f32_16x16x32_bf16 v[80:83], a[192:195], v[36:39], v[80:83]
    ds_read_b64_tr_b16 a[144:145], v30 offset:4096
    ds_read_b64_tr_b16 a[146:147], v30 offset:4608
    s_add_u32 m0, s64, 24576
    v_mfma_f32_16x16x32_bf16 v[80:83], a[196:199], v[36:39], v[80:83]
    ds_read_b64_tr_b16 a[148:149], v30 offset:16384
    ds_read_b64_tr_b16 a[150:151], v30 offset:16896
    s_lshl_b32 s63, s62, 10
    v_mfma_f32_16x16x32_bf16 v[48:51], a[192:195], a[176:179], v[48:51]
    ds_read_b128 a[128:131], v28 offset:0
    buffer_load_dwordx4 v12, s[36:39], s62 offen offset:0 lds
    v_mfma_f32_16x16x32_bf16 v[48:51], a[196:199], a[180:183], v[48:51]
    ds_read_b128 a[132:135], v29 offset:0
    s_mov_b32 s64, s56
    v_mfma_f32_16x16x32_bf16 v[52:55], a[196:199], a[188:191], v[52:55]
    ds_read_b128 a[136:139], v28 offset:2048
    s_add_u32 s56, s65, s66
    v_mfma_f32_16x16x32_bf16 v[52:55], a[192:195], a[184:187], v[52:55]
    ds_read_b128 a[140:143], v29 offset:2048
    buffer_load_dwordx4 v13, s[36:39], s62 offen offset:1024 lds
    s_waitcnt lgkmcnt(14)
    v_mfma_f32_16x16x32_bf16 v[60:63], a[200:203], a[184:187], v[60:63]
    ds_read_b64_tr_b16 a[152:153], v31 offset:4096
    s_add_u32 s65, s65, 49152
    v_mfma_f32_16x16x32_bf16 v[60:63], a[204:207], a[188:191], v[60:63]
    ds_read_b64_tr_b16 a[154:155], v31 offset:4608
    s_cmp_eq_u32 s65, 147456
    s_cselect_b32 s65, 0, s65
    v_mfma_f32_16x16x32_bf16 v[56:59], a[204:207], a[180:183], v[56:59]
    ds_read_b64_tr_b16 a[156:157], v31 offset:16384
    buffer_load_dwordx4 v14, s[36:39], s62 offen offset:2048 lds
    v_mfma_f32_16x16x32_bf16 v[56:59], a[200:203], a[176:179], v[56:59]
    ds_read_b64_tr_b16 a[158:159], v31 offset:16896
    s_sub_u32 s59, s59, 1
    v_mfma_f32_16x16x32_bf16 v[64:67], a[208:211], a[176:179], v[64:67]
    ds_read_b64_tr_b16 a[160:161], v32 offset:4096
    s_waitcnt lgkmcnt(14)
    v_mfma_f32_16x16x32_bf16 v[64:67], a[212:215], a[180:183], v[64:67]
    ds_read_b64_tr_b16 a[162:163], v32 offset:4608
    buffer_load_dwordx4 v15, s[36:39], s62 offen offset:3072 lds
    v_mfma_f32_16x16x32_bf16 v[68:71], a[212:215], a[188:191], v[68:71]
    ds_read_b64_tr_b16 a[164:165], v32 offset:16384
    s_add_u32 m0, m0, 4096
    v_mfma_f32_16x16x32_bf16 v[68:71], a[208:211], a[184:187], v[68:71]
    ds_read_b64_tr_b16 a[166:167], v32 offset:16896
    s_add_u32 s62, s62, 128
    v_mfma_f32_16x16x32_bf16 v[76:79], a[216:219], a[184:187], v[76:79]
    ds_read_b64_tr_b16 a[168:169], v33 offset:4096
    buffer_load_dwordx4 v16, s[40:43], s63 offen offset:0 lds
    s_waitcnt lgkmcnt(14)
    v_mfma_f32_16x16x32_bf16 v[76:79], a[220:223], a[188:191], v[76:79]
    ds_read_b64_tr_b16 a[170:171], v33 offset:4608
    s_and_b32 s62, s62, 2047
    v_mfma_f32_16x16x32_bf16 v[72:75], a[220:223], a[180:183], v[72:75]
    ds_read_b64_tr_b16 a[172:173], v33 offset:16384
    s_cmp_lg_u32 s59, 0
    v_mfma_f32_16x16x32_bf16 v[72:75], a[216:219], a[176:179], v[72:75]
    ds_read_b64_tr_b16 a[174:175], v33 offset:16896
    buffer_load_dwordx4 v17, s[40:43], s63 offen offset:1024 lds
    s_cbranch_scc1 F_p1loop
    s_waitcnt vmcnt(12) lgkmcnt(12)
    s_barrier
    v_mfma_f32_16x16x32_bf16 v[80:83], a[144:147], v[36:39], v[80:83]
    ds_read_b64_tr_b16 a[192:193], v30 offset:28672
    ds_read_b64_tr_b16 a[194:195], v30 offset:29184
    v_mfma_f32_16x16x32_bf16 v[80:83], a[148:151], v[36:39], v[80:83]
    ds_read_b64_tr_b16 a[196:197], v30 offset:40960
    ds_read_b64_tr_b16 a[198:199], v30 offset:41472
    v_mfma_f32_16x16x32_bf16 v[48:51], a[144:147], a[128:131], v[48:51]
    ds_read_b128 a[176:179], v28 offset:24576
    s_movk_i32 s61, 16384
    v_mfma_f32_16x16x32_bf16 v[48:51], a[148:151], a[132:135], v[48:51]
    ds_read_b128 a[180:183], v29 offset:24576
    v_add_u32 v30, s65, v24
    v_mfma_f32_16x16x32_bf16 v[52:55], a[148:151], a[140:143], v[52:55]
    ds_read_b128 a[184:187], v28 offset:26624
    buffer_load_dword v9, v245, s[48:51], s61 offen sc1
    v_mfma_f32_16x16x32_bf16 v[52:55], a[144:147], a[136:139], v[52:55]
    ds_read_b128 a[188:191], v29 offset:26624
    s_mov_b32 s60, 1048576
    s_waitcnt lgkmcnt(14)
    v_mfma_f32_16x16x32_bf16 v[60:63], a[152:155], a[136:139], v[60:63]
    ds_read_b64_tr_b16 a[200:201], v31 offset:28672
    v_add_u32 v28, s65, v22
    v_mfma_f32_16x16x32_bf16 v[60:63], a[156:159], a[140:143], v[60:63]
    ds_read_b64_tr_b16 a[202:203], v31 offset:29184
    v_add_u32 v29, s65, v23
    v_mfma_f32_16x16x32_bf16 v[56:59], a[156:159], a[132:135], v[56:59]
    ds_read_b64_tr_b16 a[204:205], v31 offset:40960
    v_mfma_f32_16x16x32_bf16 v[56:59], a[152:155], a[128:131], v[56:59]
    ds_read_b64_tr_b16 a[206:207], v31 offset:41472
    v_mfma_f32_16x16x32_bf16 v[64:67], a[160:163], a[128:131], v[64:67]
    ds_read_b64_tr_b16 a[208:209], v32 offset:28672
    v_add_u32 v31, s65, v25
    s_waitcnt lgkmcnt(14)
    v_mfma_f32_16x16x32_bf16 v[64:67], a[164:167], a[132:135], v[64:67]
    ds_read_b64_tr_b16 a[210:211], v32 offset:29184
    s_lshl_b32 s56, s55, 3
    v_mfma_f32_16x16x32_bf16 v[68:71], a[164:167], a[140:143], v[68:71]
    ds_read_b64_tr_b16 a[212:213], v32 offset:40960
    v_mfma_f32_16x16x32_bf16 v[68:71], a[160:163], a[136:139], v[68:71]
    ds_read_b64_tr_b16 a[214:215], v32 offset:41472
    v_mfma_f32_16x16x32_bf16 v[76:79], a[168:171], a[136:139], v[76:79]
    ds_read_b64_tr_b16 a[216:217], v33 offset:28672
    s_waitcnt lgkmcnt(14)
    v_mfma_f32_16x16x32_bf16 v[76:79], a[172:175], a[140:143], v[76:79]
    ds_read_b64_tr_b16 a[218:219], v33 offset:29184
    v_add_u32 v32, s65, v26
    v_mfma_f32_16x16x32_bf16 v[72:75], a[172:175], a[132:135], v[72:75]
    ds_read_b64_tr_b16 a[220:221], v33 offset:40960
    v_mfma_f32_16x16x32_bf16 v[72:75], a[168:171], a[128:131], v[72:75]
    ds_read_b64_tr_b16 a[222:223], v33 offset:41472
    v_add_u32 v33, s65, v27
    s_waitcnt vmcnt(0) lgkmcnt(12)
    s_barrier
    s_branch F_gchk
F_gpoll:
    buffer_load_dword v9, v245, s[48:51], s61 offen sc1
    s_waitcnt vmcnt(0)
F_gchk:
    v_cmp_gt_u32 vcc, 16, v9
    s_sub_u32 s60, s60, 1
    s_cbranch_scc1 F_gdone
    s_cbranch_vccnz F_gpoll
F_gdone:
    v_mfma_f32_16x16x32_bf16 v[80:83], a[192:195], v[36:39], v[80:83]
    ds_read_b64_tr_b16 a[144:145], v30 offset:4096
    ds_read_b64_tr_b16 a[146:147], v30 offset:4608
    v_mfma_f32_16x16x32_bf16 v[80:83], a[196:199], v[36:39], v[80:83]
    ds_read_b64_tr_b16 a[148:149], v30 offset:16384
    ds_read_b64_tr_b16 a[150:151], v30 offset:16896
    v_mfma_f32_16x16x32_bf16 v[48:51], a[192:195], a[176:179], v[48:51]
    ds_read_b128 a[128:131], v28 offset:0
    buffer_load_dwordx2 v[84:85], v246, s[48:51], s56 offen offset:0 sc1
    v_mfma_f32_16x16x32_bf16 v[48:51], a[196:199], a[180:183], v[48:51]
    ds_read_b128 a[132:135], v29 offset:0
    v_mfma_f32_16x16x32_bf16 v[52:55], a[196:199], a[188:191], v[52:55]
    ds_read_b128 a[136:139], v28 offset:2048
    v_mfma_f32_16x16x32_bf16 v[52:55], a[192:195], a[184:187], v[52:55]
    ds_read_b128 a[140:143], v29 offset:2048
    buffer_load_dwordx2 v[86:87], v246, s[48:51], s56 offen offset:128 sc1
    s_waitcnt lgkmcnt(14)
    v_mfma_f32_16x16x32_bf16 v[60:63], a[200:203], a[184:187], v[60:63]
    ds_read_b64_tr_b16 a[152:153], v31 offset:4096
    v_mfma_f32_16x16x32_bf16 v[60:63], a[204:207], a[188:191], v[60:63]
    ds_read_b64_tr_b16 a[154:155], v31 offset:4608
    v_mfma_f32_16x16x32_bf16 v[56:59], a[204:207], a[180:183], v[56:59]
    ds_read_b64_tr_b16 a[156:157], v31 offset:16384
    s_and_b32 s73, s52, 1
    s_lshl_b32 s73, s73, 17
    s_add_u32 s30, s73, 0x20000
    buffer_load_dwordx4 a[0:3], v1, s[28:31], s73 offen offset:0
    v_mfma_f32_16x16x32_bf16 v[56:59], a[200:203], a[176:179], v[56:59]
    ds_read_b64_tr_b16 a[158:159], v31 offset:16896
    v_mfma_f32_16x16x32_bf16 v[64:67], a[208:211], a[176:179], v[64:67]
    ds_read_b64_tr_b16 a[160:161], v32 offset:4096
    s_waitcnt lgkmcnt(14)
    v_mfma_f32_16x16x32_bf16 v[64:67], a[212:215], a[180:183], v[64:67]
    ds_read_b64_tr_b16 a[162:163], v32 offset:4608
    buffer_load_dwordx4 a[4:7], v1, s[28:31], s73 offen offset:1024
    v_mfma_f32_16x16x32_bf16 v[68:71], a[212:215], a[188:191], v[68:71]
    ds_read_b64_tr_b16 a[164:165], v32 offset:16384
    v_mfma_f32_16x16x32_bf16 v[68:71], a[208:211], a[184:187], v[68:71]
    ds_read_b64_tr_b16 a[166:167], v32 offset:16896
    v_mfma_f32_16x16x32_bf16 v[76:79], a[216:219], a[184:187], v[76:79]
    ds_read_b64_tr_b16 a[168:169], v33 offset:4096
    buffer_load_dwordx4 a[64:67], v1, s[28:31], s73 offen offset:2048
    s_waitcnt lgkmcnt(14)
    v_mfma_f32_16x16x32_bf16 v[76:79], a[220:223], a[188:191], v[76:79]
    ds_read_b64_tr_b16 a[170:171], v33 offset:4608
    v_mfma_f32_16x16x32_bf16 v[72:75], a[220:223], a[180:183], v[72:75]
    ds_read_b64_tr_b16 a[172:173], v33 offset:16384
    v_mfma_f32_16x16x32_bf16 v[72:75], a[216:219], a[176:179], v[72:75]
    ds_read_b64_tr_b16 a[174:175], v33 offset:16896
    buffer_load_dwordx4 a[68:71], v1, s[28:31], s73 offen offset:3072
    v_mfma_f32_16x16x32_bf16 v[80:83], a[144:147], v[36:39], v[80:83]
    ds_read_b64_tr_b16 a[192:193], v30 offset:28672
    ds_read_b64_tr_b16 a[194:195], v30 offset:29184
    s_waitcnt lgkmcnt(14)
    v_mfma_f32_16x16x32_bf16 v[80:83], a[148:151], v[36:39], v[80:83]
    ds_read_b64_tr_b16 a[196:197], v30 offset:40960
    ds_read_b64_tr_b16 a[198:199], v30 offset:41472
    v_mfma_f32_16x16x32_bf16 v[48:51], a[144:147], a[128:131], v[48:51]
    ds_read_b128 a[176:179], v28 offset:24576
    s_add_u32 s73, s73, 4096
    buffer_load_dwordx4 a[8:11], v1, s[28:31], s73 offen offset:0
    v_mfma_f32_16x16x32_bf16 v[48:51], a[148:151], a[132:135], v[48:51]
    ds_read_b128 a[180:183], v29 offset:24576
    v_mfma_f32_16x16x32_bf16 v[52:55], a[148:151], a[140:143], v[52:55]
    ds_read_b128 a[184:187], v28 offset:26624
    v_mfma_f32_16x16x32_bf16 v[52:55], a[144:147], a[136:139], v[52:55]
    ds_read_b128 a[188:191], v29 offset:26624
    buffer_load_dwordx4 a[12:15], v1, s[28:31], s73 offen offset:1024
    s_waitcnt lgkmcnt(14)
    v_mfma_f32_16x16x32_bf16 v[60:63], a[152:155], a[136:139], v[60:63]
    ds_read_b64_tr_b16 a[200:201], v31 offset:28672
    v_mfma_f32_16x16x32_bf16 v[60:63], a[156:159], a[140:143], v[60:63]
    ds_read_b64_tr_b16 a[202:203], v31 offset:29184
    v_mfma_f32_16x16x32_bf16 v[56:59], a[156:159], a[132:135], v[56:59]
    ds_read_b64_tr_b16 a[204:205], v31 offset:40960
    buffer_load_dwordx4 a[72:75], v1, s[28:31], s73 offen offset:2048
    v_mfma_f32_16x16x32_bf16 v[56:59], a[152:155], a[128:131], v[56:59]
    ds_read_b64_tr_b16 a[206:207], v31 offset:41472
    v_mfma_f32_16x16x32_bf16 v[64:67], a[160:163], a[128:131], v[64:67]
    ds_read_b64_tr_b16 a[208:209], v32 offset:28672
    s_waitcnt lgkmcnt(14)
    v_mfma_f32_16x16x32_bf16 v[64:67], a[164:167], a[132:135], v[64:67]
    ds_read_b64_tr_b16 a[210:211], v32 offset:29184
    buffer_load_dwordx4 a[76:79], v1, s[28:31], s73 offen offset:3072
    v_mfma_f32_16x16x32_bf16 v[68:71], a[164:167], a[140:143], v[68:71]
    ds_read_b64_tr_b16 a[212:213], v32 offset:40960
    v_mfma_f32_16x16x32_bf16 v[68:71], a[160:163], a[136:139], v[68:71]
    ds_read_b64_tr_b16 a[214:215], v32 offset:41472
    v_mfma_f32_16x16x32_bf16 v[76:79], a[168:171], a[136:139], v[76:79]
    ds_read_b64_tr_b16 a[216:217], v33 offset:28672
    s_add_u32 s73, s73, 4096
    buffer_load_dwordx4 a[16:19], v1, s[28:31], s73 offen offset:0
    s_waitcnt lgkmcnt(14)
    v_mfma_f32_16x16x32_bf16 v[76:79], a[172:175], a[140:143], v[76:79]
    ds_read_b64_tr_b16 a[218:219], v33 offset:29184
    v_mfma_f32_16x16x32_bf16 v[72:75], a[172:175], a[132:135], v[72:75]
    ds_read_b64_tr_b16 a[220:221], v33 offset:40960
    v_mfma_f32_16x16x32_bf16 v[72:75], a[168:171], a[128:131], v[72:75]
    ds_read_b64_tr_b16 a[222:223], v33 offset:41472
    buffer_load_dwordx4 a[20:23], v1, s[28:31], s73 offen offset:1024
    v_mfma_f32_16x16x32_bf16 v[80:83], a[192:195], v[36:39], v[80:83]
    s_waitcnt lgkmcnt(14)
    v_mfma_f32_16x16x32_bf16 v[80:83], a[196:199], v[36:39], v[80:83]
    v_mfma_f32_16x16x32_bf16 v[48:51], a[192:195], a[176:179], v[48:51]
    buffer_load_dwordx4 a[80:83], v1, s[28:31], s73 offen offset:2048
    v_mfma_f32_16x16x32_bf16 v[48:51], a[196:199], a[180:183], v[48:51]
    s_waitcnt lgkmcnt(12)
    v_mfma_f32_16x16x32_bf16 v[52:55], a[196:199], a[188:191], v[52:55]
    v_mfma_f32_16x16x32_bf16 v[52:55], a[192:195], a[184:187], v[52:55]
    buffer_load_dwordx4 a[84:87], v1, s[28:31], s73 offen offset:3072
    s_waitcnt lgkmcnt(10)
    v_mfma_f32_16x16x32_bf16 v[60:63], a[200:203], a[184:187], v[60:63]
    s_waitcnt lgkmcnt(8)
    v_mfma_f32_16x16x32_bf16 v[60:63], a[204:207], a[188:191], v[60:63]
    v_mfma_f32_16x16x32_bf16 v[56:59], a[204:207], a[180:183], v[56:59]
    s_add_u32 s73, s73, 4096
    buffer_load_dwordx4 a[24:27], v1, s[28:31], s73 offen offset:0
    v_mfma_f32_16x16x32_bf16 v[56:59], a[200:203], a[176:179], v[56:59]
    s_waitcnt lgkmcnt(6)
    v_mfma_f32_16x16x32_bf16 v[64:67], a[208:211], a[176:179], v[64:67]
    ds_write_b128 v244, v[80:83]
    s_waitcnt lgkmcnt(5)
    v_mfma_f32_16x16x32_bf16 v[64:67], a[212:215], a[180:183], v[64:67]
    v_mfma_f32_16x16x32_bf16 v[68:71], a[212:215], a[188:191], v[68:71]
    v_mfma_f32_16x16x32_bf16 v[68:71], a[208:211], a[184:187], v[68:71]
    s_waitcnt lgkmcnt(3)
    v_mfma_f32_16x16x32_bf16 v[76:79], a[216:219], a[184:187], v[76:79]
    s_waitcnt lgkmcnt(1)
    v_mfma_f32_16x16x32_bf16 v[76:79], a[220:223], a[188:191], v[76:79]
    v_mfma_f32_16x16x32_bf16 v[72:75], a[220:223], a[180:183], v[72:75]
    v_mfma_f32_16x16x32_bf16 v[72:75], a[216:219], a[176:179], v[72:75]
    s_waitcnt lgkmcnt(0)
    s_barrier
    ds_read_b128 v[88:91], v244
    v_xor_b32 v5, 64, v244
    ds_read_b128 v[92:95], v5
    v_xor_b32 v6, 128, v244
    ds_read_b128 v[96:99], v6
    v_xor_b32 v7, 192, v244
    ds_read_b128 v[100:103], v7
    s_waitcnt vmcnt(14)
    v_accvgpr_write_b32 a238, v84
    v_mul_f32 v85, 0x3e8293ee, v85
    s_waitcnt vmcnt(13)
    v_accvgpr_write_b32 a239, v86
    v_mul_f32 v87, 0x3e8293ee, v87
    s_bitcmp1_b32 s52, 0
    s_cselect_b64 vcc, -1, 0
    s_waitcnt lgkmcnt(3)
    v_pk_fma_f32 v[48:49], v[88:89], v[84:85], v[48:49] op_sel_hi:[1,0,1] neg_lo:[0,1,0] neg_hi:[0,1,0]
    v_pk_fma_f32 v[50:51], v[90:91], v[84:85], v[50:51] op_sel_hi:[1,0,1] neg_lo:[0,1,0] neg_hi:[0,1,0]
    v_pk_mul_f32 v[48:49], v[48:49], v[84:85] op_sel:[0,1]
    v_pk_mul_f32 v[50:51], v[50:51], v[84:85] op_sel:[0,1]
    v_cvt_pk_bf16_f32 v112, v48, v49
    v_cvt_pk_bf16_f32 v113, v50, v51
    s_waitcnt lgkmcnt(2)
    v_pk_fma_f32 v[56:57], v[92:93], v[84:85], v[56:57] op_sel_hi:[1,0,1] neg_lo:[0,1,0] neg_hi:[0,1,0]
    v_pk_fma_f32 v[58:59], v[94:95], v[84:85], v[58:59] op_sel_hi:[1,0,1] neg_lo:[0,1,0] neg_hi:[0,1,0]
    v_pk_mul_f32 v[56:57], v[56:57], v[84:85] op_sel:[0,1]
    v_pk_mul_f32 v[58:59], v[58:59], v[84:85] op_sel:[0,1]
    v_cvt_pk_bf16_f32 v114, v56, v57
    v_cvt_pk_bf16_f32 v115, v58, v59
    v_pk_fma_f32 v[52:53], v[88:89], v[86:87], v[52:53] op_sel_hi:[1,0,1] neg_lo:[0,1,0] neg_hi:[0,1,0]
    v_pk_fma_f32 v[54:55], v[90:91], v[86:87], v[54:55] op_sel_hi:[1,0,1] neg_lo:[0,1,0] neg_hi:[0,1,0]
    v_pk_mul_f32 v[52:53], v[52:53], v[86:87] op_sel:[0,1]
    v_pk_mul_f32 v[54:55], v[54:55], v[86:87] op_sel:[0,1]
    v_cvt_pk_bf16_f32 v116, v52, v53
    v_cvt_pk_bf16_f32 v117, v54, v55
    v_pk_fma_f32 v[60:61], v[92:93], v[86:87], v[60:61] op_sel_hi:[1,0,1] neg_lo:[0,1,0] neg_hi:[0,1,0]
    v_pk_fma_f32 v[62:63], v[94:95], v[86:87], v[62:63] op_sel_hi:[1,0,1] neg_lo:[0,1,0] neg_hi:[0,1,0]
    v_pk_mul_f32 v[60:61], v[60:61], v[86:87] op_sel:[0,1]
    v_pk_mul_f32 v[62:63], v[62:63], v[86:87] op_sel:[0,1]
    v_cvt_pk_bf16_f32 v118, v60, v61
    v_cvt_pk_bf16_f32 v119, v62, v63
    v_cndmask_b32 v16, v112, v114, vcc
    v_cndmask_b32 v17, v113, v115, vcc
    v_cndmask_b32 v18, v114, v112, vcc
    v_cndmask_b32 v19, v115, v113, vcc
    v_cndmask_b32 v20, v116, v118, vcc
    v_cndmask_b32 v21, v117, v119, vcc
    v_cndmask_b32 v22, v118, v116, vcc
    v_cndmask_b32 v23, v119, v117, vcc
    v_permlane16_swap_b32 v16, v20
    v_permlane16_swap_b32 v17, v21
    v_permlane16_swap_b32 v18, v22
    v_permlane16_swap_b32 v19, v23
    ds_write_b128 v248, v[16:19] offset:0
    ds_write_b128 v248, v[20:23] offset:1024
    s_waitcnt lgkmcnt(3)
    v_pk_fma_f32 v[64:65], v[96:97], v[84:85], v[64:65] op_sel_hi:[1,0,1] neg_lo:[0,1,0] neg_hi:[0,1,0]
    v_pk_fma_f32 v[66:67], v[98:99], v[84:85], v[66:67] op_sel_hi:[1,0,1] neg_lo:[0,1,0] neg_hi:[0,1,0]
    v_pk_mul_f32 v[64:65], v[64:65], v[84:85] op_sel:[0,1]
    v_pk_mul_f32 v[66:67], v[66:67], v[84:85] op_sel:[0,1]
    v_cvt_pk_bf16_f32 v120, v64, v65
    v_cvt_pk_bf16_f32 v121, v66, v67
    s_waitcnt lgkmcnt(2)
    v_pk_fma_f32 v[72:73], v[100:101], v[84:85], v[72:73] op_sel_hi:[1,0,1] neg_lo:[0,1,0] neg_hi:[0,1,0]
    v_pk_fma_f32 v[74:75], v[102:103], v[84:85], v[74:75] op_sel_hi:[1,0,1] neg_lo:[0,1,0] neg_hi:[0,1,0]
    v_pk_mul_f32 v[72:73], v[72:73], v[84:85] op_sel:[0,1]
    v_pk_mul_f32 v[74:75], v[74:75], v[84:85] op_sel:[0,1]
    v_cvt_pk_bf16_f32 v122, v72, v73
    v_cvt_pk_bf16_f32 v123, v74, v75
    v_pk_fma_f32 v[68:69], v[96:97], v[86:87], v[68:69] op_sel_hi:[1,0,1] neg_lo:[0,1,0] neg_hi:[0,1,0]
    v_pk_fma_f32 v[70:71], v[98:99], v[86:87], v[70:71] op_sel_hi:[1,0,1] neg_lo:[0,1,0] neg_hi:[0,1,0]
    v_pk_mul_f32 v[68:69], v[68:69], v[86:87] op_sel:[0,1]
    v_pk_mul_f32 v[70:71], v[70:71], v[86:87] op_sel:[0,1]
    v_cvt_pk_bf16_f32 v124, v68, v69
    v_cvt_pk_bf16_f32 v125, v70, v71
    v_pk_fma_f32 v[76:77], v[100:101], v[86:87], v[76:77] op_sel_hi:[1,0,1] neg_lo:[0,1,0] neg_hi:[0,1,0]
    v_pk_fma_f32 v[78:79], v[102:103], v[86:87], v[78:79] op_sel_hi:[1,0,1] neg_lo:[0,1,0] neg_hi:[0,1,0]
    v_pk_mul_f32 v[76:77], v[76:77], v[86:87] op_sel:[0,1]
    v_pk_mul_f32 v[78:79], v[78:79], v[86:87] op_sel:[0,1]
    v_cvt_pk_bf16_f32 v126, v76, v77
    v_cvt_pk_bf16_f32 v127, v78, v79
    v_cndmask_b32 v24, v120, v122, vcc
    v_cndmask_b32 v25, v121, v123, vcc
    v_cndmask_b32 v26, v122, v120, vcc
    v_cndmask_b32 v27, v123, v121, vcc
    v_cndmask_b32 v28, v124, v126, vcc
    v_cndmask_b32 v29, v125, v127, vcc
    v_cndmask_b32 v30, v126, v124, vcc
    v_cndmask_b32 v31, v127, v125, vcc
    v_permlane16_swap_b32 v24, v28
    v_permlane16_swap_b32 v25, v29
    v_permlane16_swap_b32 v26, v30
    v_permlane16_swap_b32 v27, v31
    ds_write_b128 v248, v[24:27] offset:2048
    ds_write_b128 v248, v[28:31] offset:3072
    v_pk_mov_b32 v[96:97], 0, 0
    v_pk_mov_b32 v[98:99], 0, 0
    v_pk_mov_b32 v[100:101], 0, 0
    v_pk_mov_b32 v[102:103], 0, 0
    s_waitcnt lgkmcnt(0)
    s_barrier
    ds_read_b128 a[112:115], v249 offset:0
    ds_read_b128 a[116:119], v249 offset:1024
    ds_read_b128 a[120:123], v249 offset:2048
    ds_read_b128 a[124:127], v249 offset:3072
    s_mov_b64 s[40:41], s[16:17]
    s_mov_b32 s42, 7340032
    s_mov_b64 s[0:1], s[16:17]
    s_mov_b64 s[14:15], s[18:19]
    s_mov_b32 s70, 7340032
    s_sub_u32 s68, s68, 262144
    s_mov_b32 s65, 0
    s_add_u32 s32, s26, 0x800000
    s_addc_u32 s33, s27, 0
    s_mov_b32 s34, 0x400000
    s_mov_b32 s35, 0x20000
    s_waitcnt vmcnt(12) lgkmcnt(3)
    v_mfma_f32_32x32x16_bf16 v[64:79], a[0:3], a[112:115], 0
    s_waitcnt vmcnt(11) lgkmcnt(2)
    v_mfma_f32_32x32x16_bf16 v[64:79], a[4:7], a[116:119], v[64:79]
    s_waitcnt lgkmcnt(0)
    s_barrier
    s_mov_b32 s59, 8
    s_lshl_b32 s61, s2, 2
    s_add_u32 s61, s61, s52
    s_lshl_b32 s56, s61, 11
    buffer_load_dwordx4 v[40:43], v1, s[44:47], s56 offen
    buffer_load_dwordx4 v[44:47], v1, s[44:47], s56 offen offset:1024
    s_getpc_b64 s[74:75]
    s_lshr_b32 s56, s2, 3
    s_lshl_b32 s56, s56, 2
    s_add_u32 s56, s56, s52
    s_mul_i32 s56, s56, 384
    s_min_u32 s56, s56, F_end-F_fast_loop
    v_min_u32 v4, 2, v0
    v_lshl_add_u32 v4, v4, 7, s56
    global_load_dword v241, v4, s[74:75]
.p2align 6
F_fast_loop:
    v_mfma_f32_32x32x16_bf16 v[80:95], a[0:3], a[120:123], 0
    v_exp_f32 v64, v64
    v_exp_f32 v65, v65
    v_exp_f32 v66, v66
    v_exp_f32 v67, v67
    v_cvt_pk_bf16_f32 v216, v64, v65
    v_mfma_f32_32x32x16_bf16 v[80:95], a[4:7], a[124:127], v[80:95]
    buffer_load_dword v241, v240, s[40:43], s70 offen
    v_exp_f32 v68, v68
    v_exp_f32 v69, v69
    v_cvt_pk_bf16_f32 v217, v66, v67
    v_exp_f32 v70, v70
    v_exp_f32 v71, v71
    v_mfma_f32_32x32x16_bf16 v[192:207], a[88:91], v[224:227], v[192:207]
    s_add_u32 s70, s70, 1835008
    v_cvt_pk_bf16_f32 v218, v68, v69
    v_exp_f32 v72, v72
    v_exp_f32 v73, v73
    v_cvt_pk_bf16_f32 v219, v70, v71
    v_exp_f32 v74, v74
    v_mfma_f32_32x32x16_bf16 v[192:207], a[92:95], v[228:231], v[192:207]
    s_waitcnt vmcnt(13)
    v_exp_f32 v75, v75
    v_cvt_pk_bf16_f32 v220, v72, v73
    v_exp_f32 v76, v76
    v_exp_f32 v77, v77
    v_cvt_pk_bf16_f32 v221, v74, v75
    v_smfmac_f32_16x16x64_bf16 v[212:215], v[232:235], v[224:231], v252
    buffer_load_dwordx4 a[28:31], v1, s[28:31], s73 offen offset:1024
    v_exp_f32 v78, v78
    v_exp_f32 v79, v79
    v_cvt_pk_bf16_f32 v222, v76, v77
    v_cvt_pk_bf16_f32 v223, v78, v79
    v_mfma_f32_32x32x16_bf16 v[64:79], a[0:3], v[16:19], 0
    v_exp_f32 v80, v80
    v_exp_f32 v81, v81
    v_exp_f32 v82, v82
    v_exp_f32 v83, v83
    v_cvt_pk_bf16_f32 v224, v80, v81
    v_mfma_f32_32x32x16_bf16 v[64:79], a[4:7], v[20:23], v[64:79]
    s_and_b32 m0, s69, 0x1ffff
    v_exp_f32 v84, v84
    v_exp_f32 v85, v85
    v_cvt_pk_bf16_f32 v225, v82, v83
    v_exp_f32 v86, v86
    v_exp_f32 v87, v87
    v_mfma_f32_32x32x16_bf16 v[144:159], a[64:67], v[216:219], v[144:159]
    s_add_u32 s69, s69, 16384
    v_cvt_pk_bf16_f32 v226, v84, v85
    v_exp_f32 v88, v88
    v_exp_f32 v89, v89
    v_cvt_pk_bf16_f32 v227, v86, v87
    v_exp_f32 v90, v90
    v_mfma_f32_32x32x16_bf16 v[144:159], a[68:71], v[220:223], v[144:159]
    v_exp_f32 v91, v91
    v_cvt_pk_bf16_f32 v228, v88, v89
    v_exp_f32 v92, v92
    v_exp_f32 v93, v93
    v_cvt_pk_bf16_f32 v229, v90, v91
    v_smfmac_f32_16x16x64_bf16 v[96:99], v[232:235], v[216:223], v252
    buffer_load_dwordx4 a[88:91], v1, s[28:31], s73 offen offset:2048
    v_exp_f32 v94, v94
    v_exp_f32 v95, v95
    v_cvt_pk_bf16_f32 v230, v92, v93
    v_cvt_pk_bf16_f32 v231, v94, v95
    v_mfma_f32_32x32x16_bf16 v[80:95], a[0:3], v[24:27], 0
    v_exp_f32 v64, v64
    v_exp_f32 v65, v65
    v_exp_f32 v66, v66
    v_exp_f32 v67, v67
    v_cvt_pk_bf16_f32 v216, v64, v65
    v_mfma_f32_32x32x16_bf16 v[80:95], a[4:7], v[28:31], v[80:95]
    s_add_u32 s68, s68, 262144
    v_exp_f32 v68, v68
    v_exp_f32 v69, v69
    v_cvt_pk_bf16_f32 v217, v66, v67
    v_exp_f32 v70, v70
    v_exp_f32 v71, v71
    v_mfma_f32_32x32x16_bf16 v[160:175], a[64:67], v[224:227], v[160:175]
    v_cvt_pk_bf16_f32 v218, v68, v69
    v_exp_f32 v72, v72
    v_exp_f32 v73, v73
    v_cvt_pk_bf16_f32 v219, v70, v71
    v_exp_f32 v74, v74
    v_mfma_f32_32x32x16_bf16 v[160:175], a[68:71], v[228:231], v[160:175]
    s_waitcnt vmcnt(12)
    v_exp_f32 v75, v75
    v_cvt_pk_bf16_f32 v220, v72, v73
    v_exp_f32 v76, v76
    v_exp_f32 v77, v77
    v_cvt_pk_bf16_f32 v221, v74, v75
    v_smfmac_f32_16x16x64_bf16 v[100:103], v[232:235], v[224:231], v252
    buffer_load_dwordx4 a[92:95], v1, s[28:31], s73 offen offset:3072
    v_exp_f32 v78, v78
    v_exp_f32 v79, v79
    v_cvt_pk_bf16_f32 v222, v76, v77
    v_cvt_pk_bf16_f32 v223, v78, v79
    v_mfma_f32_32x32x16_bf16 v[64:79], a[8:11], a[112:115], 0
    s_add_u32 s73, s73, 4096
    v_exp_f32 v80, v80
    v_exp_f32 v81, v81
    v_exp_f32 v82, v82
    v_exp_f32 v83, v83
    v_cvt_pk_bf16_f32 v224, v80, v81
    v_mfma_f32_32x32x16_bf16 v[64:79], a[12:15], a[116:119], v[64:79]
    v_exp_f32 v84, v84
    v_exp_f32 v85, v85
    v_cvt_pk_bf16_f32 v225, v82, v83
    v_exp_f32 v86, v86
    v_exp_f32 v87, v87
    v_mfma_f32_32x32x16_bf16 v[176:191], a[64:67], v[216:219], v[176:191]
    v_cvt_pk_bf16_f32 v226, v84, v85
    v_exp_f32 v88, v88
    v_exp_f32 v89, v89
    v_cvt_pk_bf16_f32 v227, v86, v87
    v_exp_f32 v90, v90
    v_mfma_f32_32x32x16_bf16 v[176:191], a[68:71], v[220:223], v[176:191]
    v_exp_f32 v91, v91
    v_cvt_pk_bf16_f32 v228, v88, v89
    v_exp_f32 v92, v92
    v_exp_f32 v93, v93
    v_cvt_pk_bf16_f32 v229, v90, v91
    v_smfmac_f32_16x16x64_bf16 v[208:211], v[232:235], v[216:223], v252
    buffer_load_dwordx4 a[0:3], v1, s[28:31], s73 offen offset:0
    v_exp_f32 v94, v94
    v_exp_f32 v95, v95
    v_cvt_pk_bf16_f32 v230, v92, v93
    v_cvt_pk_bf16_f32 v231, v94, v95
    v_mfma_f32_32x32x16_bf16 v[80:95], a[8:11], a[120:123], 0
    v_exp_f32 v64, v64
    v_exp_f32 v65, v65
    v_exp_f32 v66, v66
    v_exp_f32 v67, v67
    v_cvt_pk_bf16_f32 v216, v64, v65
    v_mfma_f32_32x32x16_bf16 v[80:95], a[12:15], a[124:127], v[80:95]
    v_exp_f32 v68, v68
    v_exp_f32 v69, v69
    v_cvt_pk_bf16_f32 v217, v66, v67
    v_exp_f32 v70, v70
    v_exp_f32 v71, v71
    v_mfma_f32_32x32x16_bf16 v[192:207], a[64:67], v[224:227], v[192:207]
    v_cvt_pk_bf16_f32 v218, v68, v69
    v_exp_f32 v72, v72
    v_exp_f32 v73, v73
    v_cvt_pk_bf16_f32 v219, v70, v71
    v_exp_f32 v74, v74
    v_mfma_f32_32x32x16_bf16 v[192:207], a[68:71], v[228:231], v[192:207]
    s_waitcnt vmcnt(11)
    v_exp_f32 v75, v75
    v_cvt_pk_bf16_f32 v220, v72, v73
    v_exp_f32 v76, v76
    v_exp_f32 v77, v77
    v_cvt_pk_bf16_f32 v221, v74, v75
    v_smfmac_f32_16x16x64_bf16 v[212:215], v[232:235], v[224:231], v252
    buffer_load_dwordx4 a[4:7], v1, s[28:31], s73 offen offset:1024
    v_exp_f32 v78, v78
    v_exp_f32 v79, v79
    v_cvt_pk_bf16_f32 v222, v76, v77
    v_cvt_pk_bf16_f32 v223, v78, v79
    v_mfma_f32_32x32x16_bf16 v[64:79], a[8:11], v[16:19], 0
    v_exp_f32 v80, v80
    v_exp_f32 v81, v81
    v_exp_f32 v82, v82
    v_exp_f32 v83, v83
    v_cvt_pk_bf16_f32 v224, v80, v81
    v_mfma_f32_32x32x16_bf16 v[64:79], a[12:15], v[20:23], v[64:79]
    buffer_load_dwordx4 v236, s[44:47], s68 offen offset:0 lds
    v_exp_f32 v84, v84
    v_exp_f32 v85, v85
    v_cvt_pk_bf16_f32 v225, v82, v83
    v_exp_f32 v86, v86
    v_exp_f32 v87, v87
    v_mfma_f32_32x32x16_bf16 v[144:159], a[72:75], v[216:219], v[144:159]
    v_cvt_pk_bf16_f32 v226, v84, v85
    v_exp_f32 v88, v88
    v_exp_f32 v89, v89
    v_cvt_pk_bf16_f32 v227, v86, v87
    v_exp_f32 v90, v90
    v_mfma_f32_32x32x16_bf16 v[144:159], a[76:79], v[220:223], v[144:159]
    v_exp_f32 v91, v91
    v_cvt_pk_bf16_f32 v228, v88, v89
    v_exp_f32 v92, v92
    v_exp_f32 v93, v93
    v_cvt_pk_bf16_f32 v229, v90, v91
    v_smfmac_f32_16x16x64_bf16 v[96:99], v[232:235], v[216:223], v252
    buffer_load_dwordx4 a[64:67], v1, s[28:31], s73 offen offset:2048
    v_exp_f32 v94, v94
    v_exp_f32 v95, v95
    v_cvt_pk_bf16_f32 v230, v92, v93
    v_cvt_pk_bf16_f32 v231, v94, v95
    v_mfma_f32_32x32x16_bf16 v[80:95], a[8:11], v[24:27], 0
    v_exp_f32 v64, v64
    v_exp_f32 v65, v65
    v_exp_f32 v66, v66
    v_exp_f32 v67, v67
    v_cvt_pk_bf16_f32 v216, v64, v65
    v_mfma_f32_32x32x16_bf16 v[80:95], a[12:15], v[28:31], v[80:95]
    v_exp_f32 v68, v68
    v_exp_f32 v69, v69
    v_cvt_pk_bf16_f32 v217, v66, v67
    v_exp_f32 v70, v70
    v_exp_f32 v71, v71
    v_mfma_f32_32x32x16_bf16 v[160:175], a[72:75], v[224:227], v[160:175]
    v_cvt_pk_bf16_f32 v218, v68, v69
    v_exp_f32 v72, v72
    v_exp_f32 v73, v73
    v_cvt_pk_bf16_f32 v219, v70, v71
    v_exp_f32 v74, v74
    v_mfma_f32_32x32x16_bf16 v[160:175], a[76:79], v[228:231], v[160:175]
    s_waitcnt vmcnt(11)
    v_exp_f32 v75, v75
    v_cvt_pk_bf16_f32 v220, v72, v73
    v_exp_f32 v76, v76
    v_exp_f32 v77, v77
    v_cvt_pk_bf16_f32 v221, v74, v75
    v_smfmac_f32_16x16x64_bf16 v[100:103], v[232:235], v[224:231], v252
    buffer_load_dwordx4 a[68:71], v1, s[28:31], s73 offen offset:3072
    v_exp_f32 v78, v78
    v_exp_f32 v79, v79
    v_cvt_pk_bf16_f32 v222, v76, v77
    v_cvt_pk_bf16_f32 v223, v78, v79
    v_mfma_f32_32x32x16_bf16 v[64:79], a[16:19], a[112:115], 0
    s_add_u32 s73, s73, 4096
    v_exp_f32 v80, v80
    v_exp_f32 v81, v81
    v_exp_f32 v82, v82
    v_exp_f32 v83, v83
    v_cvt_pk_bf16_f32 v224, v80, v81
    v_mfma_f32_32x32x16_bf16 v[64:79], a[20:23], a[116:119], v[64:79]
    buffer_load_dwordx4 v237, s[44:47], s68 offen offset:1024 lds
    v_exp_f32 v84, v84
    v_exp_f32 v85, v85
    v_cvt_pk_bf16_f32 v225, v82, v83
    v_exp_f32 v86, v86
    v_exp_f32 v87, v87
    v_mfma_f32_32x32x16_bf16 v[176:191], a[72:75], v[216:219], v[176:191]
    v_cvt_pk_bf16_f32 v226, v84, v85
    v_exp_f32 v88, v88
    v_exp_f32 v89, v89
    v_cvt_pk_bf16_f32 v227, v86, v87
    v_exp_f32 v90, v90
    v_mfma_f32_32x32x16_bf16 v[176:191], a[76:79], v[220:223], v[176:191]
    v_exp_f32 v91, v91
    v_cvt_pk_bf16_f32 v228, v88, v89
    v_exp_f32 v92, v92
    v_exp_f32 v93, v93
    v_cvt_pk_bf16_f32 v229, v90, v91
    v_smfmac_f32_16x16x64_bf16 v[208:211], v[232:235], v[216:223], v252
    buffer_load_dwordx4 a[8:11], v1, s[28:31], s73 offen offset:0
    v_exp_f32 v94, v94
    v_exp_f32 v95, v95
    v_cvt_pk_bf16_f32 v230, v92, v93
    v_cvt_pk_bf16_f32 v231, v94, v95
    v_mfma_f32_32x32x16_bf16 v[80:95], a[16:19], a[120:123], 0
    v_exp_f32 v64, v64
    v_exp_f32 v65, v65
    v_exp_f32 v66, v66
    v_exp_f32 v67, v67
    v_cvt_pk_bf16_f32 v216, v64, v65
    v_mfma_f32_32x32x16_bf16 v[80:95], a[20:23], a[124:127], v[80:95]
    buffer_load_dword v241, v240, s[40:43], s70 offen
    v_exp_f32 v68, v68
    v_exp_f32 v69, v69
    v_cvt_pk_bf16_f32 v217, v66, v67
    v_exp_f32 v70, v70
    v_exp_f32 v71, v71
    v_mfma_f32_32x32x16_bf16 v[192:207], a[72:75], v[224:227], v[192:207]
    s_add_u32 s70, s70, 1835008
    v_cvt_pk_bf16_f32 v218, v68, v69
    v_exp_f32 v72, v72
    v_exp_f32 v73, v73
    v_cvt_pk_bf16_f32 v219, v70, v71
    v_exp_f32 v74, v74
    v_mfma_f32_32x32x16_bf16 v[192:207], a[76:79], v[228:231], v[192:207]
    s_waitcnt vmcnt(13)
    v_exp_f32 v75, v75
    v_cvt_pk_bf16_f32 v220, v72, v73
    v_exp_f32 v76, v76
    v_exp_f32 v77, v77
    v_cvt_pk_bf16_f32 v221, v74, v75
    v_smfmac_f32_16x16x64_bf16 v[212:215], v[232:235], v[224:231], v252
    buffer_load_dwordx4 a[12:15], v1, s[28:31], s73 offen offset:1024
    v_exp_f32 v78, v78
    v_exp_f32 v79, v79
    v_cvt_pk_bf16_f32 v222, v76, v77
    v_cvt_pk_bf16_f32 v223, v78, v79
    v_mfma_f32_32x32x16_bf16 v[64:79], a[16:19], v[16:19], 0
    v_exp_f32 v80, v80
    v_exp_f32 v81, v81
    v_exp_f32 v82, v82
    v_exp_f32 v83, v83
    v_cvt_pk_bf16_f32 v224, v80, v81
    v_mfma_f32_32x32x16_bf16 v[64:79], a[20:23], v[20:23], v[64:79]
    buffer_load_dwordx4 v238, s[44:47], s68 offen offset:2048 lds
    v_exp_f32 v84, v84
    v_exp_f32 v85, v85
    v_cvt_pk_bf16_f32 v225, v82, v83
    v_exp_f32 v86, v86
    v_exp_f32 v87, v87
    v_mfma_f32_32x32x16_bf16 v[144:159], a[80:83], v[216:219], v[144:159]
    v_cvt_pk_bf16_f32 v226, v84, v85
    v_exp_f32 v88, v88
    v_exp_f32 v89, v89
    v_cvt_pk_bf16_f32 v227, v86, v87
    v_exp_f32 v90, v90
    v_mfma_f32_32x32x16_bf16 v[144:159], a[84:87], v[220:223], v[144:159]
    v_exp_f32 v91, v91
    v_cvt_pk_bf16_f32 v228, v88, v89
    v_exp_f32 v92, v92
    v_exp_f32 v93, v93
    v_cvt_pk_bf16_f32 v229, v90, v91
    v_smfmac_f32_16x16x64_bf16 v[96:99], v[232:235], v[216:223], v252
    buffer_load_dwordx4 a[72:75], v1, s[28:31], s73 offen offset:2048
    v_exp_f32 v94, v94
    v_exp_f32 v95, v95
    v_cvt_pk_bf16_f32 v230, v92, v93
    v_cvt_pk_bf16_f32 v231, v94, v95
    v_mfma_f32_32x32x16_bf16 v[80:95], a[16:19], v[24:27], 0
    v_exp_f32 v64, v64
    v_exp_f32 v65, v65
    v_exp_f32 v66, v66
    v_exp_f32 v67, v67
    v_cvt_pk_bf16_f32 v216, v64, v65
    v_mfma_f32_32x32x16_bf16 v[80:95], a[20:23], v[28:31], v[80:95]
    v_exp_f32 v68, v68
    v_exp_f32 v69, v69
    v_cvt_pk_bf16_f32 v217, v66, v67
    v_exp_f32 v70, v70
    v_exp_f32 v71, v71
    v_mfma_f32_32x32x16_bf16 v[160:175], a[80:83], v[224:227], v[160:175]
    v_cvt_pk_bf16_f32 v218, v68, v69
    v_exp_f32 v72, v72
    v_exp_f32 v73, v73
    v_cvt_pk_bf16_f32 v219, v70, v71
    v_exp_f32 v74, v74
    v_mfma_f32_32x32x16_bf16 v[160:175], a[84:87], v[228:231], v[160:175]
    s_waitcnt vmcnt(13)
    v_exp_f32 v75, v75
    v_cvt_pk_bf16_f32 v220, v72, v73
    v_exp_f32 v76, v76
    v_exp_f32 v77, v77
    v_cvt_pk_bf16_f32 v221, v74, v75
    v_smfmac_f32_16x16x64_bf16 v[100:103], v[232:235], v[224:231], v252
    buffer_load_dwordx4 a[76:79], v1, s[28:31], s73 offen offset:3072
    v_exp_f32 v78, v78
    v_exp_f32 v79, v79
    v_cvt_pk_bf16_f32 v222, v76, v77
    v_cvt_pk_bf16_f32 v223, v78, v79
    v_mfma_f32_32x32x16_bf16 v[64:79], a[24:27], a[112:115], 0
    s_add_u32 s73, s73, 4096
    v_exp_f32 v80, v80
    v_exp_f32 v81, v81
    v_exp_f32 v82, v82
    v_exp_f32 v83, v83
    v_cvt_pk_bf16_f32 v224, v80, v81
    v_mfma_f32_32x32x16_bf16 v[64:79], a[28:31], a[116:119], v[64:79]
    buffer_load_dwordx4 v239, s[44:47], s68 offen offset:3072 lds
    v_exp_f32 v84, v84
    v_exp_f32 v85, v85
    v_cvt_pk_bf16_f32 v225, v82, v83
    v_exp_f32 v86, v86
    v_exp_f32 v87, v87
    v_mfma_f32_32x32x16_bf16 v[176:191], a[80:83], v[216:219], v[176:191]
    s_cmp_eq_u32 s59, 1
    v_cvt_pk_bf16_f32 v226, v84, v85
    v_exp_f32 v88, v88
    v_exp_f32 v89, v89
    v_cvt_pk_bf16_f32 v227, v86, v87
    v_exp_f32 v90, v90
    v_mfma_f32_32x32x16_bf16 v[176:191], a[84:87], v[220:223], v[176:191]
    v_exp_f32 v91, v91
    v_cvt_pk_bf16_f32 v228, v88, v89
    v_exp_f32 v92, v92
    v_exp_f32 v93, v93
    v_cvt_pk_bf16_f32 v229, v90, v91
    v_smfmac_f32_16x16x64_bf16 v[208:211], v[232:235], v[216:223], v252
    buffer_load_dwordx4 a[16:19], v1, s[28:31], s73 offen offset:0
    v_exp_f32 v94, v94
    v_exp_f32 v95, v95
    v_cvt_pk_bf16_f32 v230, v92, v93
    v_cvt_pk_bf16_f32 v231, v94, v95
    s_cbranch_scc1 F_fast_last
    v_mfma_f32_32x32x16_bf16 v[80:95], a[24:27], a[120:123], 0
    s_bitcmp1_b32 0x150, s59
    v_exp_f32 v64, v64
    v_exp_f32 v65, v65
    v_exp_f32 v66, v66
    v_exp_f32 v67, v67
    v_cvt_pk_bf16_f32 v216, v64, v65
    v_mfma_f32_32x32x16_bf16 v[80:95], a[28:31], a[124:127], v[80:95]
    s_cselect_b32 s70, s71, s70
    v_exp_f32 v68, v68
    v_exp_f32 v69, v69
    v_cvt_pk_bf16_f32 v217, v66, v67
    v_exp_f32 v70, v70
    v_exp_f32 v71, v71
    v_mfma_f32_32x32x16_bf16 v[192:207], a[80:83], v[224:227], v[192:207]
    s_cselect_b64 s[40:41], s[0:1], s[40:41]
    v_cvt_pk_bf16_f32 v218, v68, v69
    v_exp_f32 v72, v72
    v_exp_f32 v73, v73
    v_cvt_pk_bf16_f32 v219, v70, v71
    v_exp_f32 v74, v74
    v_mfma_f32_32x32x16_bf16 v[192:207], a[84:87], v[228:231], v[192:207]
    s_waitcnt vmcnt(14)
    v_exp_f32 v75, v75
    v_cvt_pk_bf16_f32 v220, v72, v73
    v_exp_f32 v76, v76
    v_exp_f32 v77, v77
    v_cvt_pk_bf16_f32 v221, v74, v75
    v_smfmac_f32_16x16x64_bf16 v[212:215], v[232:235], v[224:231], v252
    buffer_load_dwordx4 a[20:23], v1, s[28:31], s73 offen offset:1024
    v_exp_f32 v78, v78
    v_exp_f32 v79, v79
    v_cvt_pk_bf16_f32 v222, v76, v77
    v_cvt_pk_bf16_f32 v223, v78, v79
    v_mfma_f32_32x32x16_bf16 v[64:79], a[24:27], v[16:19], 0
    s_cselect_b64 s[0:1], s[14:15], s[0:1]
    v_exp_f32 v80, v80
    v_exp_f32 v81, v81
    v_exp_f32 v82, v82
    v_exp_f32 v83, v83
    v_cvt_pk_bf16_f32 v224, v80, v81
    v_mfma_f32_32x32x16_bf16 v[64:79], a[28:31], v[20:23], v[64:79]
    s_cselect_b64 s[14:15], s[20:21], s[14:15]
    v_exp_f32 v84, v84
    v_exp_f32 v85, v85
    v_cvt_pk_bf16_f32 v225, v82, v83
    v_exp_f32 v86, v86
    v_exp_f32 v87, v87
    v_mfma_f32_32x32x16_bf16 v[144:159], a[88:91], v[216:219], v[144:159]
    v_cvt_pk_bf16_f32 v226, v84, v85
    v_exp_f32 v88, v88
    v_exp_f32 v89, v89
    v_cvt_pk_bf16_f32 v227, v86, v87
    v_exp_f32 v90, v90
    v_mfma_f32_32x32x16_bf16 v[144:159], a[92:95], v[220:223], v[144:159]
    v_exp_f32 v91, v91
    v_cvt_pk_bf16_f32 v228, v88, v89
    v_exp_f32 v92, v92
    v_exp_f32 v93, v93
    v_cvt_pk_bf16_f32 v229, v90, v91
    v_smfmac_f32_16x16x64_bf16 v[96:99], v[232:235], v[216:223], v252
    buffer_load_dwordx4 a[80:83], v1, s[28:31], s73 offen offset:2048
    v_exp_f32 v94, v94
    v_exp_f32 v95, v95
    v_cvt_pk_bf16_f32 v230, v92, v93
    v_cvt_pk_bf16_f32 v231, v94, v95
    v_mfma_f32_32x32x16_bf16 v[80:95], a[24:27], v[24:27], 0
    v_exp_f32 v64, v64
    v_exp_f32 v65, v65
    v_exp_f32 v66, v66
    v_exp_f32 v67, v67
    v_cvt_pk_bf16_f32 v216, v64, v65
    v_mfma_f32_32x32x16_bf16 v[80:95], a[28:31], v[28:31], v[80:95]
    s_bitcmp1_b32 0x104, s59
    v_exp_f32 v68, v68
    v_exp_f32 v69, v69
    v_cvt_pk_bf16_f32 v217, v66, v67
    v_exp_f32 v70, v70
    v_exp_f32 v71, v71
    v_mfma_f32_32x32x16_bf16 v[160:175], a[88:91], v[224:227], v[160:175]
    s_cbranch_scc1 F_rsx
F_rsxback:
    v_cvt_pk_bf16_f32 v218, v68, v69
    v_exp_f32 v72, v72
    v_exp_f32 v73, v73
    v_cvt_pk_bf16_f32 v219, v70, v71
    v_exp_f32 v74, v74
    v_mfma_f32_32x32x16_bf16 v[160:175], a[92:95], v[228:231], v[160:175]
    s_waitcnt vmcnt(14)
    v_exp_f32 v75, v75
    v_cvt_pk_bf16_f32 v220, v72, v73
    v_exp_f32 v76, v76
    v_exp_f32 v77, v77
    v_cvt_pk_bf16_f32 v221, v74, v75
    v_smfmac_f32_16x16x64_bf16 v[100:103], v[232:235], v[224:231], v252
    buffer_load_dwordx4 a[84:87], v1, s[28:31], s73 offen offset:3072
    v_exp_f32 v78, v78
    v_exp_f32 v79, v79
    v_cvt_pk_bf16_f32 v222, v76, v77
    v_cvt_pk_bf16_f32 v223, v78, v79
    v_mfma_f32_32x32x16_bf16 v[64:79], a[0:3], a[112:115], 0
    s_add_u32 s73, s73, 4096
    v_exp_f32 v80, v80
    v_exp_f32 v81, v81
    v_exp_f32 v82, v82
    v_exp_f32 v83, v83
    v_cvt_pk_bf16_f32 v224, v80, v81
    v_mfma_f32_32x32x16_bf16 v[64:79], a[4:7], a[116:119], v[64:79]
    s_sub_u32 s59, s59, 1
    v_exp_f32 v84, v84
    v_exp_f32 v85, v85
    v_cvt_pk_bf16_f32 v225, v82, v83
    v_exp_f32 v86, v86
    v_exp_f32 v87, v87
    v_mfma_f32_32x32x16_bf16 v[176:191], a[88:91], v[216:219], v[176:191]
    v_cvt_pk_bf16_f32 v226, v84, v85
    v_exp_f32 v88, v88
    v_exp_f32 v89, v89
    v_cvt_pk_bf16_f32 v227, v86, v87
    v_exp_f32 v90, v90
    v_mfma_f32_32x32x16_bf16 v[176:191], a[92:95], v[220:223], v[176:191]
    v_exp_f32 v91, v91
    v_cvt_pk_bf16_f32 v228, v88, v89
    v_exp_f32 v92, v92
    v_exp_f32 v93, v93
    v_cvt_pk_bf16_f32 v229, v90, v91
    v_smfmac_f32_16x16x64_bf16 v[208:211], v[232:235], v[216:223], v252
    buffer_load_dwordx4 a[24:27], v1, s[28:31], s73 offen offset:0
    v_exp_f32 v94, v94
    v_exp_f32 v95, v95
    v_cvt_pk_bf16_f32 v230, v92, v93
    v_cvt_pk_bf16_f32 v231, v94, v95
    s_branch F_fast_loop
F_fast_last:
    v_mfma_f32_32x32x16_bf16 v[80:95], a[24:27], a[120:123], 0
    ds_read_b64 v[40:41], v250 offset:0
    ds_read_b64 v[56:57], v250 offset:2048
    v_exp_f32 v64, v64
    v_exp_f32 v65, v65
    v_exp_f32 v66, v66
    v_exp_f32 v67, v67
    v_cvt_pk_bf16_f32 v216, v64, v65
    v_mfma_f32_32x32x16_bf16 v[80:95], a[28:31], a[124:127], v[80:95]
    ds_read_b64 v[42:43], v49 offset:0
    ds_read_b64 v[58:59], v49 offset:2048
    v_exp_f32 v68, v68
    v_exp_f32 v69, v69
    v_cvt_pk_bf16_f32 v217, v66, v67
    v_exp_f32 v70, v70
    v_exp_f32 v71, v71
    v_mfma_f32_32x32x16_bf16 v[192:207], a[80:83], v[224:227], v[192:207]
    ds_read_b64 v[44:45], v50 offset:0
    ds_read_b64 v[60:61], v50 offset:2048
    v_cvt_pk_bf16_f32 v218, v68, v69
    v_exp_f32 v72, v72
    v_exp_f32 v73, v73
    v_cvt_pk_bf16_f32 v219, v70, v71
    v_exp_f32 v74, v74
    v_mfma_f32_32x32x16_bf16 v[192:207], a[84:87], v[228:231], v[192:207]
    s_waitcnt vmcnt(14)
    ds_read_b64 v[46:47], v51 offset:0
    ds_read_b64 v[62:63], v51 offset:2048
    v_exp_f32 v75, v75
    v_cvt_pk_bf16_f32 v220, v72, v73
    v_exp_f32 v76, v76
    v_exp_f32 v77, v77
    v_cvt_pk_bf16_f32 v221, v74, v75
    v_smfmac_f32_16x16x64_bf16 v[212:215], v[232:235], v[224:231], v252
    v_cmp_ne_u32 vcc, 1, v53
    s_nop 0
    s_cbranch_vccnz F_rspoll
F_rsgo:
    ds_write_b32 v48, v52
    v_exp_f32 v78, v78
    v_exp_f32 v79, v79
    v_cvt_pk_bf16_f32 v222, v76, v77
    v_cvt_pk_bf16_f32 v223, v78, v79
    v_mfma_f32_32x32x16_bf16 v[64:79], a[24:27], v[16:19], 0
    ds_read_b128 v[112:115], v247 offset:0
    v_exp_f32 v80, v80
    v_exp_f32 v81, v81
    v_exp_f32 v82, v82
    v_exp_f32 v83, v83
    v_cvt_pk_bf16_f32 v224, v80, v81
    v_mfma_f32_32x32x16_bf16 v[64:79], a[28:31], v[20:23], v[64:79]
    ds_read_b128 v[116:119], v247 offset:32
    ds_read_b128 v[120:123], v247 offset:64
    v_exp_f32 v84, v84
    v_exp_f32 v85, v85
    v_cvt_pk_bf16_f32 v225, v82, v83
    v_exp_f32 v86, v86
    v_exp_f32 v87, v87
    v_mfma_f32_32x32x16_bf16 v[144:159], a[88:91], v[216:219], v[144:159]
    ds_read_b128 v[124:127], v247 offset:96
    v_cvt_pk_bf16_f32 v226, v84, v85
    v_exp_f32 v88, v88
    v_exp_f32 v89, v89
    v_cvt_pk_bf16_f32 v227, v86, v87
    v_exp_f32 v90, v90
    v_mfma_f32_32x32x16_bf16 v[144:159], a[92:95], v[220:223], v[144:159]
    ds_read_b128 v[128:131], v55 offset:0
    ds_read_b128 v[132:135], v55 offset:32
    v_exp_f32 v91, v91
    v_cvt_pk_bf16_f32 v228, v88, v89
    v_exp_f32 v92, v92
    v_exp_f32 v93, v93
    v_cvt_pk_bf16_f32 v229, v90, v91
    v_smfmac_f32_16x16x64_bf16 v[96:99], v[232:235], v[216:223], v252
    ds_read_b128 v[136:139], v55 offset:64
    ds_read_b128 v[140:143], v55 offset:96
    v_exp_f32 v94, v94
    v_exp_f32 v95, v95
    v_cvt_pk_bf16_f32 v230, v92, v93
    v_cvt_pk_bf16_f32 v231, v94, v95
    v_mfma_f32_32x32x16_bf16 v[80:95], a[24:27], v[24:27], 0
    v_exp_f32 v64, v64
    v_exp_f32 v65, v65
    v_exp_f32 v66, v66
    v_exp_f32 v67, v67
    v_cvt_pk_bf16_f32 v216, v64, v65
    v_mfma_f32_32x32x16_bf16 v[80:95], a[28:31], v[28:31], v[80:95]
    ds_write_b128 v248, v[144:147] offset:0
    v_exp_f32 v68, v68
    v_exp_f32 v69, v69
    v_cvt_pk_bf16_f32 v217, v66, v67
    v_exp_f32 v70, v70
    v_exp_f32 v71, v71
    v_mfma_f32_32x32x16_bf16 v[160:175], a[88:91], v[224:227], v[160:175]
    ds_write_b128 v248, v[148:151] offset:1024
    v_cvt_pk_bf16_f32 v218, v68, v69
    v_exp_f32 v72, v72
    v_exp_f32 v73, v73
    v_cvt_pk_bf16_f32 v219, v70, v71
    v_exp_f32 v74, v74
    v_mfma_f32_32x32x16_bf16 v[160:175], a[92:95], v[228:231], v[160:175]
    ds_write_b128 v248, v[152:155] offset:2048
    v_exp_f32 v75, v75
    v_cvt_pk_bf16_f32 v220, v72, v73
    v_exp_f32 v76, v76
    v_exp_f32 v77, v77
    v_cvt_pk_bf16_f32 v221, v74, v75
    v_smfmac_f32_16x16x64_bf16 v[100:103], v[232:235], v[224:231], v252
    ds_write_b128 v248, v[156:159] offset:3072
    v_exp_f32 v78, v78
    v_exp_f32 v79, v79
    v_cvt_pk_bf16_f32 v222, v76, v77
    v_cvt_pk_bf16_f32 v223, v78, v79
    v_exp_f32 v80, v80
    v_exp_f32 v81, v81
    v_exp_f32 v82, v82
    v_exp_f32 v83, v83
    v_cvt_pk_bf16_f32 v224, v80, v81
    v_exp_f32 v84, v84
    v_exp_f32 v85, v85
    v_cvt_pk_bf16_f32 v225, v82, v83
    v_exp_f32 v86, v86
    v_exp_f32 v87, v87
    v_mfma_f32_32x32x16_bf16 v[176:191], a[88:91], v[216:219], v[176:191]
    ds_write_b128 v248, v[160:163] offset:4096
    ds_write_b128 v248, v[164:167] offset:5120
    v_cvt_pk_bf16_f32 v226, v84, v85
    v_exp_f32 v88, v88
    v_exp_f32 v89, v89
    v_cvt_pk_bf16_f32 v227, v86, v87
    v_exp_f32 v90, v90
    v_mfma_f32_32x32x16_bf16 v[176:191], a[92:95], v[220:223], v[176:191]
    ds_write_b128 v248, v[168:171] offset:6144
    v_add_f32 v96, v96, v97
    v_add_f32 v100, v100, v101
    v_cvt_pk_bf16_f32 v174, v174, v175
    v_exp_f32 v91, v91
    v_cvt_pk_bf16_f32 v228, v88, v89
    v_exp_f32 v92, v92
    v_exp_f32 v93, v93
    v_cvt_pk_bf16_f32 v229, v90, v91
    v_smfmac_f32_16x16x64_bf16 v[208:211], v[232:235], v[216:223], v252
    v_permlane32_swap_b32 v96, v100
    v_mov_b32 v175, v96
    ds_write_b128 v248, v[172:175] offset:7168
    v_exp_f32 v94, v94
    v_exp_f32 v95, v95
    v_cvt_pk_bf16_f32 v230, v92, v93
    v_cvt_pk_bf16_f32 v231, v94, v95
    v_mfma_f32_32x32x16_bf16 v[192:207], a[88:91], v[224:227], v[192:207]
    s_nop 0
    v_mfma_f32_32x32x16_bf16 v[192:207], a[92:95], v[228:231], v[192:207]
    v_smfmac_f32_16x16x64_bf16 v[212:215], v[232:235], v[224:231], v252
    s_waitcnt lgkmcnt(0)
    s_waitcnt vmcnt(1)
    s_barrier
    ds_read_b128 v[172:175], v249 offset:7168
    ds_read_b128 v[144:147], v249 offset:0
    ds_read_b128 v[148:151], v249 offset:1024
    ds_read_b128 v[152:155], v249 offset:2048
    ds_read_b128 v[156:159], v249 offset:3072
    ds_read_b128 v[160:163], v249 offset:4096
    ds_read_b128 v[164:167], v249 offset:5120
    ds_read_b128 v[168:171], v249 offset:6144
    s_waitcnt lgkmcnt(7)
    v_mov_b32 v4, v175
    v_mov_b32 v5, v175
    v_and_b32 v175, 0xffff0000, v174
    v_lshlrev_b32 v174, 16, v174
    v_permlane32_swap_b32 v4, v5
    v_add_f32 v208, v208, v4
    v_add_f32 v212, v212, v5
    s_waitcnt lgkmcnt(6)
    v_pk_add_f32 v[176:177], v[176:177], v[144:145]
    v_pk_add_f32 v[178:179], v[178:179], v[146:147]
    s_waitcnt lgkmcnt(5)
    v_pk_add_f32 v[180:181], v[180:181], v[148:149]
    v_pk_add_f32 v[182:183], v[182:183], v[150:151]
    s_waitcnt lgkmcnt(4)
    v_pk_add_f32 v[184:185], v[184:185], v[152:153]
    v_pk_add_f32 v[186:187], v[186:187], v[154:155]
    s_waitcnt lgkmcnt(3)
    v_pk_add_f32 v[188:189], v[188:189], v[156:157]
    v_pk_add_f32 v[190:191], v[190:191], v[158:159]
    s_waitcnt lgkmcnt(2)
    v_pk_add_f32 v[192:193], v[192:193], v[160:161]
    v_pk_add_f32 v[194:195], v[194:195], v[162:163]
    s_waitcnt lgkmcnt(1)
    v_pk_add_f32 v[196:197], v[196:197], v[164:165]
    v_pk_add_f32 v[198:199], v[198:199], v[166:167]
    s_waitcnt lgkmcnt(0)
    v_pk_add_f32 v[200:201], v[200:201], v[168:169]
    v_pk_add_f32 v[202:203], v[202:203], v[170:171]
    v_pk_add_f32 v[204:205], v[204:205], v[172:173]
    v_pk_add_f32 v[206:207], v[206:207], v[174:175]
F_fin:
    v_add_f32 v208, v208, v209
    v_rcp_f32 v210, v208
    s_lshl_b32 s56, s55, 1
    s_add_u32 s56, s56, s67
    s_lshl_b32 s56, s56, 10
    s_xor_b32 s57, s56, 1024
    v_pk_mul_f32 v[176:177], v[176:177], v[210:211] op_sel_hi:[1,0]
    v_pk_mul_f32 v[178:179], v[178:179], v[210:211] op_sel_hi:[1,0]
    v_pk_mul_f32 v[180:181], v[180:181], v[210:211] op_sel_hi:[1,0]
    v_pk_mul_f32 v[182:183], v[182:183], v[210:211] op_sel_hi:[1,0]
    v_cvt_pk_bf16_f32 v216, v176, v177
    v_cvt_pk_bf16_f32 v217, v178, v179
    v_cvt_pk_bf16_f32 v218, v180, v181
    v_cvt_pk_bf16_f32 v219, v182, v183
    buffer_store_dwordx4 v[216:219], v242, s[32:35], s56 offen offset:0 sc1
    v_pk_mul_f32 v[184:185], v[184:185], v[210:211] op_sel_hi:[1,0]
    v_pk_mul_f32 v[186:187], v[186:187], v[210:211] op_sel_hi:[1,0]
    v_pk_mul_f32 v[188:189], v[188:189], v[210:211] op_sel_hi:[1,0]
    v_pk_mul_f32 v[190:191], v[190:191], v[210:211] op_sel_hi:[1,0]
    v_cvt_pk_bf16_f32 v220, v184, v185
    v_cvt_pk_bf16_f32 v221, v186, v187
    v_cvt_pk_bf16_f32 v222, v188, v189
    v_cvt_pk_bf16_f32 v223, v190, v191
    buffer_store_dwordx4 v[220:223], v242, s[32:35], s56 offen offset:512 sc1
    v_add_f32 v212, v212, v213
    v_rcp_f32 v214, v212
    s_nop 0
    v_pk_mul_f32 v[192:193], v[192:193], v[214:215] op_sel_hi:[1,0]
    v_pk_mul_f32 v[194:195], v[194:195], v[214:215] op_sel_hi:[1,0]
    v_pk_mul_f32 v[196:197], v[196:197], v[214:215] op_sel_hi:[1,0]
    v_pk_mul_f32 v[198:199], v[198:199], v[214:215] op_sel_hi:[1,0]
    v_cvt_pk_bf16_f32 v224, v192, v193
    v_cvt_pk_bf16_f32 v225, v194, v195
    v_cvt_pk_bf16_f32 v226, v196, v197
    v_cvt_pk_bf16_f32 v227, v198, v199
    buffer_store_dwordx4 v[224:227], v242, s[32:35], s57 offen offset:0 sc1
    v_pk_mul_f32 v[200:201], v[200:201], v[214:215] op_sel_hi:[1,0]
    v_pk_mul_f32 v[202:203], v[202:203], v[214:215] op_sel_hi:[1,0]
    v_pk_mul_f32 v[204:205], v[204:205], v[214:215] op_sel_hi:[1,0]
    v_pk_mul_f32 v[206:207], v[206:207], v[214:215] op_sel_hi:[1,0]
    v_cvt_pk_bf16_f32 v228, v200, v201
    v_cvt_pk_bf16_f32 v229, v202, v203
    v_cvt_pk_bf16_f32 v230, v204, v205
    v_cvt_pk_bf16_f32 v231, v206, v207
    buffer_store_dwordx4 v[228:231], v242, s[32:35], s57 offen offset:512 sc1
    v_pk_mul_f32 v[6:7], v[176:177], v[112:113]
    v_pk_mul_f32 v[8:9], v[178:179], v[114:115]
    v_pk_fma_f32 v[6:7], v[180:181], v[116:117], v[6:7]
    v_pk_fma_f32 v[8:9], v[182:183], v[118:119], v[8:9]
    v_pk_fma_f32 v[6:7], v[184:185], v[120:121], v[6:7]
    v_pk_fma_f32 v[8:9], v[186:187], v[122:123], v[8:9]
    v_pk_fma_f32 v[6:7], v[188:189], v[124:125], v[6:7]
    v_pk_fma_f32 v[8:9], v[190:191], v[126:127], v[8:9]
    v_pk_fma_f32 v[6:7], v[192:193], v[128:129], v[6:7]
    v_pk_fma_f32 v[8:9], v[194:195], v[130:131], v[8:9]
    v_pk_fma_f32 v[6:7], v[196:197], v[132:133], v[6:7]
    v_pk_fma_f32 v[8:9], v[198:199], v[134:135], v[8:9]
    v_pk_fma_f32 v[6:7], v[200:201], v[136:137], v[6:7]
    v_pk_fma_f32 v[8:9], v[202:203], v[138:139], v[8:9]
    v_pk_fma_f32 v[6:7], v[204:205], v[140:141], v[6:7]
    v_pk_fma_f32 v[8:9], v[206:207], v[142:143], v[8:9]
    v_pk_add_f32 v[6:7], v[6:7], v[8:9]
    v_add_f32 v6, v6, v7
    v_mov_b32 v7, v6
    s_add_u32 s56, s3, 163840
    s_mov_b32 s57, 0x2b800000
    v_permlane32_swap_b32 v6, v7
    v_add_f32 v6, v6, v7
    s_mov_b32 exec_hi, 0
    buffer_store_dword v6, v243, s[48:51], s56 offen sc1
    s_mov_b32 exec_hi, -1
    v_cmp_nle_f32 s[0:1], s57, v208
    v_cmp_nle_f32 s[14:15], s57, v212
    s_mov_b32 s57, 0x53800000
    v_cmp_nge_f32 s[74:75], s57, v208
    v_cmp_nge_f32 vcc, s57, v212
    s_or_b64 s[0:1], s[0:1], s[14:15]
    s_movk_i32 s57, 0x207
    v_cmp_class_f32 s[14:15], v6, s57
    s_or_b64 s[0:1], s[0:1], s[74:75]
    s_or_b64 s[0:1], s[0:1], vcc
    s_or_b64 s[0:1], s[0:1], s[14:15]
    s_cselect_b32 s57, 1, 0
    s_cmp_gt_u32 s57, s65
    s_cbranch_scc1 F_slow
    s_add_u32 s63, s3, 524288
    s_andn2_b32 s61, s63, 2047
    s_lshl_b32 s62, s55, 11
    s_lshl_b32 s64, s55, 6
    s_add_u32 s64, s64, 163840
    v_add_u32 v12, 0x8000, v1
    v_and_b32 v8, 15, v0
    v_lshlrev_b32 v20, 3, v8
    v_lshrrev_b32 v9, 4, v0
    v_lshl_add_u32 v20, v9, 9, v20
    v_bfe_u32 v4, v0, 2, 3
    v_lshrrev_b32 v5, 1, v4
    v_lshlrev_b32 v5, 5, v5
    v_lshl_add_u32 v4, v4, 7, v5
    v_lshrrev_b32 v5, 5, v0
    v_lshl_add_u32 v4, v5, 11, v4
    v_and_b32 v5, 3, v0
    v_lshl_add_u32 v16, v5, 3, v4
    v_xor_b32 v17, 32, v16
    v_xor_b32 v18, 64, v16
    v_xor_b32 v19, 0x60, v16
    v_lshlrev_b32 v104, 16, v40
    v_and_b32 v105, 0xffff0000, v40
    v_lshlrev_b32 v106, 16, v41
    v_and_b32 v107, 0xffff0000, v41
    v_lshlrev_b32 v112, 16, v42
    v_and_b32 v113, 0xffff0000, v42
    v_lshlrev_b32 v114, 16, v43
    v_and_b32 v115, 0xffff0000, v43
    v_lshlrev_b32 v120, 16, v44
    v_and_b32 v121, 0xffff0000, v44
    v_lshlrev_b32 v122, 16, v45
    v_and_b32 v123, 0xffff0000, v45
    v_lshlrev_b32 v128, 16, v46
    v_and_b32 v129, 0xffff0000, v46
    v_lshlrev_b32 v130, 16, v47
    v_and_b32 v131, 0xffff0000, v47
    v_lshlrev_b32 v108, 16, v56
    v_and_b32 v109, 0xffff0000, v56
    v_lshlrev_b32 v110, 16, v57
    v_and_b32 v111, 0xffff0000, v57
    v_lshlrev_b32 v116, 16, v58
    v_and_b32 v117, 0xffff0000, v58
    v_lshlrev_b32 v118, 16, v59
    v_and_b32 v119, 0xffff0000, v59
    v_lshlrev_b32 v124, 16, v60
    v_and_b32 v125, 0xffff0000, v60
    v_lshlrev_b32 v126, 16, v61
    v_and_b32 v127, 0xffff0000, v61
    v_lshlrev_b32 v132, 16, v62
    v_and_b32 v133, 0xffff0000, v62
    v_lshlrev_b32 v134, 16, v63
    v_and_b32 v135, 0xffff0000, v63
    ds_read_b64_tr_b16 v[40:41], v16 offset:0
    ds_read_b64_tr_b16 v[42:43], v16 offset:1024
    ds_read_b64_tr_b16 v[44:45], v16 offset:4096
    ds_read_b64_tr_b16 v[46:47], v16 offset:5120
    ds_read_b64_tr_b16 v[48:49], v17 offset:0
    ds_read_b64_tr_b16 v[50:51], v17 offset:1024
    ds_read_b64_tr_b16 v[52:53], v17 offset:4096
    ds_read_b64_tr_b16 v[54:55], v17 offset:5120
    ds_read_b64_tr_b16 v[56:57], v18 offset:0
    ds_read_b64_tr_b16 v[58:59], v18 offset:1024
    ds_read_b64_tr_b16 v[60:61], v18 offset:4096
    ds_read_b64_tr_b16 v[62:63], v18 offset:5120
    v_lshlrev_b32 v4, 9, v0
    v_mov_b32 v31, 0
    s_and_b32 s56, s54, 8
    s_lshl_b32 s57, s56, 7
    s_add_u32 s57, s57, s61
    s_lshl_b32 s56, s56, 6
    s_add_u32 s61, s61, s56
    s_cmp_ge_u32 s54, 8
    s_cselect_b32 s56, s61, s50
    s_mov_b32 s60, 1048576
    s_waitcnt vmcnt(0)
    buffer_load_dword v30, v31, s[48:51], s56 offen sc1
    s_mov_b64 exec, 3
    buffer_atomic_add v3, v4, s[48:51], s57 offen
    s_mov_b64 exec, -1
    s_mov_b32 s63, s61
    s_and_b32 s56, s2, 7
    s_lshr_b32 s57, s2, 3
    s_and_b32 s72, s57, 7
    s_lshr_b32 s57, s57, 3
    s_lshl_b32 s66, s56, 2
    s_add_u32 s66, s66, s57
    s_movk_i32 s57, 4682
    s_movk_i32 s56, 6944
    v_add_u32 v4, 0, v0
    v_mul_u32_u24 v5, s57, v4
    v_lshrrev_b32 v5, 16, v5
    v_add_u32 v4, 0, v1
    v_mad_u32_u24 v21, v5, s56, v4
    v_add_u32 v4, 64, v0
    v_mul_u32_u24 v5, s57, v4
    v_lshrrev_b32 v5, 16, v5
    v_add_u32 v4, 0, v1
    v_mad_u32_u24 v22, v5, s56, v4
    v_add_u32 v4, 128, v0
    v_mul_u32_u24 v5, s57, v4
    v_lshrrev_b32 v5, 16, v5
    v_add_u32 v4, 0, v1
    v_mad_u32_u24 v23, v5, s56, v4
    v_add_u32 v4, 192, v0
    v_mul_u32_u24 v5, s57, v4
    v_lshrrev_b32 v5, 16, v5
    v_add_u32 v4, 0, v1
    v_mad_u32_u24 v24, v5, s56, v4
    v_add_u32 v4, 256, v0
    v_mul_u32_u24 v5, s57, v4
    v_lshrrev_b32 v5, 16, v5
    v_add_u32 v4, 4096, v1
    v_mad_u32_u24 v25, v5, s56, v4
    v_add_u32 v4, 320, v0
    v_mul_u32_u24 v5, s57, v4
    v_lshrrev_b32 v5, 16, v5
    v_add_u32 v4, 4096, v1
    v_mad_u32_u24 v26, v5, s56, v4
    v_add_u32 v4, 384, v0
    v_mul_u32_u24 v5, s57, v4
    v_lshrrev_b32 v5, 16, v5
    v_add_u32 v4, 4096, v1
    v_mad_u32_u24 v27, v5, s56, v4
    s_lshl_b32 s72, s72, 2
    s_add_u32 s72, s72, s52
    s_lshl_b32 s72, s72, 6
    s_and_b32 s56, s52, 1
    s_mul_i32 s68, s56, 229376
    s_mul_i32 s57, s66, 224
    s_add_u32 s68, s68, s57
    s_mul_i32 s69, s52, 7168
    s_mov_b32 s70, s69
    s_mov_b32 s71, 106496
    s_cmp_lt_u32 s52, 2
    s_cselect_b64 s[40:41], s[16:17], s[18:19]
    s_mov_b32 s42, 0x700000
    s_add_u32 s28, s26, 0xc00000
    s_addc_u32 s29, s27, 0
    s_mov_b32 s30, 0x400000
    s_mov_b32 s31, 0x20000
    v_accvgpr_write_b32 a234, v236
    v_accvgpr_write_b32 a235, v237
    v_accvgpr_write_b32 a236, v238
    v_accvgpr_write_b32 a237, v239
    v_mov_b32 v36, v243
    v_add_u32 v13, 0x10000, v1
    v_add_u32 v14, 0x18000, v1
    v_lshrrev_b32 v4, 2, v0
    v_mul_u32_u24 v4, 224, v4
    v_and_b32 v5, 3, v0
    v_lshl_add_u32 v11, v5, 3, v4
    v_mov_b32 v15, v11
    s_lshl_b32 s73, s72, 6
    s_add_u32 s67, s73, 655360
    s_add_u32 s73, s73, 32768
    s_add_u32 s65, s55, s54
    s_lshl_b32 s65, s65, 11
    s_add_u32 s61, s3, 655360
    s_add_u32 s3, s3, 32768
    s_mov_b32 s57, 0xba800000
    v_pk_mov_b32 v[156:157], 0, 0
    v_pk_mov_b32 v[158:159], 0, 0
    v_pk_mov_b32 v[160:161], 0, 0
    v_pk_mov_b32 v[162:163], 0, 0
    v_pk_mov_b32 v[164:165], 0, 0
    v_pk_mov_b32 v[166:167], 0, 0
    v_pk_mov_b32 v[168:169], 0, 0
    v_pk_mov_b32 v[170:171], 0, 0
    v_pk_mov_b32 v[172:173], 0, 0
    v_pk_mov_b32 v[174:175], 0, 0
    v_pk_mov_b32 v[176:177], 0, 0
    v_pk_mov_b32 v[178:179], 0, 0
    v_pk_mov_b32 v[180:181], 0, 0
    v_pk_mov_b32 v[182:183], 0, 0
    v_pk_mov_b32 v[184:185], 0, 0
    v_pk_mov_b32 v[186:187], 0, 0
    v_pk_mov_b32 v[188:189], 0, 0
    v_pk_mov_b32 v[190:191], 0, 0
    v_pk_mov_b32 v[192:193], 0, 0
    v_pk_mov_b32 v[194:195], 0, 0
    v_pk_mov_b32 v[196:197], 0, 0
    v_pk_mov_b32 v[198:199], 0, 0
    v_pk_mov_b32 v[200:201], 0, 0
    v_pk_mov_b32 v[202:203], 0, 0
    v_pk_mov_b32 v[204:205], 0, 0
    v_pk_mov_b32 v[206:207], 0, 0
    v_pk_mov_b32 v[208:209], 0, 0
    v_pk_mov_b32 v[210:211], 0, 0
    v_pk_mov_b32 v[212:213], 0, 0
    v_pk_mov_b32 v[214:215], 0, 0
    v_pk_mov_b32 v[216:217], 0, 0
    v_pk_mov_b32 v[218:219], 0, 0
    v_pk_mov_b32 v[220:221], 0, 0
    v_pk_mov_b32 v[222:223], 0, 0
    v_pk_mov_b32 v[224:225], 0, 0
    v_pk_mov_b32 v[226:227], 0, 0
    v_pk_mov_b32 v[228:229], 0, 0
    v_pk_mov_b32 v[230:231], 0, 0
    v_pk_mov_b32 v[232:233], 0, 0
    v_pk_mov_b32 v[234:235], 0, 0
    v_pk_mov_b32 v[236:237], 0, 0
    v_pk_mov_b32 v[238:239], 0, 0
    v_pk_mov_b32 v[240:241], 0, 0
    v_pk_mov_b32 v[242:243], 0, 0
    v_pk_mov_b32 v[244:245], 0, 0
    v_pk_mov_b32 v[246:247], 0, 0
    v_pk_mov_b32 v[248:249], 0, 0
    v_pk_mov_b32 v[250:251], 0, 0
    v_pk_mov_b32 v[252:253], 0, 0
    v_pk_mov_b32 v[254:255], 0, 0
    s_waitcnt vmcnt(1)
    v_cmp_gt_u32 vcc, 8, v30
    s_nop 0
    s_cbranch_vccnz F_opoll
F_opoll_done:
    buffer_load_dwordx4 a[0:3], v1, s[32:35], s62 offen offset:0 sc1
    buffer_load_dwordx4 a[4:7], v1, s[32:35], s62 offen offset:1024 sc1
    buffer_load_dwordx4 a[8:11], v12, s[32:35], s62 offen offset:0 sc1
    buffer_load_dwordx4 a[12:15], v12, s[32:35], s62 offen offset:1024 sc1
    buffer_load_dwordx4 a[16:19], v1, s[32:35], s62 offen offset:2048 sc1
    buffer_load_dwordx4 a[20:23], v1, s[32:35], s62 offen offset:3072 sc1
    buffer_load_dwordx4 a[24:27], v12, s[32:35], s62 offen offset:2048 sc1
    buffer_load_dwordx4 a[28:31], v12, s[32:35], s62 offen offset:3072 sc1
    s_add_u32 s62, s62, 4096
    buffer_load_dwordx4 a[32:35], v1, s[32:35], s62 offen offset:0 sc1
    buffer_load_dwordx4 a[36:39], v1, s[32:35], s62 offen offset:1024 sc1
    buffer_load_dwordx4 a[40:43], v12, s[32:35], s62 offen offset:0 sc1
    buffer_load_dwordx4 a[44:47], v12, s[32:35], s62 offen offset:1024 sc1
    s_waitcnt vmcnt(11) lgkmcnt(10)
    v_mfma_f32_16x16x32_bf16 v[104:107], v[40:43], a[0:3], v[104:107]
    ds_read_b64_tr_b16 v[64:65], v19 offset:0
    buffer_load_dwordx4 a[48:51], v1, s[32:35], s62 offen offset:2048 sc1
    s_waitcnt vmcnt(11) lgkmcnt(9)
    v_mfma_f32_16x16x32_bf16 v[104:107], v[44:47], a[4:7], v[104:107]
    ds_read_b64_tr_b16 v[66:67], v19 offset:1024
    s_waitcnt vmcnt(9)
    v_mfma_f32_16x16x32_bf16 v[108:111], v[44:47], a[12:15], v[108:111]
    ds_read_b64_tr_b16 v[68:69], v19 offset:4096
    v_mfma_f32_16x16x32_bf16 v[108:111], v[40:43], a[8:11], v[108:111]
    ds_read_b64_tr_b16 v[70:71], v19 offset:5120
    s_waitcnt lgkmcnt(10)
    v_mfma_f32_16x16x32_bf16 v[116:119], v[48:51], a[8:11], v[116:119]
    ds_read_b64_tr_b16 v[72:73], v16 offset:8192
    buffer_load_dwordx4 a[52:55], v1, s[32:35], s62 offen offset:3072 sc1
    s_waitcnt lgkmcnt(9)
    v_mfma_f32_16x16x32_bf16 v[116:119], v[52:55], a[12:15], v[116:119]
    ds_read_b64_tr_b16 v[74:75], v16 offset:9216
    v_mfma_f32_16x16x32_bf16 v[112:115], v[52:55], a[4:7], v[112:115]
    ds_read_b64_tr_b16 v[76:77], v16 offset:12288
    v_mfma_f32_16x16x32_bf16 v[112:115], v[48:51], a[0:3], v[112:115]
    ds_read_b64_tr_b16 v[78:79], v16 offset:13312
    s_waitcnt lgkmcnt(8)
    v_mfma_f32_16x16x32_bf16 v[120:123], v[56:59], a[0:3], v[120:123]
    ds_read_b64_tr_b16 v[80:81], v17 offset:8192
    buffer_load_dwordx4 a[56:59], v12, s[32:35], s62 offen offset:2048 sc1
    v_mfma_f32_16x16x32_bf16 v[120:123], v[60:63], a[4:7], v[120:123]
    ds_read_b64_tr_b16 v[82:83], v17 offset:9216
    v_mfma_f32_16x16x32_bf16 v[124:127], v[60:63], a[12:15], v[124:127]
    ds_read_b64_tr_b16 v[84:85], v17 offset:12288
    v_mfma_f32_16x16x32_bf16 v[124:127], v[56:59], a[8:11], v[124:127]
    ds_read_b64_tr_b16 v[86:87], v17 offset:13312
    s_waitcnt lgkmcnt(8)
    v_mfma_f32_16x16x32_bf16 v[132:135], v[64:67], a[8:11], v[132:135]
    ds_read_b64_tr_b16 v[88:89], v18 offset:8192
    buffer_load_dwordx4 a[60:63], v12, s[32:35], s62 offen offset:3072 sc1
    v_mfma_f32_16x16x32_bf16 v[132:135], v[68:71], a[12:15], v[132:135]
    ds_read_b64_tr_b16 v[90:91], v18 offset:9216
    s_add_u32 s62, s62, 4096
    v_mfma_f32_16x16x32_bf16 v[128:131], v[68:71], a[4:7], v[128:131]
    ds_read_b64_tr_b16 v[92:93], v18 offset:12288
    v_mfma_f32_16x16x32_bf16 v[128:131], v[64:67], a[0:3], v[128:131]
    ds_read_b64_tr_b16 v[94:95], v18 offset:13312
    s_waitcnt vmcnt(8) lgkmcnt(8)
    v_mfma_f32_16x16x32_bf16 v[104:107], v[72:75], a[16:19], v[104:107]
    ds_read_b64_tr_b16 v[96:97], v19 offset:8192
    buffer_load_dwordx4 a[64:67], v1, s[32:35], s62 offen offset:0 sc1
    v_mfma_f32_16x16x32_bf16 v[104:107], v[76:79], a[20:23], v[104:107]
    ds_read_b64_tr_b16 v[98:99], v19 offset:9216
    v_mfma_f32_16x16x32_bf16 v[108:111], v[76:79], a[28:31], v[108:111]
    ds_read_b64_tr_b16 v[100:101], v19 offset:12288
    v_mfma_f32_16x16x32_bf16 v[108:111], v[72:75], a[24:27], v[108:111]
    ds_read_b64_tr_b16 v[102:103], v19 offset:13312
    s_waitcnt lgkmcnt(8)
    v_mfma_f32_16x16x32_bf16 v[116:119], v[80:83], a[24:27], v[116:119]
    ds_read_b64_tr_b16 v[40:41], v16 offset:16384
    buffer_load_dwordx4 a[68:71], v1, s[32:35], s62 offen offset:1024 sc1
    v_mfma_f32_16x16x32_bf16 v[116:119], v[84:87], a[28:31], v[116:119]
    ds_read_b64_tr_b16 v[42:43], v16 offset:17408
    v_mfma_f32_16x16x32_bf16 v[112:115], v[84:87], a[20:23], v[112:115]
    ds_read_b64_tr_b16 v[44:45], v16 offset:20480
    v_mfma_f32_16x16x32_bf16 v[112:115], v[80:83], a[16:19], v[112:115]
    ds_read_b64_tr_b16 v[46:47], v16 offset:21504
    s_waitcnt lgkmcnt(8)
    v_mfma_f32_16x16x32_bf16 v[120:123], v[88:91], a[16:19], v[120:123]
    ds_read_b64_tr_b16 v[48:49], v17 offset:16384
    buffer_load_dwordx4 a[72:75], v12, s[32:35], s62 offen offset:0 sc1
    v_mfma_f32_16x16x32_bf16 v[120:123], v[92:95], a[20:23], v[120:123]
    ds_read_b64_tr_b16 v[50:51], v17 offset:17408
    v_mfma_f32_16x16x32_bf16 v[124:127], v[92:95], a[28:31], v[124:127]
    ds_read_b64_tr_b16 v[52:53], v17 offset:20480
    v_mfma_f32_16x16x32_bf16 v[124:127], v[88:91], a[24:27], v[124:127]
    ds_read_b64_tr_b16 v[54:55], v17 offset:21504
    s_waitcnt lgkmcnt(8)
    v_mfma_f32_16x16x32_bf16 v[132:135], v[96:99], a[24:27], v[132:135]
    ds_read_b64_tr_b16 v[56:57], v18 offset:16384
    buffer_load_dwordx4 a[76:79], v12, s[32:35], s62 offen offset:1024 sc1
    v_mfma_f32_16x16x32_bf16 v[132:135], v[100:103], a[28:31], v[132:135]
    ds_read_b64_tr_b16 v[58:59], v18 offset:17408
    v_mfma_f32_16x16x32_bf16 v[128:131], v[100:103], a[20:23], v[128:131]
    ds_read_b64_tr_b16 v[60:61], v18 offset:20480
    v_mfma_f32_16x16x32_bf16 v[128:131], v[96:99], a[16:19], v[128:131]
    ds_read_b64_tr_b16 v[62:63], v18 offset:21504
    s_waitcnt vmcnt(8) lgkmcnt(8)
    v_mfma_f32_16x16x32_bf16 v[104:107], v[40:43], a[32:35], v[104:107]
    ds_read_b64_tr_b16 v[64:65], v19 offset:16384
    buffer_load_dwordx4 a[80:83], v1, s[32:35], s62 offen offset:2048 sc1
    v_mfma_f32_16x16x32_bf16 v[104:107], v[44:47], a[36:39], v[104:107]
    ds_read_b64_tr_b16 v[66:67], v19 offset:17408
    v_mfma_f32_16x16x32_bf16 v[108:111], v[44:47], a[44:47], v[108:111]
    ds_read_b64_tr_b16 v[68:69], v19 offset:20480
    buffer_load_dword v30, v31, s[48:51], s63 offen offset:1024 sc1
    v_mfma_f32_16x16x32_bf16 v[108:111], v[40:43], a[40:43], v[108:111]
    ds_read_b64_tr_b16 v[70:71], v19 offset:21504
    s_waitcnt lgkmcnt(8)
    v_mfma_f32_16x16x32_bf16 v[116:119], v[48:51], a[40:43], v[116:119]
    ds_read_b64_tr_b16 v[72:73], v16 offset:24576
    buffer_load_dwordx4 a[84:87], v1, s[32:35], s62 offen offset:3072 sc1
    v_mfma_f32_16x16x32_bf16 v[116:119], v[52:55], a[44:47], v[116:119]
    ds_read_b64_tr_b16 v[74:75], v16 offset:25600
    v_mfma_f32_16x16x32_bf16 v[112:115], v[52:55], a[36:39], v[112:115]
    ds_read_b64_tr_b16 v[76:77], v16 offset:28672
    v_mfma_f32_16x16x32_bf16 v[112:115], v[48:51], a[32:35], v[112:115]
    ds_read_b64_tr_b16 v[78:79], v16 offset:29696
    s_waitcnt lgkmcnt(8)
    v_mfma_f32_16x16x32_bf16 v[120:123], v[56:59], a[32:35], v[120:123]
    ds_read_b64_tr_b16 v[80:81], v17 offset:24576
    buffer_load_dwordx4 a[88:91], v12, s[32:35], s62 offen offset:2048 sc1
    v_mfma_f32_16x16x32_bf16 v[120:123], v[60:63], a[36:39], v[120:123]
    ds_read_b64_tr_b16 v[82:83], v17 offset:25600
    v_mfma_f32_16x16x32_bf16 v[124:127], v[60:63], a[44:47], v[124:127]
    ds_read_b64_tr_b16 v[84:85], v17 offset:28672
    v_mfma_f32_16x16x32_bf16 v[124:127], v[56:59], a[40:43], v[124:127]
    ds_read_b64_tr_b16 v[86:87], v17 offset:29696
    s_waitcnt lgkmcnt(8)
    v_mfma_f32_16x16x32_bf16 v[132:135], v[64:67], a[40:43], v[132:135]
    ds_read_b64_tr_b16 v[88:89], v18 offset:24576
    buffer_load_dwordx4 a[92:95], v12, s[32:35], s62 offen offset:3072 sc1
    v_mfma_f32_16x16x32_bf16 v[132:135], v[68:71], a[44:47], v[132:135]
    ds_read_b64_tr_b16 v[90:91], v18 offset:25600
    s_add_u32 s62, s62, 4096
    v_mfma_f32_16x16x32_bf16 v[128:131], v[68:71], a[36:39], v[128:131]
    ds_read_b64_tr_b16 v[92:93], v18 offset:28672
    v_mfma_f32_16x16x32_bf16 v[128:131], v[64:67], a[32:35], v[128:131]
    ds_read_b64_tr_b16 v[94:95], v18 offset:29696
    s_waitcnt vmcnt(9) lgkmcnt(8)
    v_mfma_f32_16x16x32_bf16 v[104:107], v[72:75], a[48:51], v[104:107]
    ds_read_b64_tr_b16 v[96:97], v19 offset:24576
    buffer_load_dwordx4 a[96:99], v1, s[32:35], s62 offen offset:0 sc1
    v_mfma_f32_16x16x32_bf16 v[104:107], v[76:79], a[52:55], v[104:107]
    ds_read_b64_tr_b16 v[98:99], v19 offset:25600
    v_mfma_f32_16x16x32_bf16 v[108:111], v[76:79], a[60:63], v[108:111]
    ds_read_b64_tr_b16 v[100:101], v19 offset:28672
    v_mfma_f32_16x16x32_bf16 v[108:111], v[72:75], a[56:59], v[108:111]
    ds_read_b64_tr_b16 v[102:103], v19 offset:29696
    s_waitcnt lgkmcnt(8)
    v_mfma_f32_16x16x32_bf16 v[116:119], v[80:83], a[56:59], v[116:119]
    ds_read_b64_tr_b16 v[40:41], v16 offset:32768
    buffer_load_dwordx4 a[100:103], v1, s[32:35], s62 offen offset:1024 sc1
    v_mfma_f32_16x16x32_bf16 v[116:119], v[84:87], a[60:63], v[116:119]
    ds_read_b64_tr_b16 v[42:43], v16 offset:33792
    v_mfma_f32_16x16x32_bf16 v[112:115], v[84:87], a[52:55], v[112:115]
    ds_read_b64_tr_b16 v[44:45], v16 offset:36864
    v_mfma_f32_16x16x32_bf16 v[112:115], v[80:83], a[48:51], v[112:115]
    ds_read_b64_tr_b16 v[46:47], v16 offset:37888
    s_waitcnt lgkmcnt(8)
    v_mfma_f32_16x16x32_bf16 v[120:123], v[88:91], a[48:51], v[120:123]
    ds_read_b64_tr_b16 v[48:49], v17 offset:32768
    buffer_load_dwordx4 a[104:107], v12, s[32:35], s62 offen offset:0 sc1
    v_mfma_f32_16x16x32_bf16 v[120:123], v[92:95], a[52:55], v[120:123]
    ds_read_b64_tr_b16 v[50:51], v17 offset:33792
    v_mfma_f32_16x16x32_bf16 v[124:127], v[92:95], a[60:63], v[124:127]
    ds_read_b64_tr_b16 v[52:53], v17 offset:36864
    v_mfma_f32_16x16x32_bf16 v[124:127], v[88:91], a[56:59], v[124:127]
    ds_read_b64_tr_b16 v[54:55], v17 offset:37888
    s_waitcnt lgkmcnt(8)
    v_mfma_f32_16x16x32_bf16 v[132:135], v[96:99], a[56:59], v[132:135]
    ds_read_b64_tr_b16 v[56:57], v18 offset:32768
    buffer_load_dwordx4 a[108:111], v12, s[32:35], s62 offen offset:1024 sc1
    v_mfma_f32_16x16x32_bf16 v[132:135], v[100:103], a[60:63], v[132:135]
    ds_read_b64_tr_b16 v[58:59], v18 offset:33792
    v_mfma_f32_16x16x32_bf16 v[128:131], v[100:103], a[52:55], v[128:131]
    ds_read_b64_tr_b16 v[60:61], v18 offset:36864
    v_mfma_f32_16x16x32_bf16 v[128:131], v[96:99], a[48:51], v[128:131]
    ds_read_b64_tr_b16 v[62:63], v18 offset:37888
    s_waitcnt vmcnt(9) lgkmcnt(8)
    v_mfma_f32_16x16x32_bf16 v[104:107], v[40:43], a[64:67], v[104:107]
    ds_read_b64_tr_b16 v[64:65], v19 offset:32768
    buffer_load_dwordx4 a[112:115], v1, s[32:35], s62 offen offset:2048 sc1
    v_mfma_f32_16x16x32_bf16 v[104:107], v[44:47], a[68:71], v[104:107]
    ds_read_b64_tr_b16 v[66:67], v19 offset:33792
    v_mfma_f32_16x16x32_bf16 v[108:111], v[44:47], a[76:79], v[108:111]
    ds_read_b64_tr_b16 v[68:69], v19 offset:36864
    v_mfma_f32_16x16x32_bf16 v[108:111], v[40:43], a[72:75], v[108:111]
    ds_read_b64_tr_b16 v[70:71], v19 offset:37888
    s_waitcnt lgkmcnt(8)
    v_mfma_f32_16x16x32_bf16 v[116:119], v[48:51], a[72:75], v[116:119]
    ds_read_b64_tr_b16 v[72:73], v16 offset:40960
    buffer_load_dwordx4 a[116:119], v1, s[32:35], s62 offen offset:3072 sc1
    v_mfma_f32_16x16x32_bf16 v[116:119], v[52:55], a[76:79], v[116:119]
    ds_read_b64_tr_b16 v[74:75], v16 offset:41984
    v_mfma_f32_16x16x32_bf16 v[112:115], v[52:55], a[68:71], v[112:115]
    ds_read_b64_tr_b16 v[76:77], v16 offset:45056
    v_mfma_f32_16x16x32_bf16 v[112:115], v[48:51], a[64:67], v[112:115]
    ds_read_b64_tr_b16 v[78:79], v16 offset:46080
    s_waitcnt lgkmcnt(8)
    v_mfma_f32_16x16x32_bf16 v[120:123], v[56:59], a[64:67], v[120:123]
    ds_read_b64_tr_b16 v[80:81], v17 offset:40960
    buffer_load_dwordx4 a[120:123], v12, s[32:35], s62 offen offset:2048 sc1
    v_mfma_f32_16x16x32_bf16 v[120:123], v[60:63], a[68:71], v[120:123]
    ds_read_b64_tr_b16 v[82:83], v17 offset:41984
    v_mfma_f32_16x16x32_bf16 v[124:127], v[60:63], a[76:79], v[124:127]
    ds_read_b64_tr_b16 v[84:85], v17 offset:45056
    v_mfma_f32_16x16x32_bf16 v[124:127], v[56:59], a[72:75], v[124:127]
    ds_read_b64_tr_b16 v[86:87], v17 offset:46080
    s_waitcnt lgkmcnt(8)
    v_mfma_f32_16x16x32_bf16 v[132:135], v[64:67], a[72:75], v[132:135]
    ds_read_b64_tr_b16 v[88:89], v18 offset:40960
    buffer_load_dwordx4 a[124:127], v12, s[32:35], s62 offen offset:3072 sc1
    v_mfma_f32_16x16x32_bf16 v[132:135], v[68:71], a[76:79], v[132:135]
    ds_read_b64_tr_b16 v[90:91], v18 offset:41984
    s_add_u32 s62, s62, 4096
    v_mfma_f32_16x16x32_bf16 v[128:131], v[68:71], a[68:71], v[128:131]
    ds_read_b64_tr_b16 v[92:93], v18 offset:45056
    v_mfma_f32_16x16x32_bf16 v[128:131], v[64:67], a[64:67], v[128:131]
    ds_read_b64_tr_b16 v[94:95], v18 offset:46080
    s_waitcnt vmcnt(8) lgkmcnt(8)
    v_cmp_gt_u32 vcc, 8, v30
    s_nop 0
    s_cbranch_vccnz F_opoll2
F_opoll2_done:
    v_mfma_f32_16x16x32_bf16 v[104:107], v[72:75], a[80:83], v[104:107]
    ds_read_b64_tr_b16 v[96:97], v19 offset:40960
    buffer_load_dwordx4 a[0:3], v1, s[32:35], s62 offen offset:0 sc1
    v_mfma_f32_16x16x32_bf16 v[104:107], v[76:79], a[84:87], v[104:107]
    ds_read_b64_tr_b16 v[98:99], v19 offset:41984
    v_mfma_f32_16x16x32_bf16 v[108:111], v[76:79], a[92:95], v[108:111]
    ds_read_b64_tr_b16 v[100:101], v19 offset:45056
    v_mfma_f32_16x16x32_bf16 v[108:111], v[72:75], a[88:91], v[108:111]
    ds_read_b64_tr_b16 v[102:103], v19 offset:46080
    s_waitcnt lgkmcnt(8)
    v_mfma_f32_16x16x32_bf16 v[116:119], v[80:83], a[88:91], v[116:119]
    ds_read_b64_tr_b16 v[40:41], v16 offset:49152
    buffer_load_dwordx4 a[4:7], v1, s[32:35], s62 offen offset:1024 sc1
    v_mfma_f32_16x16x32_bf16 v[116:119], v[84:87], a[92:95], v[116:119]
    ds_read_b64_tr_b16 v[42:43], v16 offset:50176
    v_mfma_f32_16x16x32_bf16 v[112:115], v[84:87], a[84:87], v[112:115]
    ds_read_b64_tr_b16 v[44:45], v16 offset:53248
    v_mfma_f32_16x16x32_bf16 v[112:115], v[80:83], a[80:83], v[112:115]
    ds_read_b64_tr_b16 v[46:47], v16 offset:54272
    s_waitcnt lgkmcnt(8)
    v_mfma_f32_16x16x32_bf16 v[120:123], v[88:91], a[80:83], v[120:123]
    ds_read_b64_tr_b16 v[48:49], v17 offset:49152
    buffer_load_dwordx4 a[8:11], v12, s[32:35], s62 offen offset:0 sc1
    v_mfma_f32_16x16x32_bf16 v[120:123], v[92:95], a[84:87], v[120:123]
    ds_read_b64_tr_b16 v[50:51], v17 offset:50176
    v_mfma_f32_16x16x32_bf16 v[124:127], v[92:95], a[92:95], v[124:127]
    ds_read_b64_tr_b16 v[52:53], v17 offset:53248
    v_mfma_f32_16x16x32_bf16 v[124:127], v[88:91], a[88:91], v[124:127]
    ds_read_b64_tr_b16 v[54:55], v17 offset:54272
    s_waitcnt lgkmcnt(8)
    v_mfma_f32_16x16x32_bf16 v[132:135], v[96:99], a[88:91], v[132:135]
    ds_read_b64_tr_b16 v[56:57], v18 offset:49152
    buffer_load_dwordx4 a[12:15], v12, s[32:35], s62 offen offset:1024 sc1
    v_mfma_f32_16x16x32_bf16 v[132:135], v[100:103], a[92:95], v[132:135]
    ds_read_b64_tr_b16 v[58:59], v18 offset:50176
    v_mfma_f32_16x16x32_bf16 v[128:131], v[100:103], a[84:87], v[128:131]
    ds_read_b64_tr_b16 v[60:61], v18 offset:53248
    v_mfma_f32_16x16x32_bf16 v[128:131], v[96:99], a[80:83], v[128:131]
    ds_read_b64_tr_b16 v[62:63], v18 offset:54272
    s_waitcnt vmcnt(8) lgkmcnt(8)
    v_mfma_f32_16x16x32_bf16 v[104:107], v[40:43], a[96:99], v[104:107]
    ds_read_b64_tr_b16 v[64:65], v19 offset:49152
    buffer_load_dwordx4 a[16:19], v1, s[32:35], s62 offen offset:2048 sc1
    v_mfma_f32_16x16x32_bf16 v[104:107], v[44:47], a[100:103], v[104:107]
    ds_read_b64_tr_b16 v[66:67], v19 offset:50176
    v_mfma_f32_16x16x32_bf16 v[108:111], v[44:47], a[108:111], v[108:111]
    ds_read_b64_tr_b16 v[68:69], v19 offset:53248
    buffer_load_dwordx2 v[136:137], v20, s[48:51], s64 offen offset:0 sc1
    v_mfma_f32_16x16x32_bf16 v[108:111], v[40:43], a[104:107], v[108:111]
    ds_read_b64_tr_b16 v[70:71], v19 offset:54272
    s_waitcnt lgkmcnt(8)
    v_mfma_f32_16x16x32_bf16 v[116:119], v[48:51], a[104:107], v[116:119]
    ds_read_b64_tr_b16 v[72:73], v16 offset:57344
    buffer_load_dwordx4 a[20:23], v1, s[32:35], s62 offen offset:3072 sc1
    v_mfma_f32_16x16x32_bf16 v[116:119], v[52:55], a[108:111], v[116:119]
    ds_read_b64_tr_b16 v[74:75], v16 offset:58368
    v_mfma_f32_16x16x32_bf16 v[112:115], v[52:55], a[100:103], v[112:115]
    ds_read_b64_tr_b16 v[76:77], v16 offset:61440
    buffer_load_dwordx2 v[138:139], v20, s[48:51], s64 offen offset:128 sc1
    v_mfma_f32_16x16x32_bf16 v[112:115], v[48:51], a[96:99], v[112:115]
    ds_read_b64_tr_b16 v[78:79], v16 offset:62464
    v_xor_b32 v16, 0x10000, v16
    s_waitcnt lgkmcnt(8)
    v_mfma_f32_16x16x32_bf16 v[120:123], v[56:59], a[96:99], v[120:123]
    ds_read_b64_tr_b16 v[80:81], v17 offset:57344
    buffer_load_dwordx4 a[24:27], v12, s[32:35], s62 offen offset:2048 sc1
    v_mfma_f32_16x16x32_bf16 v[120:123], v[60:63], a[100:103], v[120:123]
    ds_read_b64_tr_b16 v[82:83], v17 offset:58368
    v_mfma_f32_16x16x32_bf16 v[124:127], v[60:63], a[108:111], v[124:127]
    ds_read_b64_tr_b16 v[84:85], v17 offset:61440
    buffer_load_dwordx2 v[140:141], v20, s[48:51], s64 offen offset:256 sc1
    v_mfma_f32_16x16x32_bf16 v[124:127], v[56:59], a[104:107], v[124:127]
    ds_read_b64_tr_b16 v[86:87], v17 offset:62464
    v_xor_b32 v17, 0x10000, v17
    s_waitcnt lgkmcnt(8)
    v_mfma_f32_16x16x32_bf16 v[132:135], v[64:67], a[104:107], v[132:135]
    ds_read_b64_tr_b16 v[88:89], v18 offset:57344
    buffer_load_dwordx4 a[28:31], v12, s[32:35], s62 offen offset:3072 sc1
    v_mfma_f32_16x16x32_bf16 v[132:135], v[68:71], a[108:111], v[132:135]
    ds_read_b64_tr_b16 v[90:91], v18 offset:58368
    s_add_u32 s62, s62, 4096
    v_mfma_f32_16x16x32_bf16 v[128:131], v[68:71], a[100:103], v[128:131]
    ds_read_b64_tr_b16 v[92:93], v18 offset:61440
    buffer_load_dwordx2 v[142:143], v20, s[48:51], s64 offen offset:384 sc1
    v_mfma_f32_16x16x32_bf16 v[128:131], v[64:67], a[96:99], v[128:131]
    ds_read_b64_tr_b16 v[94:95], v18 offset:62464
    v_xor_b32 v18, 0x10000, v18
    s_waitcnt vmcnt(12) lgkmcnt(8)
    v_mfma_f32_16x16x32_bf16 v[104:107], v[72:75], a[112:115], v[104:107]
    ds_read_b64_tr_b16 v[96:97], v19 offset:57344
    buffer_load_dwordx4 a[32:35], v1, s[32:35], s62 offen offset:0 sc1
    v_mfma_f32_16x16x32_bf16 v[104:107], v[76:79], a[116:119], v[104:107]
    ds_read_b64_tr_b16 v[98:99], v19 offset:58368
    v_mfma_f32_16x16x32_bf16 v[108:111], v[76:79], a[124:127], v[108:111]
    ds_read_b64_tr_b16 v[100:101], v19 offset:61440
    v_mfma_f32_16x16x32_bf16 v[108:111], v[72:75], a[120:123], v[108:111]
    ds_read_b64_tr_b16 v[102:103], v19 offset:62464
    v_xor_b32 v19, 0x10000, v19
    s_waitcnt lgkmcnt(8)
    v_mfma_f32_16x16x32_bf16 v[116:119], v[80:83], a[120:123], v[116:119]
    ds_read_b64_tr_b16 v[40:41], v16 offset:0
    buffer_load_dwordx4 a[36:39], v1, s[32:35], s62 offen offset:1024 sc1
    v_mfma_f32_16x16x32_bf16 v[116:119], v[84:87], a[124:127], v[116:119]
    ds_read_b64_tr_b16 v[42:43], v16 offset:1024
    v_mfma_f32_16x16x32_bf16 v[112:115], v[84:87], a[116:119], v[112:115]
    ds_read_b64_tr_b16 v[44:45], v16 offset:4096
    v_mfma_f32_16x16x32_bf16 v[112:115], v[80:83], a[112:115], v[112:115]
    ds_read_b64_tr_b16 v[46:47], v16 offset:5120
    s_waitcnt lgkmcnt(8)
    v_mfma_f32_16x16x32_bf16 v[120:123], v[88:91], a[112:115], v[120:123]
    ds_read_b64_tr_b16 v[48:49], v17 offset:0
    buffer_load_dwordx4 a[40:43], v12, s[32:35], s62 offen offset:0 sc1
    v_mfma_f32_16x16x32_bf16 v[120:123], v[92:95], a[116:119], v[120:123]
    ds_read_b64_tr_b16 v[50:51], v17 offset:1024
    v_mfma_f32_16x16x32_bf16 v[124:127], v[92:95], a[124:127], v[124:127]
    ds_read_b64_tr_b16 v[52:53], v17 offset:4096
    v_mfma_f32_16x16x32_bf16 v[124:127], v[88:91], a[120:123], v[124:127]
    ds_read_b64_tr_b16 v[54:55], v17 offset:5120
    s_waitcnt lgkmcnt(8)
    v_mfma_f32_16x16x32_bf16 v[132:135], v[96:99], a[120:123], v[132:135]
    ds_read_b64_tr_b16 v[56:57], v18 offset:0
    buffer_load_dwordx4 a[44:47], v12, s[32:35], s62 offen offset:1024 sc1
    v_mfma_f32_16x16x32_bf16 v[132:135], v[100:103], a[124:127], v[132:135]
    ds_read_b64_tr_b16 v[58:59], v18 offset:1024
    v_mfma_f32_16x16x32_bf16 v[128:131], v[100:103], a[116:119], v[128:131]
    ds_read_b64_tr_b16 v[60:61], v18 offset:4096
    v_mfma_f32_16x16x32_bf16 v[128:131], v[96:99], a[112:115], v[128:131]
    ds_read_b64_tr_b16 v[62:63], v18 offset:5120
    s_waitcnt vmcnt(12) lgkmcnt(8)
    v_mfma_f32_16x16x32_bf16 v[104:107], v[40:43], a[0:3], v[104:107]
    ds_read_b64_tr_b16 v[64:65], v19 offset:0
    buffer_load_dwordx4 a[48:51], v1, s[32:35], s62 offen offset:2048 sc1
    v_mfma_f32_16x16x32_bf16 v[104:107], v[44:47], a[4:7], v[104:107]
    ds_read_b64_tr_b16 v[66:67], v19 offset:1024
    v_mfma_f32_16x16x32_bf16 v[108:111], v[44:47], a[12:15], v[108:111]
    ds_read_b64_tr_b16 v[68:69], v19 offset:4096
    v_mfma_f32_16x16x32_bf16 v[108:111], v[40:43], a[8:11], v[108:111]
    ds_read_b64_tr_b16 v[70:71], v19 offset:5120
    s_waitcnt lgkmcnt(8)
    v_mfma_f32_16x16x32_bf16 v[116:119], v[48:51], a[8:11], v[116:119]
    ds_read_b64_tr_b16 v[72:73], v16 offset:8192
    buffer_load_dwordx4 a[52:55], v1, s[32:35], s62 offen offset:3072 sc1
    v_mfma_f32_16x16x32_bf16 v[116:119], v[52:55], a[12:15], v[116:119]
    ds_read_b64_tr_b16 v[74:75], v16 offset:9216
    v_mfma_f32_16x16x32_bf16 v[112:115], v[52:55], a[4:7], v[112:115]
    ds_read_b64_tr_b16 v[76:77], v16 offset:12288
    v_mfma_f32_16x16x32_bf16 v[112:115], v[48:51], a[0:3], v[112:115]
    ds_read_b64_tr_b16 v[78:79], v16 offset:13312
    s_waitcnt lgkmcnt(8)
    v_mfma_f32_16x16x32_bf16 v[120:123], v[56:59], a[0:3], v[120:123]
    ds_read_b64_tr_b16 v[80:81], v17 offset:8192
    buffer_load_dwordx4 a[56:59], v12, s[32:35], s62 offen offset:2048 sc1
    v_mfma_f32_16x16x32_bf16 v[120:123], v[60:63], a[4:7], v[120:123]
    ds_read_b64_tr_b16 v[82:83], v17 offset:9216
    v_mfma_f32_16x16x32_bf16 v[124:127], v[60:63], a[12:15], v[124:127]
    ds_read_b64_tr_b16 v[84:85], v17 offset:12288
    v_mfma_f32_16x16x32_bf16 v[124:127], v[56:59], a[8:11], v[124:127]
    ds_read_b64_tr_b16 v[86:87], v17 offset:13312
    s_waitcnt lgkmcnt(8)
    v_mfma_f32_16x16x32_bf16 v[132:135], v[64:67], a[8:11], v[132:135]
    ds_read_b64_tr_b16 v[88:89], v18 offset:8192
    buffer_load_dwordx4 a[60:63], v12, s[32:35], s62 offen offset:3072 sc1
    v_mfma_f32_16x16x32_bf16 v[132:135], v[68:71], a[12:15], v[132:135]
    ds_read_b64_tr_b16 v[90:91], v18 offset:9216
    s_add_u32 s62, s62, 4096
    v_mfma_f32_16x16x32_bf16 v[128:131], v[68:71], a[4:7], v[128:131]
    ds_read_b64_tr_b16 v[92:93], v18 offset:12288
    v_mfma_f32_16x16x32_bf16 v[128:131], v[64:67], a[0:3], v[128:131]
    ds_read_b64_tr_b16 v[94:95], v18 offset:13312
    s_waitcnt vmcnt(9) lgkmcnt(8)
    v_mfma_f32_16x16x32_bf16 v[104:107], v[72:75], a[16:19], v[104:107]
    ds_read_b64_tr_b16 v[96:97], v19 offset:8192
    buffer_load_dwordx4 a[64:67], v1, s[32:35], s62 offen offset:0 sc1
    v_mfma_f32_16x16x32_bf16 v[104:107], v[76:79], a[20:23], v[104:107]
    ds_read_b64_tr_b16 v[98:99], v19 offset:9216
    v_mfma_f32_16x16x32_bf16 v[108:111], v[76:79], a[28:31], v[108:111]
    ds_read_b64_tr_b16 v[100:101], v19 offset:12288
    v_mfma_f32_16x16x32_bf16 v[108:111], v[72:75], a[24:27], v[108:111]
    ds_read_b64_tr_b16 v[102:103], v19 offset:13312
    s_waitcnt lgkmcnt(8)
    v_mfma_f32_16x16x32_bf16 v[116:119], v[80:83], a[24:27], v[116:119]
    ds_read_b64_tr_b16 v[40:41], v16 offset:16384
    buffer_load_dwordx4 a[68:71], v1, s[32:35], s62 offen offset:1024 sc1
    v_mfma_f32_16x16x32_bf16 v[116:119], v[84:87], a[28:31], v[116:119]
    ds_read_b64_tr_b16 v[42:43], v16 offset:17408
    v_mfma_f32_16x16x32_bf16 v[112:115], v[84:87], a[20:23], v[112:115]
    ds_read_b64_tr_b16 v[44:45], v16 offset:20480
    v_mfma_f32_16x16x32_bf16 v[112:115], v[80:83], a[16:19], v[112:115]
    ds_read_b64_tr_b16 v[46:47], v16 offset:21504
    s_waitcnt lgkmcnt(8)
    v_mfma_f32_16x16x32_bf16 v[120:123], v[88:91], a[16:19], v[120:123]
    ds_read_b64_tr_b16 v[48:49], v17 offset:16384
    buffer_load_dwordx4 a[72:75], v12, s[32:35], s62 offen offset:0 sc1
    v_mfma_f32_16x16x32_bf16 v[120:123], v[92:95], a[20:23], v[120:123]
    ds_read_b64_tr_b16 v[50:51], v17 offset:17408
    v_mfma_f32_16x16x32_bf16 v[124:127], v[92:95], a[28:31], v[124:127]
    ds_read_b64_tr_b16 v[52:53], v17 offset:20480
    v_mfma_f32_16x16x32_bf16 v[124:127], v[88:91], a[24:27], v[124:127]
    ds_read_b64_tr_b16 v[54:55], v17 offset:21504
    s_waitcnt lgkmcnt(8)
    v_mfma_f32_16x16x32_bf16 v[132:135], v[96:99], a[24:27], v[132:135]
    ds_read_b64_tr_b16 v[56:57], v18 offset:16384
    buffer_load_dwordx4 a[76:79], v12, s[32:35], s62 offen offset:1024 sc1
    v_mfma_f32_16x16x32_bf16 v[132:135], v[100:103], a[28:31], v[132:135]
    ds_read_b64_tr_b16 v[58:59], v18 offset:17408
    v_mfma_f32_16x16x32_bf16 v[128:131], v[100:103], a[20:23], v[128:131]
    ds_read_b64_tr_b16 v[60:61], v18 offset:20480
    v_mfma_f32_16x16x32_bf16 v[128:131], v[96:99], a[16:19], v[128:131]
    ds_read_b64_tr_b16 v[62:63], v18 offset:21504
    s_waitcnt vmcnt(8) lgkmcnt(8)
    v_mfma_f32_16x16x32_bf16 v[104:107], v[40:43], a[32:35], v[104:107]
    s_barrier
    ds_read_b64_tr_b16 v[64:65], v19 offset:16384
    buffer_load_dwordx4 a[80:83], v1, s[32:35], s62 offen offset:2048 sc1
    v_mfma_f32_16x16x32_bf16 v[104:107], v[44:47], a[36:39], v[104:107]
    ds_read_b64_tr_b16 v[66:67], v19 offset:17408
    v_mfma_f32_16x16x32_bf16 v[108:111], v[44:47], a[44:47], v[108:111]
    ds_read_b64_tr_b16 v[68:69], v19 offset:20480
    v_mfma_f32_16x16x32_bf16 v[108:111], v[40:43], a[40:43], v[108:111]
    ds_read_b64_tr_b16 v[70:71], v19 offset:21504
    s_waitcnt lgkmcnt(8)
    v_mfma_f32_16x16x32_bf16 v[116:119], v[48:51], a[40:43], v[116:119]
    ds_read_b64_tr_b16 v[72:73], v16 offset:24576
    buffer_load_dwordx4 a[84:87], v1, s[32:35], s62 offen offset:3072 sc1
    v_mfma_f32_16x16x32_bf16 v[116:119], v[52:55], a[44:47], v[116:119]
    ds_read_b64_tr_b16 v[74:75], v16 offset:25600
    v_mfma_f32_16x16x32_bf16 v[112:115], v[52:55], a[36:39], v[112:115]
    ds_read_b64_tr_b16 v[76:77], v16 offset:28672
    v_mfma_f32_16x16x32_bf16 v[112:115], v[48:51], a[32:35], v[112:115]
    ds_read_b64_tr_b16 v[78:79], v16 offset:29696
    s_waitcnt lgkmcnt(8)
    v_mfma_f32_16x16x32_bf16 v[120:123], v[56:59], a[32:35], v[120:123]
    ds_read_b64_tr_b16 v[80:81], v17 offset:24576
    buffer_load_dwordx4 a[88:91], v12, s[32:35], s62 offen offset:2048 sc1
    v_mfma_f32_16x16x32_bf16 v[120:123], v[60:63], a[36:39], v[120:123]
    ds_read_b64_tr_b16 v[82:83], v17 offset:25600
    v_mfma_f32_16x16x32_bf16 v[124:127], v[60:63], a[44:47], v[124:127]
    ds_read_b64_tr_b16 v[84:85], v17 offset:28672
    v_mfma_f32_16x16x32_bf16 v[124:127], v[56:59], a[40:43], v[124:127]
    ds_read_b64_tr_b16 v[86:87], v17 offset:29696
    s_waitcnt lgkmcnt(8)
    v_mfma_f32_16x16x32_bf16 v[132:135], v[64:67], a[40:43], v[132:135]
    ds_read_b64_tr_b16 v[88:89], v18 offset:24576
    buffer_load_dwordx4 a[92:95], v12, s[32:35], s62 offen offset:3072 sc1
    v_mfma_f32_16x16x32_bf16 v[132:135], v[68:71], a[44:47], v[132:135]
    ds_read_b64_tr_b16 v[90:91], v18 offset:25600
    s_add_u32 s62, s62, 4096
    v_mfma_f32_16x16x32_bf16 v[128:131], v[68:71], a[36:39], v[128:131]
    ds_read_b64_tr_b16 v[92:93], v18 offset:28672
    v_mfma_f32_16x16x32_bf16 v[128:131], v[64:67], a[32:35], v[128:131]
    ds_read_b64_tr_b16 v[94:95], v18 offset:29696
    s_waitcnt vmcnt(8) lgkmcnt(8)
    v_mfma_f32_16x16x32_bf16 v[104:107], v[72:75], a[48:51], v[104:107]
    ds_read_b64_tr_b16 v[96:97], v19 offset:24576
    buffer_load_dwordx4 a[96:99], v1, s[32:35], s62 offen offset:0 sc1
    v_mfma_f32_16x16x32_bf16 v[104:107], v[76:79], a[52:55], v[104:107]
    ds_read_b64_tr_b16 v[98:99], v19 offset:25600
    v_add_f32 v136, v136, v138
    v_mfma_f32_16x16x32_bf16 v[108:111], v[76:79], a[60:63], v[108:111]
    ds_read_b64_tr_b16 v[100:101], v19 offset:28672
    v_add_f32 v140, v140, v142
    v_mfma_f32_16x16x32_bf16 v[108:111], v[72:75], a[56:59], v[108:111]
    ds_read_b64_tr_b16 v[102:103], v19 offset:29696
    s_waitcnt lgkmcnt(8)
    v_add_f32 v28, v136, v140
    v_mfma_f32_16x16x32_bf16 v[116:119], v[80:83], a[56:59], v[116:119]
    ds_read_b64_tr_b16 v[40:41], v16 offset:32768
    buffer_load_dwordx4 a[100:103], v1, s[32:35], s62 offen offset:1024 sc1
    v_mfma_f32_16x16x32_bf16 v[116:119], v[84:87], a[60:63], v[116:119]
    ds_read_b64_tr_b16 v[42:43], v16 offset:33792
    v_mov_b32 v4, v28
    v_mfma_f32_16x16x32_bf16 v[112:115], v[84:87], a[52:55], v[112:115]
    ds_read_b64_tr_b16 v[44:45], v16 offset:36864
    v_permlane16_swap_b32 v28, v4
    v_mfma_f32_16x16x32_bf16 v[112:115], v[80:83], a[48:51], v[112:115]
    ds_read_b64_tr_b16 v[46:47], v16 offset:37888
    s_waitcnt lgkmcnt(8)
    v_add_f32 v28, v28, v4
    v_mfma_f32_16x16x32_bf16 v[120:123], v[88:91], a[48:51], v[120:123]
    ds_read_b64_tr_b16 v[48:49], v17 offset:32768
    buffer_load_dwordx4 a[104:107], v12, s[32:35], s62 offen offset:0 sc1
    v_mfma_f32_16x16x32_bf16 v[120:123], v[92:95], a[52:55], v[120:123]
    ds_read_b64_tr_b16 v[50:51], v17 offset:33792
    v_mov_b32 v4, v28
    v_mfma_f32_16x16x32_bf16 v[124:127], v[92:95], a[60:63], v[124:127]
    ds_read_b64_tr_b16 v[52:53], v17 offset:36864
    v_permlane32_swap_b32 v28, v4
    v_mfma_f32_16x16x32_bf16 v[124:127], v[88:91], a[56:59], v[124:127]
    ds_read_b64_tr_b16 v[54:55], v17 offset:37888
    s_waitcnt lgkmcnt(8)
    v_add_f32 v28, v28, v4
    v_mfma_f32_16x16x32_bf16 v[132:135], v[96:99], a[56:59], v[132:135]
    ds_read_b64_tr_b16 v[56:57], v18 offset:32768
    buffer_load_dwordx4 a[108:111], v12, s[32:35], s62 offen offset:1024 sc1
    v_mfma_f32_16x16x32_bf16 v[132:135], v[100:103], a[60:63], v[132:135]
    ds_read_b64_tr_b16 v[58:59], v18 offset:33792
    v_accvgpr_read_b32 v4, a238
    v_mfma_f32_16x16x32_bf16 v[128:131], v[100:103], a[52:55], v[128:131]
    ds_read_b64_tr_b16 v[60:61], v18 offset:36864
    v_fma_f32 v28, v28, s57, -v4
    v_mfma_f32_16x16x32_bf16 v[128:131], v[96:99], a[48:51], v[128:131]
    ds_read_b64_tr_b16 v[62:63], v18 offset:37888
    s_waitcnt vmcnt(8) lgkmcnt(8)
    v_add_f32 v137, v137, v139
    v_mfma_f32_16x16x32_bf16 v[104:107], v[40:43], a[64:67], v[104:107]
    ds_read_b64_tr_b16 v[64:65], v19 offset:32768
    buffer_load_dwordx4 a[112:115], v1, s[32:35], s62 offen offset:2048 sc1
    v_mfma_f32_16x16x32_bf16 v[104:107], v[44:47], a[68:71], v[104:107]
    ds_read_b64_tr_b16 v[66:67], v19 offset:33792
    v_add_f32 v141, v141, v143
    v_mfma_f32_16x16x32_bf16 v[108:111], v[44:47], a[76:79], v[108:111]
    ds_read_b64_tr_b16 v[68:69], v19 offset:36864
    v_add_f32 v29, v137, v141
    v_mfma_f32_16x16x32_bf16 v[108:111], v[40:43], a[72:75], v[108:111]
    ds_read_b64_tr_b16 v[70:71], v19 offset:37888
    s_waitcnt lgkmcnt(8)
    v_mov_b32 v4, v29
    v_mfma_f32_16x16x32_bf16 v[116:119], v[48:51], a[72:75], v[116:119]
    ds_read_b64_tr_b16 v[72:73], v16 offset:40960
    buffer_load_dwordx4 a[116:119], v1, s[32:35], s62 offen offset:3072 sc1
    v_mfma_f32_16x16x32_bf16 v[116:119], v[52:55], a[76:79], v[116:119]
    ds_read_b64_tr_b16 v[74:75], v16 offset:41984
    v_permlane16_swap_b32 v29, v4
    v_mfma_f32_16x16x32_bf16 v[112:115], v[52:55], a[68:71], v[112:115]
    ds_read_b64_tr_b16 v[76:77], v16 offset:45056
    v_add_f32 v29, v29, v4
    v_mfma_f32_16x16x32_bf16 v[112:115], v[48:51], a[64:67], v[112:115]
    ds_read_b64_tr_b16 v[78:79], v16 offset:46080
    s_waitcnt lgkmcnt(8)
    v_mov_b32 v4, v29
    v_mfma_f32_16x16x32_bf16 v[120:123], v[56:59], a[64:67], v[120:123]
    ds_read_b64_tr_b16 v[80:81], v17 offset:40960
    buffer_load_dwordx4 a[120:123], v12, s[32:35], s62 offen offset:2048 sc1
    v_mfma_f32_16x16x32_bf16 v[120:123], v[60:63], a[68:71], v[120:123]
    ds_read_b64_tr_b16 v[82:83], v17 offset:41984
    v_permlane32_swap_b32 v29, v4
    v_add_f32 v29, v29, v4
    v_mfma_f32_16x16x32_bf16 v[124:127], v[60:63], a[76:79], v[124:127]
    ds_read_b64_tr_b16 v[84:85], v17 offset:45056
    v_accvgpr_read_b32 v4, a239
    v_fma_f32 v29, v29, s57, -v4
    v_mfma_f32_16x16x32_bf16 v[124:127], v[56:59], a[72:75], v[124:127]
    ds_read_b64_tr_b16 v[86:87], v17 offset:46080
    s_waitcnt lgkmcnt(8)
    v_mov_b32 v8, 0x3727c5ac
    s_mov_b32 s57, 0x3a800000
    v_mfma_f32_16x16x32_bf16 v[132:135], v[64:67], a[72:75], v[132:135]
    ds_read_b64_tr_b16 v[88:89], v18 offset:40960
    buffer_load_dwordx4 a[124:127], v12, s[32:35], s62 offen offset:3072 sc1
    v_mfma_f32_16x16x32_bf16 v[132:135], v[68:71], a[76:79], v[132:135]
    ds_read_b64_tr_b16 v[90:91], v18 offset:41984
    s_add_u32 s62, s62, 4096
    v_mfma_f32_16x16x32_bf16 v[128:131], v[68:71], a[68:71], v[128:131]
    ds_read_b64_tr_b16 v[92:93], v18 offset:45056
    v_mfma_f32_16x16x32_bf16 v[128:131], v[64:67], a[64:67], v[128:131]
    ds_read_b64_tr_b16 v[94:95], v18 offset:46080
    s_waitcnt vmcnt(8) lgkmcnt(8)
    v_mfma_f32_16x16x32_bf16 v[104:107], v[72:75], a[80:83], v[104:107]
    ds_read_b64_tr_b16 v[96:97], v19 offset:40960
    v_mfma_f32_16x16x32_bf16 v[104:107], v[76:79], a[84:87], v[104:107]
    ds_read_b64_tr_b16 v[98:99], v19 offset:41984
    v_mfma_f32_16x16x32_bf16 v[108:111], v[76:79], a[92:95], v[108:111]
    ds_read_b64_tr_b16 v[100:101], v19 offset:45056
    v_mfma_f32_16x16x32_bf16 v[108:111], v[72:75], a[88:91], v[108:111]
    ds_read_b64_tr_b16 v[102:103], v19 offset:46080
    s_waitcnt lgkmcnt(8)
    v_mfma_f32_16x16x32_bf16 v[116:119], v[80:83], a[88:91], v[116:119]
    ds_read_b64_tr_b16 v[40:41], v16 offset:49152
    v_mfma_f32_16x16x32_bf16 v[116:119], v[84:87], a[92:95], v[116:119]
    ds_read_b64_tr_b16 v[42:43], v16 offset:50176
    v_mfma_f32_16x16x32_bf16 v[112:115], v[84:87], a[84:87], v[112:115]
    ds_read_b64_tr_b16 v[44:45], v16 offset:53248
    v_mfma_f32_16x16x32_bf16 v[112:115], v[80:83], a[80:83], v[112:115]
    ds_read_b64_tr_b16 v[46:47], v16 offset:54272
    s_waitcnt lgkmcnt(8)
    v_mfma_f32_16x16x32_bf16 v[120:123], v[88:91], a[80:83], v[120:123]
    ds_read_b64_tr_b16 v[48:49], v17 offset:49152
    v_mfma_f32_16x16x32_bf16 v[120:123], v[92:95], a[84:87], v[120:123]
    ds_read_b64_tr_b16 v[50:51], v17 offset:50176
    v_mfma_f32_16x16x32_bf16 v[124:127], v[92:95], a[92:95], v[124:127]
    ds_read_b64_tr_b16 v[52:53], v17 offset:53248
    v_mfma_f32_16x16x32_bf16 v[124:127], v[88:91], a[88:91], v[124:127]
    ds_read_b64_tr_b16 v[54:55], v17 offset:54272
    s_waitcnt lgkmcnt(8)
    v_mfma_f32_16x16x32_bf16 v[132:135], v[96:99], a[88:91], v[132:135]
    ds_read_b64_tr_b16 v[56:57], v18 offset:49152
    v_mfma_f32_16x16x32_bf16 v[132:135], v[100:103], a[92:95], v[132:135]
    ds_read_b64_tr_b16 v[58:59], v18 offset:50176
    v_mfma_f32_16x16x32_bf16 v[128:131], v[100:103], a[84:87], v[128:131]
    ds_read_b64_tr_b16 v[60:61], v18 offset:53248
    v_mfma_f32_16x16x32_bf16 v[128:131], v[96:99], a[80:83], v[128:131]
    ds_read_b64_tr_b16 v[62:63], v18 offset:54272
    s_waitcnt vmcnt(4) lgkmcnt(8)
    v_mfma_f32_16x16x32_bf16 v[104:107], v[40:43], a[96:99], v[104:107]
    ds_read_b64_tr_b16 v[64:65], v19 offset:49152
    v_mfma_f32_16x16x32_bf16 v[104:107], v[44:47], a[100:103], v[104:107]
    ds_read_b64_tr_b16 v[66:67], v19 offset:50176
    v_mfma_f32_16x16x32_bf16 v[108:111], v[44:47], a[108:111], v[108:111]
    ds_read_b64_tr_b16 v[68:69], v19 offset:53248
    v_mfma_f32_16x16x32_bf16 v[108:111], v[40:43], a[104:107], v[108:111]
    ds_read_b64_tr_b16 v[70:71], v19 offset:54272
    s_waitcnt lgkmcnt(8)
    v_mfma_f32_16x16x32_bf16 v[116:119], v[48:51], a[104:107], v[116:119]
    ds_read_b64_tr_b16 v[72:73], v16 offset:57344
    v_mfma_f32_16x16x32_bf16 v[116:119], v[52:55], a[108:111], v[116:119]
    ds_read_b64_tr_b16 v[74:75], v16 offset:58368
    v_mfma_f32_16x16x32_bf16 v[112:115], v[52:55], a[100:103], v[112:115]
    ds_read_b64_tr_b16 v[76:77], v16 offset:61440
    v_mfma_f32_16x16x32_bf16 v[112:115], v[48:51], a[96:99], v[112:115]
    ds_read_b64_tr_b16 v[78:79], v16 offset:62464
    s_waitcnt lgkmcnt(8)
    v_mfma_f32_16x16x32_bf16 v[120:123], v[56:59], a[96:99], v[120:123]
    ds_read_b64_tr_b16 v[80:81], v17 offset:57344
    v_mfma_f32_16x16x32_bf16 v[120:123], v[60:63], a[100:103], v[120:123]
    ds_read_b64_tr_b16 v[82:83], v17 offset:58368
    v_mfma_f32_16x16x32_bf16 v[124:127], v[60:63], a[108:111], v[124:127]
    ds_read_b64_tr_b16 v[84:85], v17 offset:61440
    v_mfma_f32_16x16x32_bf16 v[124:127], v[56:59], a[104:107], v[124:127]
    ds_read_b64_tr_b16 v[86:87], v17 offset:62464
    s_waitcnt lgkmcnt(8)
    v_mfma_f32_16x16x32_bf16 v[132:135], v[64:67], a[104:107], v[132:135]
    ds_read_b64_tr_b16 v[88:89], v18 offset:57344
    v_mfma_f32_16x16x32_bf16 v[132:135], v[68:71], a[108:111], v[132:135]
    ds_read_b64_tr_b16 v[90:91], v18 offset:58368
    v_mfma_f32_16x16x32_bf16 v[128:131], v[68:71], a[100:103], v[128:131]
    ds_read_b64_tr_b16 v[92:93], v18 offset:61440
    v_mfma_f32_16x16x32_bf16 v[128:131], v[64:67], a[96:99], v[128:131]
    ds_read_b64_tr_b16 v[94:95], v18 offset:62464
    s_waitcnt vmcnt(0) lgkmcnt(8)
    v_mfma_f32_16x16x32_bf16 v[104:107], v[72:75], a[112:115], v[104:107]
    ds_read_b64_tr_b16 v[96:97], v19 offset:57344
    v_mfma_f32_16x16x32_bf16 v[104:107], v[76:79], a[116:119], v[104:107]
    ds_read_b64_tr_b16 v[98:99], v19 offset:58368
    v_mfma_f32_16x16x32_bf16 v[108:111], v[76:79], a[124:127], v[108:111]
    ds_read_b64_tr_b16 v[100:101], v19 offset:61440
    v_mfma_f32_16x16x32_bf16 v[108:111], v[72:75], a[120:123], v[108:111]
    ds_read_b64_tr_b16 v[102:103], v19 offset:62464
    s_waitcnt lgkmcnt(8)
    v_mfma_f32_16x16x32_bf16 v[116:119], v[80:83], a[120:123], v[116:119]
    v_mfma_f32_16x16x32_bf16 v[116:119], v[84:87], a[124:127], v[116:119]
    v_mfma_f32_16x16x32_bf16 v[112:115], v[84:87], a[116:119], v[112:115]
    v_mfma_f32_16x16x32_bf16 v[112:115], v[80:83], a[112:115], v[112:115]
    s_waitcnt lgkmcnt(4)
    v_mfma_f32_16x16x32_bf16 v[120:123], v[88:91], a[112:115], v[120:123]
    v_mfma_f32_16x16x32_bf16 v[120:123], v[92:95], a[116:119], v[120:123]
    v_mfma_f32_16x16x32_bf16 v[124:127], v[92:95], a[124:127], v[124:127]
    v_mfma_f32_16x16x32_bf16 v[124:127], v[88:91], a[120:123], v[124:127]
    s_waitcnt lgkmcnt(0)
    v_mfma_f32_16x16x32_bf16 v[132:135], v[96:99], a[120:123], v[132:135]
    v_mfma_f32_16x16x32_bf16 v[132:135], v[100:103], a[124:127], v[132:135]
    v_mfma_f32_16x16x32_bf16 v[128:131], v[100:103], a[116:119], v[128:131]
    v_mfma_f32_16x16x32_bf16 v[128:131], v[96:99], a[112:115], v[128:131]
    v_pk_add_f32 v[148:149], v[104:105], v[28:29] op_sel_hi:[1,0]
    v_pk_add_f32 v[150:151], v[106:107], v[28:29] op_sel_hi:[1,0]
    v_cvt_pk_bf16_f32 v40, v148, v149
    v_cvt_pk_bf16_f32 v41, v150, v151
    v_pk_mul_f32 v[144:145], v[148:149], v[148:149]
    v_pk_fma_f32 v[144:145], v[150:151], v[150:151], v[144:145]
    v_pk_add_f32 v[152:153], v[112:113], v[28:29] op_sel_hi:[1,0]
    v_pk_add_f32 v[154:155], v[114:115], v[28:29] op_sel_hi:[1,0]
    v_cvt_pk_bf16_f32 v42, v152, v153
    v_cvt_pk_bf16_f32 v43, v154, v155
    buffer_store_dwordx4 v[40:43], v1, s[28:31], s65 offen offset:0 sc1
    v_pk_fma_f32 v[144:145], v[152:153], v[152:153], v[144:145]
    v_pk_fma_f32 v[144:145], v[154:155], v[154:155], v[144:145]
    v_pk_add_f32 v[148:149], v[120:121], v[28:29] op_sel_hi:[1,0]
    v_pk_add_f32 v[150:151], v[122:123], v[28:29] op_sel_hi:[1,0]
    v_cvt_pk_bf16_f32 v44, v148, v149
    v_cvt_pk_bf16_f32 v45, v150, v151
    v_pk_fma_f32 v[144:145], v[148:149], v[148:149], v[144:145]
    v_pk_fma_f32 v[144:145], v[150:151], v[150:151], v[144:145]
    v_pk_add_f32 v[152:153], v[128:129], v[28:29] op_sel_hi:[1,0]
    v_pk_add_f32 v[154:155], v[130:131], v[28:29] op_sel_hi:[1,0]
    v_cvt_pk_bf16_f32 v46, v152, v153
    v_cvt_pk_bf16_f32 v47, v154, v155
    buffer_store_dwordx4 v[44:47], v1, s[28:31], s65 offen offset:1024 sc1
    v_pk_fma_f32 v[144:145], v[152:153], v[152:153], v[144:145]
    v_pk_fma_f32 v[144:145], v[154:155], v[154:155], v[144:145]
    v_pk_add_f32 v[148:149], v[108:109], v[28:29] op_sel:[0,1]
    v_pk_add_f32 v[150:151], v[110:111], v[28:29] op_sel:[0,1]
    v_cvt_pk_bf16_f32 v48, v148, v149
    v_cvt_pk_bf16_f32 v49, v150, v151
    v_pk_mul_f32 v[146:147], v[148:149], v[148:149]
    v_pk_fma_f32 v[146:147], v[150:151], v[150:151], v[146:147]
    v_pk_add_f32 v[152:153], v[116:117], v[28:29] op_sel:[0,1]
    v_pk_add_f32 v[154:155], v[118:119], v[28:29] op_sel:[0,1]
    v_cvt_pk_bf16_f32 v50, v152, v153
    v_cvt_pk_bf16_f32 v51, v154, v155
    buffer_store_dwordx4 v[48:51], v12, s[28:31], s65 offen offset:0 sc1
    v_pk_fma_f32 v[146:147], v[152:153], v[152:153], v[146:147]
    v_pk_fma_f32 v[146:147], v[154:155], v[154:155], v[146:147]
    v_pk_add_f32 v[148:149], v[124:125], v[28:29] op_sel:[0,1]
    v_pk_add_f32 v[150:151], v[126:127], v[28:29] op_sel:[0,1]
    v_cvt_pk_bf16_f32 v52, v148, v149
    v_cvt_pk_bf16_f32 v53, v150, v151
    v_pk_fma_f32 v[146:147], v[148:149], v[148:149], v[146:147]
    v_pk_fma_f32 v[146:147], v[150:151], v[150:151], v[146:147]
    v_pk_add_f32 v[152:153], v[132:133], v[28:29] op_sel:[0,1]
    v_pk_add_f32 v[154:155], v[134:135], v[28:29] op_sel:[0,1]
    v_cvt_pk_bf16_f32 v54, v152, v153
    v_cvt_pk_bf16_f32 v55, v154, v155
    buffer_store_dwordx4 v[52:55], v12, s[28:31], s65 offen offset:1024 sc1
    v_pk_fma_f32 v[146:147], v[152:153], v[152:153], v[146:147]
    v_pk_fma_f32 v[146:147], v[154:155], v[154:155], v[146:147]
    v_add_f32 v144, v144, v145
    v_add_f32 v146, v146, v147
    s_nop 1
    v_permlane16_swap_b32 v144, v146
    v_add_f32 v144, v144, v146
    v_mov_b32 v145, v144
    s_nop 1
    v_permlane32_swap_b32 v144, v145
    v_add_f32 v4, v144, v145
    s_mov_b32 exec_hi, 0
    buffer_store_dword v4, v36, s[48:51], s3 offen sc1
    s_mov_b32 exec_hi, -1
    v_cvt_pk_bf16_f32 v56, v104, v105
    v_cvt_pk_bf16_f32 v57, v106, v107
    v_cvt_pk_bf16_f32 v58, v112, v113
    v_cvt_pk_bf16_f32 v59, v114, v115
    v_cvt_pk_bf16_f32 v60, v120, v121
    v_cvt_pk_bf16_f32 v61, v122, v123
    v_cvt_pk_bf16_f32 v62, v128, v129
    v_cvt_pk_bf16_f32 v63, v130, v131
    v_cvt_pk_bf16_f32 v64, v108, v109
    v_cvt_pk_bf16_f32 v65, v110, v111
    v_cvt_pk_bf16_f32 v66, v116, v117
    v_cvt_pk_bf16_f32 v67, v118, v119
    v_cvt_pk_bf16_f32 v68, v124, v125
    v_cvt_pk_bf16_f32 v69, v126, v127
    v_cvt_pk_bf16_f32 v70, v132, v133
    v_cvt_pk_bf16_f32 v71, v134, v135
    v_accvgpr_write_b32 a240, v56
    v_accvgpr_write_b32 a241, v57
    v_accvgpr_write_b32 a242, v58
    v_accvgpr_write_b32 a243, v59
    v_accvgpr_write_b32 a244, v60
    v_accvgpr_write_b32 a245, v61
    v_accvgpr_write_b32 a246, v62
    v_accvgpr_write_b32 a247, v63
    v_accvgpr_write_b32 a248, v64
    v_accvgpr_write_b32 a249, v65
    v_accvgpr_write_b32 a250, v66
    v_accvgpr_write_b32 a251, v67
    v_accvgpr_write_b32 a252, v68
    v_accvgpr_write_b32 a253, v69
    v_accvgpr_write_b32 a254, v70
    v_accvgpr_write_b32 a255, v71
    v_pk_mov_b32 v[32:33], 0, 0
    v_pk_mov_b32 v[34:35], 0, 0
    v_pk_mov_b32 v[36:37], 0, 0
    v_pk_mov_b32 v[38:39], 0, 0
    v_pk_mov_b32 v[40:41], 0, 0
    v_pk_mov_b32 v[42:43], 0, 0
    v_pk_mov_b32 v[44:45], 0, 0
    v_pk_mov_b32 v[46:47], 0, 0
    v_pk_mov_b32 v[48:49], 0, 0
    v_pk_mov_b32 v[50:51], 0, 0
    v_pk_mov_b32 v[52:53], 0, 0
    v_pk_mov_b32 v[54:55], 0, 0
    v_pk_mov_b32 v[56:57], 0, 0
    v_pk_mov_b32 v[58:59], 0, 0
    v_pk_mov_b32 v[60:61], 0, 0
    v_pk_mov_b32 v[62:63], 0, 0
    v_pk_mov_b32 v[64:65], 0, 0
    v_pk_mov_b32 v[66:67], 0, 0
    v_pk_mov_b32 v[68:69], 0, 0
    v_pk_mov_b32 v[70:71], 0, 0
    v_pk_mov_b32 v[72:73], 0, 0
    v_pk_mov_b32 v[74:75], 0, 0
    v_pk_mov_b32 v[76:77], 0, 0
    v_pk_mov_b32 v[78:79], 0, 0
    v_pk_mov_b32 v[80:81], 0, 0
    v_pk_mov_b32 v[82:83], 0, 0
    v_pk_mov_b32 v[84:85], 0, 0
    v_pk_mov_b32 v[86:87], 0, 0
    v_pk_mov_b32 v[88:89], 0, 0
    v_pk_mov_b32 v[90:91], 0, 0
    v_pk_mov_b32 v[92:93], 0, 0
    v_pk_mov_b32 v[94:95], 0, 0
    v_pk_mov_b32 v[96:97], 0, 0
    v_pk_mov_b32 v[98:99], 0, 0
    v_pk_mov_b32 v[100:101], 0, 0
    v_pk_mov_b32 v[102:103], 0, 0
    v_pk_mov_b32 v[104:105], 0, 0
    v_pk_mov_b32 v[106:107], 0, 0
    v_pk_mov_b32 v[108:109], 0, 0
    v_pk_mov_b32 v[110:111], 0, 0
    v_pk_mov_b32 v[112:113], 0, 0
    v_pk_mov_b32 v[114:115], 0, 0
    v_pk_mov_b32 v[116:117], 0, 0
    v_pk_mov_b32 v[118:119], 0, 0
    v_pk_mov_b32 v[120:121], 0, 0
    v_pk_mov_b32 v[122:123], 0, 0
    v_pk_mov_b32 v[124:125], 0, 0
    v_pk_mov_b32 v[126:127], 0, 0
    v_pk_mov_b32 v[128:129], 0, 0
    v_pk_mov_b32 v[130:131], 0, 0
    v_pk_mov_b32 v[132:133], 0, 0
    v_pk_mov_b32 v[134:135], 0, 0
    v_pk_mov_b32 v[136:137], 0, 0
    v_pk_mov_b32 v[138:139], 0, 0
    v_pk_mov_b32 v[140:141], 0, 0
    v_pk_mov_b32 v[142:143], 0, 0
    v_pk_mov_b32 v[144:145], 0, 0
    v_pk_mov_b32 v[146:147], 0, 0
    v_pk_mov_b32 v[148:149], 0, 0
    v_pk_mov_b32 v[150:151], 0, 0
    v_pk_mov_b32 v[152:153], 0, 0
    v_pk_mov_b32 v[154:155], 0, 0
    s_lshl_b32 s62, s72, 11
    s_waitcnt vmcnt(0)
    buffer_store_dword v3, v2, s[48:51], s61 offen sc1
    s_add_u32 m0, s70, 0
    s_nop 0
    buffer_load_dwordx4 v21, s[40:43], s68 offen offset:0 lds
    buffer_load_dwordx4 v22, s[40:43], s68 offen offset:1024 lds
    buffer_load_dwordx4 v23, s[40:43], s68 offen offset:2048 lds
    buffer_load_dwordx4 v24, s[40:43], s68 offen offset:3072 lds
    s_add_u32 m0, m0, 4096
    s_nop 0
    buffer_load_dwordx4 v25, s[40:43], s68 offen offset:0 lds
    buffer_load_dwordx4 v26, s[40:43], s68 offen offset:1024 lds
    buffer_load_dwordx4 v27, s[40:43], s68 offen offset:2048 lds
    s_add_u32 s68, s68, 458752
    s_add_u32 m0, s70, 28672
    s_nop 0
    buffer_load_dwordx4 v21, s[40:43], s68 offen offset:0 lds
    buffer_load_dwordx4 v22, s[40:43], s68 offen offset:1024 lds
    buffer_load_dwordx4 v23, s[40:43], s68 offen offset:2048 lds
    buffer_load_dwordx4 v24, s[40:43], s68 offen offset:3072 lds
    s_add_u32 m0, m0, 4096
    s_nop 0
    buffer_load_dwordx4 v25, s[40:43], s68 offen offset:0 lds
    buffer_load_dwordx4 v26, s[40:43], s68 offen offset:1024 lds
    buffer_load_dwordx4 v27, s[40:43], s68 offen offset:2048 lds
    s_add_u32 s68, s68, 458752
    s_add_u32 s70, s69, 106496
    v_bfe_u32 v4, v0, 2, 3
    v_lshrrev_b32 v5, 1, v4
    v_lshlrev_b32 v5, 5, v5
    v_lshl_add_u32 v4, v4, 7, v5
    v_lshrrev_b32 v5, 5, v0
    v_lshl_add_u32 v4, v5, 12, v4
    v_and_b32 v5, 3, v0
    v_lshl_add_u32 v16, v5, 3, v4
    v_xor_b32 v17, 32, v16
    v_xor_b32 v18, 64, v16
    v_xor_b32 v19, 0x60, v16
    s_add_u32 s32, s26, 0x1400000
    s_addc_u32 s33, s27, 0
    s_mov_b32 s34, 0xe00000
    s_mov_b32 s35, 0x20000
    s_add_u32 s36, s26, 0x2400000
    s_addc_u32 s37, s27, 0
    s_mov_b32 s38, 0x1000000
    s_mov_b32 s39, 0x20000
    s_bfe_u32 s65, s53, 0x10002
    s_lshl_b32 s65, s65, 1
    s_lshr_b32 s56, s54, 3
    s_add_u32 s65, s65, s56
    s_and_b32 s61, s55, 0x5c0
    s_lshl_b32 s61, s61, 6
    s_lshl_b32 s56, s65, 10
    s_add_u32 s61, s61, s56
    s_add_u32 s61, s61, 786432
    s_xor_b32 s63, s55, 512
    s_mul_i32 s63, s63, 7168
    s_mul_i32 s56, s65, 28672
    s_add_u32 s63, s63, s56
    s_mul_i32 s64, s72, 7168
    s_lshr_b32 s56, s66, 3
    s_mul_i32 s56, s56, 48
    s_add_u32 s56, s56, s66
    s_lshl_b32 s56, s56, 9
    s_add_u32 s64, s64, s56
    v_and_b32 v9, 7, v0
    v_lshlrev_b32 v9, 7, v9
    v_bfe_u32 v4, v0, 3, 1
    v_lshl_add_u32 v9, v4, 15, v9
    s_mov_b32 s60, 1048576
    v_lshlrev_b32 v5, 7, v0
    s_mov_b64 exec, 65535
    s_mov_b32 exec_lo, -1
    s_branch F_hpoll_go
F_hpoll:

F_hpoll_go:
    buffer_load_dword v4, v5, s[48:51], s67 offen sc1
    s_sub_u32 s60, s60, 1
    s_waitcnt vmcnt(0)
    v_cmp_gt_u32 vcc, 1, v4
    s_cbranch_scc1 F_hpoll_done
    s_cbranch_vccnz F_hpoll
F_hpoll_done:
    s_mov_b64 exec, -1
    s_waitcnt vmcnt(0)
    buffer_load_dwordx4 a[0:3], v1, s[28:31], s62 offen offset:0 sc1
    buffer_load_dwordx4 a[4:7], v1, s[28:31], s62 offen offset:1024 sc1
    buffer_load_dwordx4 a[8:11], v12, s[28:31], s62 offen offset:0 sc1
    buffer_load_dwordx4 a[12:15], v12, s[28:31], s62 offen offset:1024 sc1
    buffer_load_dwordx4 a[16:19], v13, s[28:31], s62 offen offset:0 sc1
    buffer_load_dwordx4 a[20:23], v13, s[28:31], s62 offen offset:1024 sc1
    buffer_load_dwordx4 a[24:27], v14, s[28:31], s62 offen offset:0 sc1
    buffer_load_dwordx4 a[28:31], v14, s[28:31], s62 offen offset:1024 sc1
    s_add_u32 s62, s62, 2048
    buffer_load_dwordx2 a[144:145], v20, s[48:51], s73 offen offset:0 sc1
    buffer_load_dwordx2 a[146:147], v20, s[48:51], s73 offen offset:128 sc1
    buffer_load_dwordx2 a[148:149], v20, s[48:51], s73 offen offset:256 sc1
    buffer_load_dwordx2 a[150:151], v20, s[48:51], s73 offen offset:384 sc1
    buffer_load_dwordx2 a[152:153], v20, s[48:51], s73 offen offset:2048 sc1
    buffer_load_dwordx2 a[154:155], v20, s[48:51], s73 offen offset:2176 sc1
    buffer_load_dwordx2 a[156:157], v20, s[48:51], s73 offen offset:2304 sc1
    buffer_load_dwordx2 a[158:159], v20, s[48:51], s73 offen offset:2432 sc1
    s_barrier
    ds_read_b64_tr_b16 a[96:97], v15 offset:0
    ds_read_b64_tr_b16 a[98:99], v15 offset:3584
    ds_read_b64_tr_b16 a[100:101], v15 offset:7168
    ds_read_b64_tr_b16 a[102:103], v15 offset:10752
    ds_read_b64_tr_b16 a[104:105], v15 offset:14336
    ds_read_b64_tr_b16 a[106:107], v15 offset:17920
    ds_read_b64_tr_b16 a[108:109], v15 offset:21504
    ds_read_b64_tr_b16 a[110:111], v15 offset:25088
    s_mov_b32 s59, 6
    s_waitcnt vmcnt(8) lgkmcnt(4)
.p2align 6
F_p4loop:
    v_mfma_f32_16x16x32_bf16 v[32:35], a[96:99], a[0:3], v[32:35]
    ds_read_b64_tr_b16 a[112:113], v15 offset:32
    v_mfma_f32_16x16x32_bf16 v[32:35], a[100:103], a[4:7], v[32:35]
    buffer_load_dwordx4 a[32:35], v1, s[28:31], s62 offen offset:0 sc1
    v_mfma_f32_16x16x32_bf16 v[36:39], a[100:103], a[12:15], v[36:39]
    ds_read_b64_tr_b16 a[114:115], v15 offset:3616
    v_mfma_f32_16x16x32_bf16 v[36:39], a[96:99], a[8:11], v[36:39]
    v_mfma_f32_16x16x32_bf16 v[40:43], a[96:99], a[16:19], v[40:43]
    ds_read_b64_tr_b16 a[116:117], v15 offset:7200
    v_mfma_f32_16x16x32_bf16 v[40:43], a[100:103], a[20:23], v[40:43]
    buffer_load_dwordx4 a[36:39], v1, s[28:31], s62 offen offset:1024 sc1
    v_mfma_f32_16x16x32_bf16 v[44:47], a[100:103], a[28:31], v[44:47]
    ds_read_b64_tr_b16 a[118:119], v15 offset:10784
    v_mfma_f32_16x16x32_bf16 v[44:47], a[96:99], a[24:27], v[44:47]
    s_waitcnt lgkmcnt(4)
    v_mfma_f32_16x16x32_bf16 v[60:63], a[104:107], a[24:27], v[60:63]
    ds_read_b64_tr_b16 a[120:121], v15 offset:14368
    v_mfma_f32_16x16x32_bf16 v[60:63], a[108:111], a[28:31], v[60:63]
    buffer_load_dwordx4 a[40:43], v12, s[28:31], s62 offen offset:0 sc1
    v_mfma_f32_16x16x32_bf16 v[56:59], a[108:111], a[20:23], v[56:59]
    ds_read_b64_tr_b16 a[122:123], v15 offset:17952
    v_mfma_f32_16x16x32_bf16 v[56:59], a[104:107], a[16:19], v[56:59]
    v_mfma_f32_16x16x32_bf16 v[52:55], a[104:107], a[8:11], v[52:55]
    ds_read_b64_tr_b16 a[124:125], v15 offset:21536
    v_mfma_f32_16x16x32_bf16 v[52:55], a[108:111], a[12:15], v[52:55]
    buffer_load_dwordx4 a[44:47], v12, s[28:31], s62 offen offset:1024 sc1
    v_mfma_f32_16x16x32_bf16 v[48:51], a[108:111], a[4:7], v[48:51]
    ds_read_b64_tr_b16 a[126:127], v15 offset:25120
    v_mfma_f32_16x16x32_bf16 v[48:51], a[104:107], a[0:3], v[48:51]
    s_waitcnt lgkmcnt(4)
    v_mfma_f32_16x16x32_bf16 v[64:67], a[112:115], a[0:3], v[64:67]
    ds_read_b64_tr_b16 a[96:97], v15 offset:64
    v_mfma_f32_16x16x32_bf16 v[64:67], a[116:119], a[4:7], v[64:67]
    buffer_load_dwordx4 a[48:51], v13, s[28:31], s62 offen offset:0 sc1
    v_mfma_f32_16x16x32_bf16 v[68:71], a[116:119], a[12:15], v[68:71]
    ds_read_b64_tr_b16 a[98:99], v15 offset:3648
    v_mfma_f32_16x16x32_bf16 v[68:71], a[112:115], a[8:11], v[68:71]
    v_mfma_f32_16x16x32_bf16 v[72:75], a[112:115], a[16:19], v[72:75]
    ds_read_b64_tr_b16 a[100:101], v15 offset:7232
    v_mfma_f32_16x16x32_bf16 v[72:75], a[116:119], a[20:23], v[72:75]
    buffer_load_dwordx4 a[52:55], v13, s[28:31], s62 offen offset:1024 sc1
    v_mfma_f32_16x16x32_bf16 v[76:79], a[116:119], a[28:31], v[76:79]
    ds_read_b64_tr_b16 a[102:103], v15 offset:10816
    v_mfma_f32_16x16x32_bf16 v[76:79], a[112:115], a[24:27], v[76:79]
    s_waitcnt lgkmcnt(4)
    v_mfma_f32_16x16x32_bf16 v[92:95], a[120:123], a[24:27], v[92:95]
    ds_read_b64_tr_b16 a[104:105], v15 offset:14400
    v_mfma_f32_16x16x32_bf16 v[92:95], a[124:127], a[28:31], v[92:95]
    buffer_load_dwordx4 a[56:59], v14, s[28:31], s62 offen offset:0 sc1
    v_mfma_f32_16x16x32_bf16 v[88:91], a[124:127], a[20:23], v[88:91]
    ds_read_b64_tr_b16 a[106:107], v15 offset:17984
    v_mfma_f32_16x16x32_bf16 v[88:91], a[120:123], a[16:19], v[88:91]
    v_mfma_f32_16x16x32_bf16 v[84:87], a[120:123], a[8:11], v[84:87]
    ds_read_b64_tr_b16 a[108:109], v15 offset:21568
    v_mfma_f32_16x16x32_bf16 v[84:87], a[124:127], a[12:15], v[84:87]
    buffer_load_dwordx4 a[60:63], v14, s[28:31], s62 offen offset:1024 sc1
    v_mfma_f32_16x16x32_bf16 v[80:83], a[124:127], a[4:7], v[80:83]
    ds_read_b64_tr_b16 a[110:111], v15 offset:25152
    v_mfma_f32_16x16x32_bf16 v[80:83], a[120:123], a[0:3], v[80:83]
    s_waitcnt lgkmcnt(4)
    v_mfma_f32_16x16x32_bf16 v[96:99], a[96:99], a[0:3], v[96:99]
    ds_read_b64_tr_b16 a[112:113], v15 offset:96
    v_mfma_f32_16x16x32_bf16 v[96:99], a[100:103], a[4:7], v[96:99]
    s_add_u32 s62, s62, 2048
    v_mfma_f32_16x16x32_bf16 v[100:103], a[100:103], a[12:15], v[100:103]
    ds_read_b64_tr_b16 a[114:115], v15 offset:3680
    v_mfma_f32_16x16x32_bf16 v[100:103], a[96:99], a[8:11], v[100:103]
    s_add_u32 m0, s70, 0
    v_mfma_f32_16x16x32_bf16 v[104:107], a[96:99], a[16:19], v[104:107]
    ds_read_b64_tr_b16 a[116:117], v15 offset:7264
    v_mfma_f32_16x16x32_bf16 v[104:107], a[100:103], a[20:23], v[104:107]
    buffer_load_dwordx4 v21, s[40:43], s68 offen offset:0 lds
    v_mfma_f32_16x16x32_bf16 v[108:111], a[100:103], a[28:31], v[108:111]
    ds_read_b64_tr_b16 a[118:119], v15 offset:10848
    v_mfma_f32_16x16x32_bf16 v[108:111], a[96:99], a[24:27], v[108:111]
    s_waitcnt lgkmcnt(4)
    v_mfma_f32_16x16x32_bf16 v[124:127], a[104:107], a[24:27], v[124:127]
    ds_read_b64_tr_b16 a[120:121], v15 offset:14432
    v_mfma_f32_16x16x32_bf16 v[124:127], a[108:111], a[28:31], v[124:127]
    buffer_load_dwordx4 v22, s[40:43], s68 offen offset:1024 lds
    v_mfma_f32_16x16x32_bf16 v[120:123], a[108:111], a[20:23], v[120:123]
    ds_read_b64_tr_b16 a[122:123], v15 offset:18016
    v_mfma_f32_16x16x32_bf16 v[120:123], a[104:107], a[16:19], v[120:123]
    v_mfma_f32_16x16x32_bf16 v[116:119], a[104:107], a[8:11], v[116:119]
    ds_read_b64_tr_b16 a[124:125], v15 offset:21600
    v_mfma_f32_16x16x32_bf16 v[116:119], a[108:111], a[12:15], v[116:119]
    buffer_load_dwordx4 v23, s[40:43], s68 offen offset:2048 lds
    v_mfma_f32_16x16x32_bf16 v[112:115], a[108:111], a[4:7], v[112:115]
    ds_read_b64_tr_b16 a[126:127], v15 offset:25184
    v_mfma_f32_16x16x32_bf16 v[112:115], a[104:107], a[0:3], v[112:115]
    s_waitcnt lgkmcnt(4)
    v_mfma_f32_16x16x32_bf16 v[128:131], a[112:115], a[0:3], v[128:131]
    ds_read_b64_tr_b16 a[96:97], v15 offset:128
    v_mfma_f32_16x16x32_bf16 v[128:131], a[116:119], a[4:7], v[128:131]
    buffer_load_dwordx4 v24, s[40:43], s68 offen offset:3072 lds
    v_mfma_f32_16x16x32_bf16 v[132:135], a[116:119], a[12:15], v[132:135]
    ds_read_b64_tr_b16 a[98:99], v15 offset:3712
    v_mfma_f32_16x16x32_bf16 v[132:135], a[112:115], a[8:11], v[132:135]
    v_mfma_f32_16x16x32_bf16 v[136:139], a[112:115], a[16:19], v[136:139]
    ds_read_b64_tr_b16 a[100:101], v15 offset:7296
    v_mfma_f32_16x16x32_bf16 v[136:139], a[116:119], a[20:23], v[136:139]
    s_add_u32 m0, m0, 4096
    v_mfma_f32_16x16x32_bf16 v[140:143], a[116:119], a[28:31], v[140:143]
    ds_read_b64_tr_b16 a[102:103], v15 offset:10880
    v_mfma_f32_16x16x32_bf16 v[140:143], a[112:115], a[24:27], v[140:143]
    s_waitcnt lgkmcnt(4)
    v_mfma_f32_16x16x32_bf16 v[156:159], a[120:123], a[24:27], v[156:159]
    ds_read_b64_tr_b16 a[104:105], v15 offset:14464
    v_mfma_f32_16x16x32_bf16 v[156:159], a[124:127], a[28:31], v[156:159]
    buffer_load_dwordx4 v25, s[40:43], s68 offen offset:0 lds
    v_mfma_f32_16x16x32_bf16 v[152:155], a[124:127], a[20:23], v[152:155]
    ds_read_b64_tr_b16 a[106:107], v15 offset:18048
    v_mfma_f32_16x16x32_bf16 v[152:155], a[120:123], a[16:19], v[152:155]
    v_mfma_f32_16x16x32_bf16 v[148:151], a[120:123], a[8:11], v[148:151]
    ds_read_b64_tr_b16 a[108:109], v15 offset:21632
    v_mfma_f32_16x16x32_bf16 v[148:151], a[124:127], a[12:15], v[148:151]
    buffer_load_dwordx4 v26, s[40:43], s68 offen offset:1024 lds
    v_mfma_f32_16x16x32_bf16 v[144:147], a[124:127], a[4:7], v[144:147]
    ds_read_b64_tr_b16 a[110:111], v15 offset:25216
    v_mfma_f32_16x16x32_bf16 v[144:147], a[120:123], a[0:3], v[144:147]
    s_waitcnt lgkmcnt(4)
    v_mfma_f32_16x16x32_bf16 v[160:163], a[96:99], a[0:3], v[160:163]
    ds_read_b64_tr_b16 a[112:113], v15 offset:160
    v_mfma_f32_16x16x32_bf16 v[160:163], a[100:103], a[4:7], v[160:163]
    buffer_load_dwordx4 v27, s[40:43], s68 offen offset:2048 lds
    v_mfma_f32_16x16x32_bf16 v[164:167], a[100:103], a[12:15], v[164:167]
    ds_read_b64_tr_b16 a[114:115], v15 offset:3744
    v_mfma_f32_16x16x32_bf16 v[164:167], a[96:99], a[8:11], v[164:167]
    v_mfma_f32_16x16x32_bf16 v[168:171], a[96:99], a[16:19], v[168:171]
    ds_read_b64_tr_b16 a[116:117], v15 offset:7328
    v_mfma_f32_16x16x32_bf16 v[168:171], a[100:103], a[20:23], v[168:171]
    s_add_u32 s68, s68, 458752
    v_mfma_f32_16x16x32_bf16 v[172:175], a[100:103], a[28:31], v[172:175]
    ds_read_b64_tr_b16 a[118:119], v15 offset:10912
    v_mfma_f32_16x16x32_bf16 v[172:175], a[96:99], a[24:27], v[172:175]
    s_waitcnt lgkmcnt(4)
    v_mfma_f32_16x16x32_bf16 v[188:191], a[104:107], a[24:27], v[188:191]
    ds_read_b64_tr_b16 a[120:121], v15 offset:14496
    v_mfma_f32_16x16x32_bf16 v[188:191], a[108:111], a[28:31], v[188:191]
    v_mfma_f32_16x16x32_bf16 v[184:187], a[108:111], a[20:23], v[184:187]
    ds_read_b64_tr_b16 a[122:123], v15 offset:18080
    v_mfma_f32_16x16x32_bf16 v[184:187], a[104:107], a[16:19], v[184:187]
    v_mfma_f32_16x16x32_bf16 v[180:183], a[104:107], a[8:11], v[180:183]
    ds_read_b64_tr_b16 a[124:125], v15 offset:21664
    v_mfma_f32_16x16x32_bf16 v[180:183], a[108:111], a[12:15], v[180:183]
    v_mfma_f32_16x16x32_bf16 v[176:179], a[108:111], a[4:7], v[176:179]
    ds_read_b64_tr_b16 a[126:127], v15 offset:25248
    v_mfma_f32_16x16x32_bf16 v[176:179], a[104:107], a[0:3], v[176:179]
    s_waitcnt lgkmcnt(4)
    v_mfma_f32_16x16x32_bf16 v[192:195], a[112:115], a[0:3], v[192:195]
    ds_read_b64_tr_b16 a[96:97], v15 offset:192
    v_mfma_f32_16x16x32_bf16 v[192:195], a[116:119], a[4:7], v[192:195]
    v_mfma_f32_16x16x32_bf16 v[196:199], a[116:119], a[12:15], v[196:199]
    ds_read_b64_tr_b16 a[98:99], v15 offset:3776
    v_mfma_f32_16x16x32_bf16 v[196:199], a[112:115], a[8:11], v[196:199]
    v_mfma_f32_16x16x32_bf16 v[200:203], a[112:115], a[16:19], v[200:203]
    ds_read_b64_tr_b16 a[100:101], v15 offset:7360
    v_mfma_f32_16x16x32_bf16 v[200:203], a[116:119], a[20:23], v[200:203]
    v_mfma_f32_16x16x32_bf16 v[204:207], a[116:119], a[28:31], v[204:207]
    ds_read_b64_tr_b16 a[102:103], v15 offset:10944
    v_mfma_f32_16x16x32_bf16 v[204:207], a[112:115], a[24:27], v[204:207]
    s_waitcnt lgkmcnt(4)
    v_mfma_f32_16x16x32_bf16 v[220:223], a[120:123], a[24:27], v[220:223]
    ds_read_b64_tr_b16 a[104:105], v15 offset:14528
    v_mfma_f32_16x16x32_bf16 v[220:223], a[124:127], a[28:31], v[220:223]
    v_mfma_f32_16x16x32_bf16 v[216:219], a[124:127], a[20:23], v[216:219]
    ds_read_b64_tr_b16 a[106:107], v15 offset:18112
    v_mfma_f32_16x16x32_bf16 v[216:219], a[120:123], a[16:19], v[216:219]
    v_mfma_f32_16x16x32_bf16 v[212:215], a[120:123], a[8:11], v[212:215]
    ds_read_b64_tr_b16 a[108:109], v15 offset:21696
    v_mfma_f32_16x16x32_bf16 v[212:215], a[124:127], a[12:15], v[212:215]
    v_mfma_f32_16x16x32_bf16 v[208:211], a[124:127], a[4:7], v[208:211]
    ds_read_b64_tr_b16 a[110:111], v15 offset:25280
    v_mfma_f32_16x16x32_bf16 v[208:211], a[120:123], a[0:3], v[208:211]
    s_waitcnt lgkmcnt(4)
    v_mfma_f32_16x16x32_bf16 v[224:227], a[96:99], a[0:3], v[224:227]
    ds_read_b64_tr_b16 a[112:113], v15 offset:28672
    v_mfma_f32_16x16x32_bf16 v[224:227], a[100:103], a[4:7], v[224:227]
    v_mfma_f32_16x16x32_bf16 v[228:231], a[100:103], a[12:15], v[228:231]
    ds_read_b64_tr_b16 a[114:115], v15 offset:32256
    v_mfma_f32_16x16x32_bf16 v[228:231], a[96:99], a[8:11], v[228:231]
    v_mfma_f32_16x16x32_bf16 v[232:235], a[96:99], a[16:19], v[232:235]
    ds_read_b64_tr_b16 a[116:117], v15 offset:35840
    v_mfma_f32_16x16x32_bf16 v[232:235], a[100:103], a[20:23], v[232:235]
    v_mfma_f32_16x16x32_bf16 v[236:239], a[100:103], a[28:31], v[236:239]
    ds_read_b64_tr_b16 a[118:119], v15 offset:39424
    v_mfma_f32_16x16x32_bf16 v[236:239], a[96:99], a[24:27], v[236:239]
    s_waitcnt lgkmcnt(4)
    v_mfma_f32_16x16x32_bf16 v[252:255], a[104:107], a[24:27], v[252:255]
    ds_read_b64_tr_b16 a[120:121], v15 offset:43008
    v_mfma_f32_16x16x32_bf16 v[252:255], a[108:111], a[28:31], v[252:255]
    v_mfma_f32_16x16x32_bf16 v[248:251], a[108:111], a[20:23], v[248:251]
    ds_read_b64_tr_b16 a[122:123], v15 offset:46592
    v_mfma_f32_16x16x32_bf16 v[248:251], a[104:107], a[16:19], v[248:251]
    v_mfma_f32_16x16x32_bf16 v[244:247], a[104:107], a[8:11], v[244:247]
    ds_read_b64_tr_b16 a[124:125], v15 offset:50176
    v_mfma_f32_16x16x32_bf16 v[244:247], a[108:111], a[12:15], v[244:247]
    v_mfma_f32_16x16x32_bf16 v[240:243], a[108:111], a[4:7], v[240:243]
    ds_read_b64_tr_b16 a[126:127], v15 offset:53760
    v_mfma_f32_16x16x32_bf16 v[240:243], a[104:107], a[0:3], v[240:243]
    s_waitcnt vmcnt(7) lgkmcnt(4)
    v_mfma_f32_16x16x32_bf16 v[32:35], a[112:115], a[32:35], v[32:35]
    ds_read_b64_tr_b16 a[96:97], v15 offset:28704
    v_mfma_f32_16x16x32_bf16 v[32:35], a[116:119], a[36:39], v[32:35]
    s_add_u32 m0, s70, 28672
    v_mfma_f32_16x16x32_bf16 v[36:39], a[116:119], a[44:47], v[36:39]
    ds_read_b64_tr_b16 a[98:99], v15 offset:32288
    v_mfma_f32_16x16x32_bf16 v[36:39], a[112:115], a[40:43], v[36:39]
    buffer_load_dwordx4 v21, s[40:43], s68 offen offset:0 lds
    v_mfma_f32_16x16x32_bf16 v[40:43], a[112:115], a[48:51], v[40:43]
    ds_read_b64_tr_b16 a[100:101], v15 offset:35872
    v_mfma_f32_16x16x32_bf16 v[40:43], a[116:119], a[52:55], v[40:43]
    v_mfma_f32_16x16x32_bf16 v[44:47], a[116:119], a[60:63], v[44:47]
    ds_read_b64_tr_b16 a[102:103], v15 offset:39456
    v_mfma_f32_16x16x32_bf16 v[44:47], a[112:115], a[56:59], v[44:47]
    s_waitcnt lgkmcnt(4)
    v_mfma_f32_16x16x32_bf16 v[60:63], a[120:123], a[56:59], v[60:63]
    ds_read_b64_tr_b16 a[104:105], v15 offset:43040
    v_mfma_f32_16x16x32_bf16 v[60:63], a[124:127], a[60:63], v[60:63]
    buffer_load_dwordx4 v22, s[40:43], s68 offen offset:1024 lds
    v_mfma_f32_16x16x32_bf16 v[56:59], a[124:127], a[52:55], v[56:59]
    ds_read_b64_tr_b16 a[106:107], v15 offset:46624
    v_mfma_f32_16x16x32_bf16 v[56:59], a[120:123], a[48:51], v[56:59]
    v_mfma_f32_16x16x32_bf16 v[52:55], a[120:123], a[40:43], v[52:55]
    ds_read_b64_tr_b16 a[108:109], v15 offset:50208
    v_mfma_f32_16x16x32_bf16 v[52:55], a[124:127], a[44:47], v[52:55]
    buffer_load_dwordx4 v23, s[40:43], s68 offen offset:2048 lds
    v_mfma_f32_16x16x32_bf16 v[48:51], a[124:127], a[36:39], v[48:51]
    ds_read_b64_tr_b16 a[110:111], v15 offset:53792
    v_mfma_f32_16x16x32_bf16 v[48:51], a[120:123], a[32:35], v[48:51]
    s_waitcnt lgkmcnt(4)
    v_mfma_f32_16x16x32_bf16 v[64:67], a[96:99], a[32:35], v[64:67]
    ds_read_b64_tr_b16 a[112:113], v15 offset:28736
    v_mfma_f32_16x16x32_bf16 v[64:67], a[100:103], a[36:39], v[64:67]
    buffer_load_dwordx4 v24, s[40:43], s68 offen offset:3072 lds
    v_mfma_f32_16x16x32_bf16 v[68:71], a[100:103], a[44:47], v[68:71]
    ds_read_b64_tr_b16 a[114:115], v15 offset:32320
    v_mfma_f32_16x16x32_bf16 v[68:71], a[96:99], a[40:43], v[68:71]
    v_mfma_f32_16x16x32_bf16 v[72:75], a[96:99], a[48:51], v[72:75]
    ds_read_b64_tr_b16 a[116:117], v15 offset:35904
    v_mfma_f32_16x16x32_bf16 v[72:75], a[100:103], a[52:55], v[72:75]
    s_add_u32 m0, m0, 4096
    v_mfma_f32_16x16x32_bf16 v[76:79], a[100:103], a[60:63], v[76:79]
    ds_read_b64_tr_b16 a[118:119], v15 offset:39488
    v_mfma_f32_16x16x32_bf16 v[76:79], a[96:99], a[56:59], v[76:79]
    s_waitcnt lgkmcnt(4)
    v_mfma_f32_16x16x32_bf16 v[92:95], a[104:107], a[56:59], v[92:95]
    ds_read_b64_tr_b16 a[120:121], v15 offset:43072
    v_mfma_f32_16x16x32_bf16 v[92:95], a[108:111], a[60:63], v[92:95]
    buffer_load_dwordx4 v25, s[40:43], s68 offen offset:0 lds
    v_mfma_f32_16x16x32_bf16 v[88:91], a[108:111], a[52:55], v[88:91]
    ds_read_b64_tr_b16 a[122:123], v15 offset:46656
    v_mfma_f32_16x16x32_bf16 v[88:91], a[104:107], a[48:51], v[88:91]
    v_mfma_f32_16x16x32_bf16 v[84:87], a[104:107], a[40:43], v[84:87]
    ds_read_b64_tr_b16 a[124:125], v15 offset:50240
    v_mfma_f32_16x16x32_bf16 v[84:87], a[108:111], a[44:47], v[84:87]
    buffer_load_dwordx4 v26, s[40:43], s68 offen offset:1024 lds
    v_mfma_f32_16x16x32_bf16 v[80:83], a[108:111], a[36:39], v[80:83]
    ds_read_b64_tr_b16 a[126:127], v15 offset:53824
    v_mfma_f32_16x16x32_bf16 v[80:83], a[104:107], a[32:35], v[80:83]
    s_waitcnt lgkmcnt(4)
    v_mfma_f32_16x16x32_bf16 v[96:99], a[112:115], a[32:35], v[96:99]
    ds_read_b64_tr_b16 a[96:97], v15 offset:28768
    v_mfma_f32_16x16x32_bf16 v[96:99], a[116:119], a[36:39], v[96:99]
    buffer_load_dwordx4 v27, s[40:43], s68 offen offset:2048 lds
    v_mfma_f32_16x16x32_bf16 v[100:103], a[116:119], a[44:47], v[100:103]
    ds_read_b64_tr_b16 a[98:99], v15 offset:32352
    v_mfma_f32_16x16x32_bf16 v[100:103], a[112:115], a[40:43], v[100:103]
    v_mfma_f32_16x16x32_bf16 v[104:107], a[112:115], a[48:51], v[104:107]
    ds_read_b64_tr_b16 a[100:101], v15 offset:35936
    v_mfma_f32_16x16x32_bf16 v[104:107], a[116:119], a[52:55], v[104:107]
    s_add_u32 s68, s68, 458752
    v_mfma_f32_16x16x32_bf16 v[108:111], a[116:119], a[60:63], v[108:111]
    ds_read_b64_tr_b16 a[102:103], v15 offset:39520
    v_mfma_f32_16x16x32_bf16 v[108:111], a[112:115], a[56:59], v[108:111]
    s_waitcnt lgkmcnt(4)
    v_mfma_f32_16x16x32_bf16 v[124:127], a[120:123], a[56:59], v[124:127]
    ds_read_b64_tr_b16 a[104:105], v15 offset:43104
    v_mfma_f32_16x16x32_bf16 v[124:127], a[124:127], a[60:63], v[124:127]
    buffer_load_dwordx4 a[0:3], v1, s[28:31], s62 offen offset:0 sc1
    v_mfma_f32_16x16x32_bf16 v[120:123], a[124:127], a[52:55], v[120:123]
    ds_read_b64_tr_b16 a[106:107], v15 offset:46688
    v_mfma_f32_16x16x32_bf16 v[120:123], a[120:123], a[48:51], v[120:123]
    v_mfma_f32_16x16x32_bf16 v[116:119], a[120:123], a[40:43], v[116:119]
    ds_read_b64_tr_b16 a[108:109], v15 offset:50272
    v_mfma_f32_16x16x32_bf16 v[116:119], a[124:127], a[44:47], v[116:119]
    buffer_load_dwordx4 a[4:7], v1, s[28:31], s62 offen offset:1024 sc1
    v_mfma_f32_16x16x32_bf16 v[112:115], a[124:127], a[36:39], v[112:115]
    ds_read_b64_tr_b16 a[110:111], v15 offset:53856
    v_mfma_f32_16x16x32_bf16 v[112:115], a[120:123], a[32:35], v[112:115]
    s_waitcnt lgkmcnt(4)
    v_mfma_f32_16x16x32_bf16 v[128:131], a[96:99], a[32:35], v[128:131]
    ds_read_b64_tr_b16 a[112:113], v15 offset:28800
    v_mfma_f32_16x16x32_bf16 v[128:131], a[100:103], a[36:39], v[128:131]
    buffer_load_dwordx4 a[8:11], v12, s[28:31], s62 offen offset:0 sc1
    v_mfma_f32_16x16x32_bf16 v[132:135], a[100:103], a[44:47], v[132:135]
    ds_read_b64_tr_b16 a[114:115], v15 offset:32384
    v_mfma_f32_16x16x32_bf16 v[132:135], a[96:99], a[40:43], v[132:135]
    v_mfma_f32_16x16x32_bf16 v[136:139], a[96:99], a[48:51], v[136:139]
    ds_read_b64_tr_b16 a[116:117], v15 offset:35968
    v_mfma_f32_16x16x32_bf16 v[136:139], a[100:103], a[52:55], v[136:139]
    buffer_load_dwordx4 a[12:15], v12, s[28:31], s62 offen offset:1024 sc1
    v_mfma_f32_16x16x32_bf16 v[140:143], a[100:103], a[60:63], v[140:143]
    ds_read_b64_tr_b16 a[118:119], v15 offset:39552
    v_mfma_f32_16x16x32_bf16 v[140:143], a[96:99], a[56:59], v[140:143]
    s_waitcnt lgkmcnt(4)
    v_mfma_f32_16x16x32_bf16 v[156:159], a[104:107], a[56:59], v[156:159]
    ds_read_b64_tr_b16 a[120:121], v15 offset:43136
    v_mfma_f32_16x16x32_bf16 v[156:159], a[108:111], a[60:63], v[156:159]
    buffer_load_dwordx4 a[16:19], v13, s[28:31], s62 offen offset:0 sc1
    v_mfma_f32_16x16x32_bf16 v[152:155], a[108:111], a[52:55], v[152:155]
    ds_read_b64_tr_b16 a[122:123], v15 offset:46720
    v_mfma_f32_16x16x32_bf16 v[152:155], a[104:107], a[48:51], v[152:155]
    v_mfma_f32_16x16x32_bf16 v[148:151], a[104:107], a[40:43], v[148:151]
    ds_read_b64_tr_b16 a[124:125], v15 offset:50304
    v_mfma_f32_16x16x32_bf16 v[148:151], a[108:111], a[44:47], v[148:151]
    buffer_load_dwordx4 a[20:23], v13, s[28:31], s62 offen offset:1024 sc1
    v_mfma_f32_16x16x32_bf16 v[144:147], a[108:111], a[36:39], v[144:147]
    ds_read_b64_tr_b16 a[126:127], v15 offset:53888
    v_mfma_f32_16x16x32_bf16 v[144:147], a[104:107], a[32:35], v[144:147]
    s_waitcnt lgkmcnt(4)
    v_mfma_f32_16x16x32_bf16 v[160:163], a[112:115], a[32:35], v[160:163]
    ds_read_b64_tr_b16 a[96:97], v15 offset:28832
    v_mfma_f32_16x16x32_bf16 v[160:163], a[116:119], a[36:39], v[160:163]
    buffer_load_dwordx4 a[24:27], v14, s[28:31], s62 offen offset:0 sc1
    v_mfma_f32_16x16x32_bf16 v[164:167], a[116:119], a[44:47], v[164:167]
    ds_read_b64_tr_b16 a[98:99], v15 offset:32416
    v_mfma_f32_16x16x32_bf16 v[164:167], a[112:115], a[40:43], v[164:167]
    v_mfma_f32_16x16x32_bf16 v[168:171], a[112:115], a[48:51], v[168:171]
    ds_read_b64_tr_b16 a[100:101], v15 offset:36000
    v_mfma_f32_16x16x32_bf16 v[168:171], a[116:119], a[52:55], v[168:171]
    buffer_load_dwordx4 a[28:31], v14, s[28:31], s62 offen offset:1024 sc1
    v_mfma_f32_16x16x32_bf16 v[172:175], a[116:119], a[60:63], v[172:175]
    ds_read_b64_tr_b16 a[102:103], v15 offset:39584
    v_mfma_f32_16x16x32_bf16 v[172:175], a[112:115], a[56:59], v[172:175]
    s_waitcnt lgkmcnt(4)
    v_mfma_f32_16x16x32_bf16 v[188:191], a[120:123], a[56:59], v[188:191]
    ds_read_b64_tr_b16 a[104:105], v15 offset:43168
    v_mfma_f32_16x16x32_bf16 v[188:191], a[124:127], a[60:63], v[188:191]
    s_add_u32 s62, s62, 2048
    v_mfma_f32_16x16x32_bf16 v[184:187], a[124:127], a[52:55], v[184:187]
    ds_read_b64_tr_b16 a[106:107], v15 offset:46752
    v_mfma_f32_16x16x32_bf16 v[184:187], a[120:123], a[48:51], v[184:187]
    s_sub_u32 s59, s59, 1
    v_mfma_f32_16x16x32_bf16 v[180:183], a[120:123], a[40:43], v[180:183]
    ds_read_b64_tr_b16 a[108:109], v15 offset:50336
    v_mfma_f32_16x16x32_bf16 v[180:183], a[124:127], a[44:47], v[180:183]
    s_cbranch_scc1 F_last4
    v_mfma_f32_16x16x32_bf16 v[176:179], a[124:127], a[36:39], v[176:179]
    ds_read_b64_tr_b16 a[110:111], v15 offset:53920
    v_mfma_f32_16x16x32_bf16 v[176:179], a[120:123], a[32:35], v[176:179]
    s_waitcnt lgkmcnt(4)
    v_mfma_f32_16x16x32_bf16 v[192:195], a[96:99], a[32:35], v[192:195]
    ds_read_b64_tr_b16 a[112:113], v15 offset:28864
    v_mfma_f32_16x16x32_bf16 v[192:195], a[100:103], a[36:39], v[192:195]
    v_mfma_f32_16x16x32_bf16 v[196:199], a[100:103], a[44:47], v[196:199]
    ds_read_b64_tr_b16 a[114:115], v15 offset:32448
    v_mfma_f32_16x16x32_bf16 v[196:199], a[96:99], a[40:43], v[196:199]
    v_mfma_f32_16x16x32_bf16 v[200:203], a[96:99], a[48:51], v[200:203]
    ds_read_b64_tr_b16 a[116:117], v15 offset:36032
    v_mfma_f32_16x16x32_bf16 v[200:203], a[100:103], a[52:55], v[200:203]
    v_mfma_f32_16x16x32_bf16 v[204:207], a[100:103], a[60:63], v[204:207]
    ds_read_b64_tr_b16 a[118:119], v15 offset:39616
    v_mfma_f32_16x16x32_bf16 v[204:207], a[96:99], a[56:59], v[204:207]
    s_waitcnt lgkmcnt(4)
    v_mfma_f32_16x16x32_bf16 v[220:223], a[104:107], a[56:59], v[220:223]
    ds_read_b64_tr_b16 a[120:121], v15 offset:43200
    v_mfma_f32_16x16x32_bf16 v[220:223], a[108:111], a[60:63], v[220:223]
    v_mfma_f32_16x16x32_bf16 v[216:219], a[108:111], a[52:55], v[216:219]
    ds_read_b64_tr_b16 a[122:123], v15 offset:46784
    v_mfma_f32_16x16x32_bf16 v[216:219], a[104:107], a[48:51], v[216:219]
    v_mfma_f32_16x16x32_bf16 v[212:215], a[104:107], a[40:43], v[212:215]
    ds_read_b64_tr_b16 a[124:125], v15 offset:50368
    v_mfma_f32_16x16x32_bf16 v[212:215], a[108:111], a[44:47], v[212:215]
    v_mfma_f32_16x16x32_bf16 v[208:211], a[108:111], a[36:39], v[208:211]
    ds_read_b64_tr_b16 a[126:127], v15 offset:53952
    v_mfma_f32_16x16x32_bf16 v[208:211], a[104:107], a[32:35], v[208:211]
    v_add_u32 v15, s71, v11
    s_waitcnt lgkmcnt(4)
    v_mfma_f32_16x16x32_bf16 v[224:227], a[112:115], a[32:35], v[224:227]
    v_mfma_f32_16x16x32_bf16 v[224:227], a[116:119], a[36:39], v[224:227]
    s_sub_u32 s71, 106496, s71
    v_mfma_f32_16x16x32_bf16 v[228:231], a[116:119], a[44:47], v[228:231]
    v_mfma_f32_16x16x32_bf16 v[228:231], a[112:115], a[40:43], v[228:231]
    s_waitcnt vmcnt(8) lgkmcnt(0)
    s_barrier
    ds_read_b64_tr_b16 a[96:97], v15 offset:0
    v_mfma_f32_16x16x32_bf16 v[232:235], a[112:115], a[48:51], v[232:235]
    ds_read_b64_tr_b16 a[98:99], v15 offset:3584
    v_mfma_f32_16x16x32_bf16 v[232:235], a[116:119], a[52:55], v[232:235]
    ds_read_b64_tr_b16 a[100:101], v15 offset:7168
    v_mfma_f32_16x16x32_bf16 v[236:239], a[116:119], a[60:63], v[236:239]
    ds_read_b64_tr_b16 a[102:103], v15 offset:10752
    v_mfma_f32_16x16x32_bf16 v[236:239], a[112:115], a[56:59], v[236:239]
    ds_read_b64_tr_b16 a[104:105], v15 offset:14336
    v_mfma_f32_16x16x32_bf16 v[252:255], a[120:123], a[56:59], v[252:255]
    ds_read_b64_tr_b16 a[106:107], v15 offset:17920
    v_mfma_f32_16x16x32_bf16 v[252:255], a[124:127], a[60:63], v[252:255]
    ds_read_b64_tr_b16 a[108:109], v15 offset:21504
    v_mfma_f32_16x16x32_bf16 v[248:251], a[124:127], a[52:55], v[248:251]
    ds_read_b64_tr_b16 a[110:111], v15 offset:25088
    v_mfma_f32_16x16x32_bf16 v[248:251], a[120:123], a[48:51], v[248:251]
    s_add_u32 s70, s69, s71
    v_mfma_f32_16x16x32_bf16 v[244:247], a[120:123], a[40:43], v[244:247]
    v_mfma_f32_16x16x32_bf16 v[244:247], a[124:127], a[44:47], v[244:247]
    v_mfma_f32_16x16x32_bf16 v[240:243], a[124:127], a[36:39], v[240:243]
    v_mfma_f32_16x16x32_bf16 v[240:243], a[120:123], a[32:35], v[240:243]
    s_waitcnt vmcnt(0) lgkmcnt(4)
    s_branch F_p4loop
F_last4:
    v_mfma_f32_16x16x32_bf16 v[176:179], a[124:127], a[36:39], v[176:179]
    ds_read_b64_tr_b16 a[110:111], v15 offset:53920
    v_accvgpr_read_b32 v4, a144
    v_accvgpr_read_b32 v5, a146
    v_mfma_f32_16x16x32_bf16 v[176:179], a[120:123], a[32:35], v[176:179]
    s_waitcnt lgkmcnt(4)
    v_accvgpr_read_b32 v6, a148
    v_accvgpr_read_b32 v7, a150
    v_mfma_f32_16x16x32_bf16 v[192:195], a[96:99], a[32:35], v[192:195]
    ds_read_b64_tr_b16 a[112:113], v15 offset:28864
    v_add_f32 v4, v4, v5
    v_add_f32 v6, v6, v7
    v_mfma_f32_16x16x32_bf16 v[192:195], a[100:103], a[36:39], v[192:195]
    buffer_load_dwordx4 a[64:67], v1, s[28:31], s62 offen offset:0 sc1
    v_add_f32 v4, v4, v6
    v_mov_b32 v5, v4
    v_mfma_f32_16x16x32_bf16 v[196:199], a[100:103], a[44:47], v[196:199]
    ds_read_b64_tr_b16 a[114:115], v15 offset:32448
    v_permlane16_swap_b32 v4, v5
    v_add_f32 v4, v4, v5
    v_mfma_f32_16x16x32_bf16 v[196:199], a[96:99], a[40:43], v[196:199]
    v_mov_b32 v5, v4
    s_nop 1
    v_permlane32_swap_b32 v4, v5
    v_mfma_f32_16x16x32_bf16 v[200:203], a[96:99], a[48:51], v[200:203]
    ds_read_b64_tr_b16 a[116:117], v15 offset:36032
    v_add_f32 v4, v4, v5
    v_fma_f32 v4, v4, s57, v8
    v_mfma_f32_16x16x32_bf16 v[200:203], a[100:103], a[52:55], v[200:203]
    buffer_load_dwordx4 a[68:71], v1, s[28:31], s62 offen offset:1024 sc1
    v_rsq_f32 v4, v4
    s_nop 0
    v_mul_f32 v28, 0xbfb8aa3b, v4
    v_mfma_f32_16x16x32_bf16 v[204:207], a[100:103], a[60:63], v[204:207]
    ds_read_b64_tr_b16 a[118:119], v15 offset:39616
    v_accvgpr_read_b32 v4, a145
    v_accvgpr_read_b32 v5, a147
    v_mfma_f32_16x16x32_bf16 v[204:207], a[96:99], a[56:59], v[204:207]
    s_waitcnt lgkmcnt(4)
    v_accvgpr_read_b32 v6, a149
    v_accvgpr_read_b32 v7, a151
    v_mfma_f32_16x16x32_bf16 v[220:223], a[104:107], a[56:59], v[220:223]
    ds_read_b64_tr_b16 a[120:121], v15 offset:43200
    v_add_f32 v4, v4, v5
    v_add_f32 v6, v6, v7
    v_mfma_f32_16x16x32_bf16 v[220:223], a[108:111], a[60:63], v[220:223]
    buffer_load_dwordx4 a[72:75], v12, s[28:31], s62 offen offset:0 sc1
    v_add_f32 v4, v4, v6
    v_mov_b32 v5, v4
    v_mfma_f32_16x16x32_bf16 v[216:219], a[108:111], a[52:55], v[216:219]
    ds_read_b64_tr_b16 a[122:123], v15 offset:46784
    v_permlane16_swap_b32 v4, v5
    v_add_f32 v4, v4, v5
    v_mfma_f32_16x16x32_bf16 v[216:219], a[104:107], a[48:51], v[216:219]
    v_mov_b32 v5, v4
    s_nop 1
    v_permlane32_swap_b32 v4, v5
    v_mfma_f32_16x16x32_bf16 v[212:215], a[104:107], a[40:43], v[212:215]
    ds_read_b64_tr_b16 a[124:125], v15 offset:50368
    v_add_f32 v4, v4, v5
    v_fma_f32 v4, v4, s57, v8
    v_mfma_f32_16x16x32_bf16 v[212:215], a[108:111], a[44:47], v[212:215]
    buffer_load_dwordx4 a[76:79], v12, s[28:31], s62 offen offset:1024 sc1
    v_rsq_f32 v4, v4
    s_nop 0
    v_mul_f32 v29, 0xbfb8aa3b, v4
    v_mfma_f32_16x16x32_bf16 v[208:211], a[108:111], a[36:39], v[208:211]
    ds_read_b64_tr_b16 a[126:127], v15 offset:53952
    v_accvgpr_read_b32 v4, a152
    v_accvgpr_read_b32 v5, a154
    v_mfma_f32_16x16x32_bf16 v[208:211], a[104:107], a[32:35], v[208:211]
    v_add_u32 v15, s71, v11
    s_waitcnt lgkmcnt(4)
    v_accvgpr_read_b32 v6, a156
    v_accvgpr_read_b32 v7, a158
    v_mfma_f32_16x16x32_bf16 v[224:227], a[112:115], a[32:35], v[224:227]
    v_add_f32 v4, v4, v5
    v_add_f32 v6, v6, v7
    v_mfma_f32_16x16x32_bf16 v[224:227], a[116:119], a[36:39], v[224:227]
    buffer_load_dwordx4 a[80:83], v13, s[28:31], s62 offen offset:0 sc1
    v_add_f32 v4, v4, v6
    v_mov_b32 v5, v4
    v_mfma_f32_16x16x32_bf16 v[228:231], a[116:119], a[44:47], v[228:231]
    s_nop 0
    v_permlane16_swap_b32 v4, v5
    v_add_f32 v4, v4, v5
    v_mfma_f32_16x16x32_bf16 v[228:231], a[112:115], a[40:43], v[228:231]
    s_waitcnt lgkmcnt(0)
    s_waitcnt vmcnt(13)
    s_barrier
    ds_read_b64_tr_b16 a[96:97], v15 offset:0
    v_mov_b32 v5, v4
    s_nop 1
    v_permlane32_swap_b32 v4, v5
    v_mfma_f32_16x16x32_bf16 v[232:235], a[112:115], a[48:51], v[232:235]
    ds_read_b64_tr_b16 a[98:99], v15 offset:3584
    v_add_f32 v4, v4, v5
    v_fma_f32 v4, v4, s57, v8
    v_mfma_f32_16x16x32_bf16 v[232:235], a[116:119], a[52:55], v[232:235]
    ds_read_b64_tr_b16 a[100:101], v15 offset:7168
    buffer_load_dwordx4 a[84:87], v13, s[28:31], s62 offen offset:1024 sc1
    v_rsq_f32 v4, v4
    s_nop 0
    v_mul_f32 v30, 0xbfb8aa3b, v4
    v_mfma_f32_16x16x32_bf16 v[236:239], a[116:119], a[60:63], v[236:239]
    ds_read_b64_tr_b16 a[102:103], v15 offset:10752
    v_accvgpr_read_b32 v4, a153
    v_accvgpr_read_b32 v5, a155
    v_mfma_f32_16x16x32_bf16 v[236:239], a[112:115], a[56:59], v[236:239]
    ds_read_b64_tr_b16 a[104:105], v15 offset:14336
    v_accvgpr_read_b32 v6, a157
    v_accvgpr_read_b32 v7, a159
    v_mfma_f32_16x16x32_bf16 v[252:255], a[120:123], a[56:59], v[252:255]
    ds_read_b64_tr_b16 a[106:107], v15 offset:17920
    v_add_f32 v4, v4, v5
    v_add_f32 v6, v6, v7
    v_mfma_f32_16x16x32_bf16 v[252:255], a[124:127], a[60:63], v[252:255]
    ds_read_b64_tr_b16 a[108:109], v15 offset:21504
    buffer_load_dwordx4 a[88:91], v14, s[28:31], s62 offen offset:0 sc1
    v_add_f32 v4, v4, v6
    v_mov_b32 v5, v4
    v_mfma_f32_16x16x32_bf16 v[248:251], a[124:127], a[52:55], v[248:251]
    ds_read_b64_tr_b16 a[110:111], v15 offset:25088
    v_permlane16_swap_b32 v4, v5
    v_add_f32 v4, v4, v5
    v_mfma_f32_16x16x32_bf16 v[248:251], a[120:123], a[48:51], v[248:251]
    ds_read_b64_tr_b16 a[128:129], v15 offset:28672
    v_mov_b32 v5, v4
    s_nop 1
    v_permlane32_swap_b32 v4, v5
    v_mfma_f32_16x16x32_bf16 v[244:247], a[120:123], a[40:43], v[244:247]
    ds_read_b64_tr_b16 a[130:131], v15 offset:32256
    v_add_f32 v4, v4, v5
    v_fma_f32 v4, v4, s57, v8
    v_mfma_f32_16x16x32_bf16 v[244:247], a[124:127], a[44:47], v[244:247]
    ds_read_b64_tr_b16 a[132:133], v15 offset:35840
    buffer_load_dwordx4 a[92:95], v14, s[28:31], s62 offen offset:1024 sc1
    v_rsq_f32 v4, v4
    s_nop 0
    v_mul_f32 v31, 0xbfb8aa3b, v4
    v_mfma_f32_16x16x32_bf16 v[240:243], a[124:127], a[36:39], v[240:243]
    ds_read_b64_tr_b16 a[134:135], v15 offset:39424
    v_mfma_f32_16x16x32_bf16 v[240:243], a[120:123], a[32:35], v[240:243]
    s_waitcnt vmcnt(8) lgkmcnt(8)
F_tail4:
    v_mfma_f32_16x16x32_bf16 v[32:35], a[96:99], a[0:3], v[32:35]
    ds_read_b64_tr_b16 a[136:137], v15 offset:43008
    v_accvgpr_read_b32 v21, a234
    v_mfma_f32_16x16x32_bf16 v[32:35], a[100:103], a[4:7], v[32:35]
    v_accvgpr_read_b32 v22, a235
    v_mfma_f32_16x16x32_bf16 v[36:39], a[96:99], a[8:11], v[36:39]
    ds_read_b64_tr_b16 a[138:139], v15 offset:46592
    s_mul_i32 s56, s65, 1835008
    v_mfma_f32_16x16x32_bf16 v[36:39], a[100:103], a[12:15], v[36:39]
    s_xor_b32 s57, s54, 8
    v_mfma_f32_16x16x32_bf16 v[40:43], a[96:99], a[16:19], v[40:43]
    ds_read_b64_tr_b16 a[140:141], v15 offset:50176
    s_add_u32 s57, s57, 16
    v_mfma_f32_16x16x32_bf16 v[40:43], a[100:103], a[20:23], v[40:43]
    s_sub_u32 s57, s57, s54
    v_mfma_f32_16x16x32_bf16 v[44:47], a[96:99], a[24:27], v[44:47]
    ds_read_b64_tr_b16 a[142:143], v15 offset:53760
    s_lshl_b32 s57, s57, 7
    v_mfma_f32_16x16x32_bf16 v[44:47], a[100:103], a[28:31], v[44:47]
    v_add_u32 v23, s57, v21
    s_waitcnt vmcnt(7) lgkmcnt(6)
    v_mfma_f32_16x16x32_bf16 v[32:35], a[128:131], a[64:67], v[32:35]
    ds_read_b64_tr_b16 a[112:113], v15 offset:32
    v_add_u32 v24, s57, v22
    s_waitcnt vmcnt(6) lgkmcnt(5)
    v_mfma_f32_16x16x32_bf16 v[32:35], a[132:135], a[68:71], v[32:35]
    v_add_u32 v21, 4096, v21
    s_waitcnt vmcnt(5)
    v_mfma_f32_16x16x32_bf16 v[36:39], a[128:131], a[72:75], v[36:39]
    ds_read_b64_tr_b16 a[114:115], v15 offset:3616
    v_add_u32 v22, 4096, v22
    s_waitcnt vmcnt(4)
    v_mfma_f32_16x16x32_bf16 v[36:39], a[132:135], a[76:79], v[36:39]
    s_mul_i32 s68, s52, 229376
    s_waitcnt vmcnt(3)
    v_mfma_f32_16x16x32_bf16 v[40:43], a[128:131], a[80:83], v[40:43]
    ds_read_b64_tr_b16 a[116:117], v15 offset:7200
    s_add_u32 s40, s20, s56
    s_waitcnt vmcnt(2)
    v_mfma_f32_16x16x32_bf16 v[40:43], a[132:135], a[84:87], v[40:43]
    s_addc_u32 s41, s21, 0
    s_waitcnt vmcnt(1)
    v_mfma_f32_16x16x32_bf16 v[44:47], a[128:131], a[88:91], v[44:47]
    ds_read_b64_tr_b16 a[118:119], v15 offset:10784
    s_sub_u32 s40, s40, 0x1000
    s_waitcnt vmcnt(0)
    v_mfma_f32_16x16x32_bf16 v[44:47], a[132:135], a[92:95], v[44:47]
    s_waitcnt lgkmcnt(4)
    s_subb_u32 s41, s41, 0
    s_mov_b32 s42, 0x1c1000
    v_mfma_f32_16x16x32_bf16 v[60:63], a[104:107], a[24:27], v[60:63]
    ds_read_b64_tr_b16 a[144:145], v15 offset:28704
    s_mov_b32 s43, 0x20000
    v_mfma_f32_16x16x32_bf16 v[60:63], a[108:111], a[28:31], v[60:63]
    s_lshl_b32 s57, s54, 7
    v_mfma_f32_16x16x32_bf16 v[60:63], a[136:139], a[88:91], v[60:63]
    ds_read_b64_tr_b16 a[146:147], v15 offset:32288
    s_add_u32 s68, s68, s57
    v_mfma_f32_16x16x32_bf16 v[60:63], a[140:143], a[92:95], v[60:63]
    s_lshl_b32 s69, s52, 12
    v_mfma_f32_16x16x32_bf16 v[56:59], a[140:143], a[84:87], v[56:59]
    ds_read_b64_tr_b16 a[148:149], v15 offset:35872
    v_lshrrev_b32 v4, 5, v0
    v_mfma_f32_16x16x32_bf16 v[56:59], a[136:139], a[80:83], v[56:59]
    v_mul_u32_u24 v4, 114176, v4
    v_mfma_f32_16x16x32_bf16 v[56:59], a[108:111], a[20:23], v[56:59]
    ds_read_b64_tr_b16 a[150:151], v15 offset:39456
    v_add_u32 v13, v4, v1
    v_mfma_f32_16x16x32_bf16 v[56:59], a[104:107], a[16:19], v[56:59]
    v_add_u32 v14, 229376, v13
    v_mfma_f32_16x16x32_bf16 v[52:55], a[104:107], a[8:11], v[52:55]
    ds_read_b64_tr_b16 a[120:121], v15 offset:14368
    v_add_u32 v12, 114688, v1
    v_mfma_f32_16x16x32_bf16 v[52:55], a[108:111], a[12:15], v[52:55]
    s_mul_i32 s62, s55, 7168
    v_mfma_f32_16x16x32_bf16 v[52:55], a[136:139], a[72:75], v[52:55]
    ds_read_b64_tr_b16 a[122:123], v15 offset:17952
    s_mul_i32 s56, s65, 28672
    v_mfma_f32_16x16x32_bf16 v[52:55], a[140:143], a[76:79], v[52:55]
    s_add_u32 s62, s62, s56
    v_mfma_f32_16x16x32_bf16 v[48:51], a[140:143], a[68:71], v[48:51]
    ds_read_b64_tr_b16 a[124:125], v15 offset:21536
    s_mov_b32 s60, 1048576
    v_mfma_f32_16x16x32_bf16 v[48:51], a[136:139], a[64:67], v[48:51]
    s_lshl_b32 s56, s66, 7
    v_mfma_f32_16x16x32_bf16 v[48:51], a[108:111], a[4:7], v[48:51]
    ds_read_b64_tr_b16 a[126:127], v15 offset:25120
    s_add_u32 s73, s73, s56
    v_mfma_f32_16x16x32_bf16 v[48:51], a[104:107], a[0:3], v[48:51]
    s_waitcnt lgkmcnt(4)
    s_add_u32 s73, s73, 753664
    v_mfma_f32_16x16x32_bf16 v[64:67], a[112:115], a[0:3], v[64:67]
    ds_read_b64_tr_b16 a[152:153], v15 offset:43040
    v_mul_f32 v32, v28, v32
    v_mul_f32 v33, v28, v33
    v_mul_f32 v34, v28, v34
    v_mul_f32 v35, v28, v35
    v_mfma_f32_16x16x32_bf16 v[64:67], a[116:119], a[4:7], v[64:67]
    s_add_u32 m0, s69, 0
    v_exp_f32 v32, v32
    v_exp_f32 v33, v33
    v_mfma_f32_16x16x32_bf16 v[64:67], a[144:147], a[64:67], v[64:67]
    ds_read_b64_tr_b16 a[154:155], v15 offset:46624
    v_exp_f32 v34, v34
    v_exp_f32 v35, v35
    v_mfma_f32_16x16x32_bf16 v[64:67], a[148:151], a[68:71], v[64:67]
    buffer_load_dwordx4 v21, s[40:43], s68 offen offset:0 lds
    v_add_f32 v32, 1.0, v32
    v_add_f32 v33, 1.0, v33
    v_add_f32 v34, 1.0, v34
    v_add_f32 v35, 1.0, v35
    v_mfma_f32_16x16x32_bf16 v[68:71], a[148:151], a[76:79], v[68:71]
    ds_read_b64_tr_b16 a[156:157], v15 offset:50208
    v_rcp_f32 v32, v32
    v_rcp_f32 v33, v33
    v_mfma_f32_16x16x32_bf16 v[68:71], a[144:147], a[72:75], v[68:71]
    buffer_load_dwordx4 v22, s[40:43], s68 offen offset:1024 lds
    v_rcp_f32 v34, v34
    v_rcp_f32 v35, v35
    v_mfma_f32_16x16x32_bf16 v[68:71], a[116:119], a[12:15], v[68:71]
    ds_read_b64_tr_b16 a[158:159], v15 offset:53792
    v_mul_f32 v48, v48, v32
    v_mul_f32 v49, v49, v33
    v_mul_f32 v50, v50, v34
    v_mfma_f32_16x16x32_bf16 v[68:71], a[112:115], a[8:11], v[68:71]
    buffer_load_dwordx4 v23, s[40:43], s68 offen offset:2048 lds
    v_mul_f32 v51, v51, v35
    v_cvt_pk_bf16_f32 v32, v48, v49
    v_cvt_pk_bf16_f32 v33, v50, v51
    v_mul_f32 v36, v29, v36
    v_mfma_f32_16x16x32_bf16 v[72:75], a[112:115], a[16:19], v[72:75]
    ds_read_b64_tr_b16 a[96:97], v15 offset:64
    v_mul_f32 v37, v29, v37
    v_mul_f32 v38, v29, v38
    v_mul_f32 v39, v29, v39
    v_exp_f32 v36, v36
    v_mfma_f32_16x16x32_bf16 v[72:75], a[116:119], a[20:23], v[72:75]
    buffer_load_dwordx4 v24, s[40:43], s68 offen offset:3072 lds
    v_exp_f32 v37, v37
    v_exp_f32 v38, v38
    v_mfma_f32_16x16x32_bf16 v[72:75], a[144:147], a[80:83], v[72:75]
    ds_read_b64_tr_b16 a[98:99], v15 offset:3648
    v_exp_f32 v39, v39
    v_add_f32 v36, 1.0, v36
    v_mfma_f32_16x16x32_bf16 v[72:75], a[148:151], a[84:87], v[72:75]
    s_add_u32 s68, s68, 917504
    v_add_f32 v37, 1.0, v37
    v_add_f32 v38, 1.0, v38
    v_add_f32 v39, 1.0, v39
    v_mfma_f32_16x16x32_bf16 v[76:79], a[148:151], a[92:95], v[76:79]
    ds_read_b64_tr_b16 a[100:101], v15 offset:7232
    v_rcp_f32 v36, v36
    v_rcp_f32 v37, v37
    v_mfma_f32_16x16x32_bf16 v[76:79], a[144:147], a[88:91], v[76:79]
    v_rcp_f32 v38, v38
    v_rcp_f32 v39, v39
    v_mul_f32 v52, v52, v36
    v_mfma_f32_16x16x32_bf16 v[76:79], a[116:119], a[28:31], v[76:79]
    ds_read_b64_tr_b16 a[102:103], v15 offset:10816
    v_mul_f32 v53, v53, v37
    v_mul_f32 v54, v54, v38
    v_mul_f32 v55, v55, v39
    v_cvt_pk_bf16_f32 v34, v52, v53
    v_mfma_f32_16x16x32_bf16 v[76:79], a[112:115], a[24:27], v[76:79]
    s_waitcnt lgkmcnt(4)
    v_cvt_pk_bf16_f32 v35, v54, v55
    v_permlane32_swap_b32 v32, v34
    s_nop 0
    v_permlane32_swap_b32 v33, v35
    v_mul_f32 v40, v30, v40
    v_mfma_f32_16x16x32_bf16 v[92:95], a[120:123], a[24:27], v[92:95]
    ds_read_b64_tr_b16 a[128:129], v15 offset:28736
    v_mul_f32 v41, v30, v41
    v_mul_f32 v42, v30, v42
    v_mul_f32 v43, v30, v43
    v_mfma_f32_16x16x32_bf16 v[92:95], a[124:127], a[28:31], v[92:95]
    buffer_store_dwordx4 v[32:35], v13, s[32:35], s64 offen sc1
    v_exp_f32 v40, v40
    v_exp_f32 v41, v41
    v_mfma_f32_16x16x32_bf16 v[92:95], a[152:155], a[88:91], v[92:95]
    ds_read_b64_tr_b16 a[130:131], v15 offset:32320
    v_exp_f32 v42, v42
    v_exp_f32 v43, v43
    v_mfma_f32_16x16x32_bf16 v[92:95], a[156:159], a[92:95], v[92:95]
    v_add_f32 v40, 1.0, v40
    v_add_f32 v41, 1.0, v41
    v_add_f32 v42, 1.0, v42
    v_add_f32 v43, 1.0, v43
    v_mfma_f32_16x16x32_bf16 v[88:91], a[156:159], a[84:87], v[88:91]
    ds_read_b64_tr_b16 a[132:133], v15 offset:35904
    v_rcp_f32 v40, v40
    v_rcp_f32 v41, v41
    v_mfma_f32_16x16x32_bf16 v[88:91], a[152:155], a[80:83], v[88:91]
    v_rcp_f32 v42, v42
    v_rcp_f32 v43, v43
    v_mfma_f32_16x16x32_bf16 v[88:91], a[124:127], a[20:23], v[88:91]
    ds_read_b64_tr_b16 a[134:135], v15 offset:39488
    v_mul_f32 v56, v56, v40
    v_mul_f32 v57, v57, v41
    v_mul_f32 v58, v58, v42
    v_mul_f32 v59, v59, v43
    v_mfma_f32_16x16x32_bf16 v[88:91], a[120:123], a[16:19], v[88:91]
    v_cvt_pk_bf16_f32 v40, v56, v57
    v_cvt_pk_bf16_f32 v41, v58, v59
    v_mul_f32 v44, v31, v44
    v_mul_f32 v45, v31, v45
    v_mfma_f32_16x16x32_bf16 v[84:87], a[120:123], a[8:11], v[84:87]
    ds_read_b64_tr_b16 a[104:105], v15 offset:14400
    v_mul_f32 v46, v31, v46
    v_mul_f32 v47, v31, v47
    v_exp_f32 v44, v44
    v_mfma_f32_16x16x32_bf16 v[84:87], a[124:127], a[12:15], v[84:87]
    v_exp_f32 v45, v45
    v_exp_f32 v46, v46
    v_mfma_f32_16x16x32_bf16 v[84:87], a[152:155], a[72:75], v[84:87]
    ds_read_b64_tr_b16 a[106:107], v15 offset:17984
    v_exp_f32 v47, v47
    v_add_f32 v44, 1.0, v44
    v_mfma_f32_16x16x32_bf16 v[84:87], a[156:159], a[76:79], v[84:87]
    v_add_f32 v45, 1.0, v45
    v_add_f32 v46, 1.0, v46
    v_add_f32 v47, 1.0, v47
    v_rcp_f32 v44, v44
    v_mfma_f32_16x16x32_bf16 v[80:83], a[156:159], a[68:71], v[80:83]
    ds_read_b64_tr_b16 a[108:109], v15 offset:21568
    v_rcp_f32 v45, v45
    v_rcp_f32 v46, v46
    v_mfma_f32_16x16x32_bf16 v[80:83], a[152:155], a[64:67], v[80:83]
    v_rcp_f32 v47, v47
    v_mul_f32 v60, v60, v44
    v_mfma_f32_16x16x32_bf16 v[80:83], a[124:127], a[4:7], v[80:83]
    ds_read_b64_tr_b16 a[110:111], v15 offset:25152
    v_mul_f32 v61, v61, v45
    v_mul_f32 v62, v62, v46
    v_mul_f32 v63, v63, v47
    v_cvt_pk_bf16_f32 v42, v60, v61
    v_mfma_f32_16x16x32_bf16 v[80:83], a[120:123], a[0:3], v[80:83]
    s_waitcnt lgkmcnt(4)
    v_cvt_pk_bf16_f32 v43, v62, v63
    v_permlane32_swap_b32 v40, v42
    s_nop 0
    v_permlane32_swap_b32 v41, v43
    v_mfma_f32_16x16x32_bf16 v[96:99], a[96:99], a[0:3], v[96:99]
    ds_read_b64_tr_b16 a[136:137], v15 offset:43072
    v_mul_f32 v64, v28, v64
    v_mul_f32 v65, v28, v65
    v_mul_f32 v66, v28, v66
    v_mul_f32 v67, v28, v67
    v_mfma_f32_16x16x32_bf16 v[96:99], a[100:103], a[4:7], v[96:99]
    buffer_store_dwordx4 v[40:43], v14, s[32:35], s64 offen sc1
    v_exp_f32 v64, v64
    v_exp_f32 v65, v65
    v_mfma_f32_16x16x32_bf16 v[96:99], a[128:131], a[64:67], v[96:99]
    ds_read_b64_tr_b16 a[138:139], v15 offset:46656
    v_exp_f32 v66, v66
    v_exp_f32 v67, v67
    v_mfma_f32_16x16x32_bf16 v[96:99], a[132:135], a[68:71], v[96:99]
    s_add_u32 s64, s64, 4096
    v_add_f32 v64, 1.0, v64
    v_add_f32 v65, 1.0, v65
    v_add_f32 v66, 1.0, v66
    v_add_f32 v67, 1.0, v67
    v_mfma_f32_16x16x32_bf16 v[100:103], a[132:135], a[76:79], v[100:103]
    ds_read_b64_tr_b16 a[140:141], v15 offset:50240
    v_rcp_f32 v64, v64
    v_rcp_f32 v65, v65
    v_mfma_f32_16x16x32_bf16 v[100:103], a[128:131], a[72:75], v[100:103]
    s_add_u32 m0, s69, 16384
    v_rcp_f32 v66, v66
    v_rcp_f32 v67, v67
    v_mfma_f32_16x16x32_bf16 v[100:103], a[100:103], a[12:15], v[100:103]
    ds_read_b64_tr_b16 a[142:143], v15 offset:53824
    v_mul_f32 v80, v80, v64
    v_mul_f32 v81, v81, v65
    v_mul_f32 v82, v82, v66
    v_mfma_f32_16x16x32_bf16 v[100:103], a[96:99], a[8:11], v[100:103]
    buffer_load_dwordx4 v21, s[40:43], s68 offen offset:0 lds
    v_mul_f32 v83, v83, v67
    v_cvt_pk_bf16_f32 v64, v80, v81
    v_cvt_pk_bf16_f32 v65, v82, v83
    v_mul_f32 v68, v29, v68
    v_mfma_f32_16x16x32_bf16 v[104:107], a[96:99], a[16:19], v[104:107]
    ds_read_b64_tr_b16 a[112:113], v15 offset:96
    v_mul_f32 v69, v29, v69
    v_mul_f32 v70, v29, v70
    v_mul_f32 v71, v29, v71
    v_exp_f32 v68, v68
    v_mfma_f32_16x16x32_bf16 v[104:107], a[100:103], a[20:23], v[104:107]
    buffer_load_dwordx4 v22, s[40:43], s68 offen offset:1024 lds
    v_exp_f32 v69, v69
    v_exp_f32 v70, v70
    v_mfma_f32_16x16x32_bf16 v[104:107], a[128:131], a[80:83], v[104:107]
    ds_read_b64_tr_b16 a[114:115], v15 offset:3680
    v_exp_f32 v71, v71
    v_add_f32 v68, 1.0, v68
    v_mfma_f32_16x16x32_bf16 v[104:107], a[132:135], a[84:87], v[104:107]
    buffer_load_dwordx4 v23, s[40:43], s68 offen offset:2048 lds
    v_add_f32 v69, 1.0, v69
    v_add_f32 v70, 1.0, v70
    v_add_f32 v71, 1.0, v71
    v_mfma_f32_16x16x32_bf16 v[108:111], a[132:135], a[92:95], v[108:111]
    ds_read_b64_tr_b16 a[116:117], v15 offset:7264
    v_rcp_f32 v68, v68
    v_rcp_f32 v69, v69
    v_mfma_f32_16x16x32_bf16 v[108:111], a[128:131], a[88:91], v[108:111]
    buffer_load_dwordx4 v24, s[40:43], s68 offen offset:3072 lds
    v_rcp_f32 v70, v70
    v_rcp_f32 v71, v71
    v_mul_f32 v84, v84, v68
    v_mfma_f32_16x16x32_bf16 v[108:111], a[100:103], a[28:31], v[108:111]
    ds_read_b64_tr_b16 a[118:119], v15 offset:10848
    v_mul_f32 v85, v85, v69
    v_mul_f32 v86, v86, v70
    v_mul_f32 v87, v87, v71
    v_cvt_pk_bf16_f32 v66, v84, v85
    v_mfma_f32_16x16x32_bf16 v[108:111], a[96:99], a[24:27], v[108:111]
    s_waitcnt lgkmcnt(4)
    v_cvt_pk_bf16_f32 v67, v86, v87
    v_permlane32_swap_b32 v64, v66
    s_nop 0
    v_permlane32_swap_b32 v65, v67
    v_mul_f32 v72, v30, v72
    v_mfma_f32_16x16x32_bf16 v[124:127], a[104:107], a[24:27], v[124:127]
    ds_read_b64_tr_b16 a[144:145], v15 offset:28768
    v_mul_f32 v73, v30, v73
    v_mul_f32 v74, v30, v74
    v_mul_f32 v75, v30, v75
    v_mfma_f32_16x16x32_bf16 v[124:127], a[108:111], a[28:31], v[124:127]
    buffer_store_dwordx4 v[64:67], v13, s[32:35], s64 offen sc1
    v_exp_f32 v72, v72
    v_exp_f32 v73, v73
    v_mfma_f32_16x16x32_bf16 v[124:127], a[136:139], a[88:91], v[124:127]
    ds_read_b64_tr_b16 a[146:147], v15 offset:32352
    v_exp_f32 v74, v74
    v_exp_f32 v75, v75
    v_mfma_f32_16x16x32_bf16 v[124:127], a[140:143], a[92:95], v[124:127]
    s_sub_u32 s68, s68, 884736
    v_add_f32 v72, 1.0, v72
    v_add_f32 v73, 1.0, v73
    v_add_f32 v74, 1.0, v74
    v_add_f32 v75, 1.0, v75
    v_mfma_f32_16x16x32_bf16 v[120:123], a[140:143], a[84:87], v[120:123]
    ds_read_b64_tr_b16 a[148:149], v15 offset:35936
    v_rcp_f32 v72, v72
    v_rcp_f32 v73, v73
    v_mfma_f32_16x16x32_bf16 v[120:123], a[136:139], a[80:83], v[120:123]
    v_rcp_f32 v74, v74
    v_rcp_f32 v75, v75
    v_mfma_f32_16x16x32_bf16 v[120:123], a[108:111], a[20:23], v[120:123]
    ds_read_b64_tr_b16 a[150:151], v15 offset:39520
    v_mul_f32 v88, v88, v72
    v_mul_f32 v89, v89, v73
    v_mul_f32 v90, v90, v74
    v_mul_f32 v91, v91, v75
    v_mfma_f32_16x16x32_bf16 v[120:123], a[104:107], a[16:19], v[120:123]
    v_cvt_pk_bf16_f32 v72, v88, v89
    v_cvt_pk_bf16_f32 v73, v90, v91
    v_mul_f32 v76, v31, v76
    v_mul_f32 v77, v31, v77
    v_mfma_f32_16x16x32_bf16 v[116:119], a[104:107], a[8:11], v[116:119]
    ds_read_b64_tr_b16 a[120:121], v15 offset:14432
    v_mul_f32 v78, v31, v78
    v_mul_f32 v79, v31, v79
    v_exp_f32 v76, v76
    v_mfma_f32_16x16x32_bf16 v[116:119], a[108:111], a[12:15], v[116:119]
    v_exp_f32 v77, v77
    v_exp_f32 v78, v78
    v_mfma_f32_16x16x32_bf16 v[116:119], a[136:139], a[72:75], v[116:119]
    ds_read_b64_tr_b16 a[122:123], v15 offset:18016
    v_exp_f32 v79, v79
    v_add_f32 v76, 1.0, v76
    v_mfma_f32_16x16x32_bf16 v[116:119], a[140:143], a[76:79], v[116:119]
    v_add_f32 v77, 1.0, v77
    v_add_f32 v78, 1.0, v78
    v_add_f32 v79, 1.0, v79
    v_rcp_f32 v76, v76
    v_mfma_f32_16x16x32_bf16 v[112:115], a[140:143], a[68:71], v[112:115]
    ds_read_b64_tr_b16 a[124:125], v15 offset:21600
    v_rcp_f32 v77, v77
    v_rcp_f32 v78, v78
    v_mfma_f32_16x16x32_bf16 v[112:115], a[136:139], a[64:67], v[112:115]
    v_rcp_f32 v79, v79
    v_mul_f32 v92, v92, v76
    v_mfma_f32_16x16x32_bf16 v[112:115], a[108:111], a[4:7], v[112:115]
    ds_read_b64_tr_b16 a[126:127], v15 offset:25184
    v_mul_f32 v93, v93, v77
    v_mul_f32 v94, v94, v78
    v_mul_f32 v95, v95, v79
    v_cvt_pk_bf16_f32 v74, v92, v93
    v_mfma_f32_16x16x32_bf16 v[112:115], a[104:107], a[0:3], v[112:115]
    s_waitcnt lgkmcnt(4)
    v_cvt_pk_bf16_f32 v75, v94, v95
    v_permlane32_swap_b32 v72, v74
    s_nop 0
    v_permlane32_swap_b32 v73, v75
    v_mfma_f32_16x16x32_bf16 v[128:131], a[112:115], a[0:3], v[128:131]
    ds_read_b64_tr_b16 a[152:153], v15 offset:43104
    v_mul_f32 v96, v28, v96
    v_mul_f32 v97, v28, v97
    v_mul_f32 v98, v28, v98
    v_mul_f32 v99, v28, v99
    v_mfma_f32_16x16x32_bf16 v[128:131], a[116:119], a[4:7], v[128:131]
    buffer_store_dwordx4 v[72:75], v14, s[32:35], s64 offen sc1
    v_exp_f32 v96, v96
    v_exp_f32 v97, v97
    v_mfma_f32_16x16x32_bf16 v[128:131], a[144:147], a[64:67], v[128:131]
    ds_read_b64_tr_b16 a[154:155], v15 offset:46688
    v_exp_f32 v98, v98
    v_exp_f32 v99, v99
    v_mfma_f32_16x16x32_bf16 v[128:131], a[148:151], a[68:71], v[128:131]
    s_add_u32 s64, s64, 4096
    v_add_f32 v96, 1.0, v96
    v_add_f32 v97, 1.0, v97
    v_add_f32 v98, 1.0, v98
    v_add_f32 v99, 1.0, v99
    v_mfma_f32_16x16x32_bf16 v[132:135], a[148:151], a[76:79], v[132:135]
    ds_read_b64_tr_b16 a[156:157], v15 offset:50272
    v_rcp_f32 v96, v96
    v_rcp_f32 v97, v97
    v_mfma_f32_16x16x32_bf16 v[132:135], a[144:147], a[72:75], v[132:135]
    s_waitcnt vmcnt(6)
    buffer_store_dword v3, v2, s[48:51], s73 offen sc1
    s_add_u32 s73, s73, 0x40000
    v_rcp_f32 v98, v98
    v_rcp_f32 v99, v99
    v_mfma_f32_16x16x32_bf16 v[132:135], a[116:119], a[12:15], v[132:135]
    ds_read_b64_tr_b16 a[158:159], v15 offset:53856
    v_mul_f32 v112, v112, v96
    v_mul_f32 v113, v113, v97
    v_mul_f32 v114, v114, v98
    v_mfma_f32_16x16x32_bf16 v[132:135], a[112:115], a[8:11], v[132:135]
    s_add_u32 m0, s69, 32768
    v_mul_f32 v115, v115, v99
    v_cvt_pk_bf16_f32 v96, v112, v113
    v_cvt_pk_bf16_f32 v97, v114, v115
    v_mul_f32 v100, v29, v100
    v_mfma_f32_16x16x32_bf16 v[136:139], a[112:115], a[16:19], v[136:139]
    ds_read_b64_tr_b16 a[96:97], v15 offset:128
    v_mul_f32 v101, v29, v101
    v_mul_f32 v102, v29, v102
    v_mul_f32 v103, v29, v103
    v_exp_f32 v100, v100
    v_mfma_f32_16x16x32_bf16 v[136:139], a[116:119], a[20:23], v[136:139]
    buffer_load_dwordx4 v21, s[40:43], s68 offen offset:0 lds
    v_exp_f32 v101, v101
    v_exp_f32 v102, v102
    v_mfma_f32_16x16x32_bf16 v[136:139], a[144:147], a[80:83], v[136:139]
    ds_read_b64_tr_b16 a[98:99], v15 offset:3712
    v_exp_f32 v103, v103
    v_add_f32 v100, 1.0, v100
    v_mfma_f32_16x16x32_bf16 v[136:139], a[148:151], a[84:87], v[136:139]
    buffer_load_dwordx4 v22, s[40:43], s68 offen offset:1024 lds
    v_add_f32 v101, 1.0, v101
    v_add_f32 v102, 1.0, v102
    v_add_f32 v103, 1.0, v103
    v_mfma_f32_16x16x32_bf16 v[140:143], a[148:151], a[92:95], v[140:143]
    ds_read_b64_tr_b16 a[100:101], v15 offset:7296
    v_rcp_f32 v100, v100
    v_rcp_f32 v101, v101
    v_mfma_f32_16x16x32_bf16 v[140:143], a[144:147], a[88:91], v[140:143]
    buffer_load_dwordx4 v23, s[40:43], s68 offen offset:2048 lds
    v_rcp_f32 v102, v102
    v_rcp_f32 v103, v103
    v_mul_f32 v116, v116, v100
    v_mfma_f32_16x16x32_bf16 v[140:143], a[116:119], a[28:31], v[140:143]
    ds_read_b64_tr_b16 a[102:103], v15 offset:10880
    v_mul_f32 v117, v117, v101
    v_mul_f32 v118, v118, v102
    v_mul_f32 v119, v119, v103
    v_cvt_pk_bf16_f32 v98, v116, v117
    v_mfma_f32_16x16x32_bf16 v[140:143], a[112:115], a[24:27], v[140:143]
    s_waitcnt lgkmcnt(4)
    v_cvt_pk_bf16_f32 v99, v118, v119
    v_permlane32_swap_b32 v96, v98
    s_nop 0
    v_permlane32_swap_b32 v97, v99
    v_mul_f32 v104, v30, v104
    v_mfma_f32_16x16x32_bf16 v[156:159], a[120:123], a[24:27], v[156:159]
    ds_read_b64_tr_b16 a[128:129], v15 offset:28800
    v_mul_f32 v105, v30, v105
    v_mul_f32 v106, v30, v106
    v_mul_f32 v107, v30, v107
    v_mfma_f32_16x16x32_bf16 v[156:159], a[124:127], a[28:31], v[156:159]
    buffer_store_dwordx4 v[96:99], v13, s[32:35], s64 offen sc1
    v_exp_f32 v104, v104
    v_exp_f32 v105, v105
    v_mfma_f32_16x16x32_bf16 v[156:159], a[152:155], a[88:91], v[156:159]
    ds_read_b64_tr_b16 a[130:131], v15 offset:32384
    v_exp_f32 v106, v106
    v_exp_f32 v107, v107
    v_mfma_f32_16x16x32_bf16 v[156:159], a[156:159], a[92:95], v[156:159]
    buffer_load_dwordx4 v24, s[40:43], s68 offen offset:3072 lds
    v_add_f32 v104, 1.0, v104
    v_add_f32 v105, 1.0, v105
    v_add_f32 v106, 1.0, v106
    v_add_f32 v107, 1.0, v107
    v_mfma_f32_16x16x32_bf16 v[152:155], a[156:159], a[84:87], v[152:155]
    ds_read_b64_tr_b16 a[132:133], v15 offset:35968
    v_rcp_f32 v104, v104
    v_rcp_f32 v105, v105
    v_mfma_f32_16x16x32_bf16 v[152:155], a[152:155], a[80:83], v[152:155]
    s_add_u32 s68, s68, 917504
    v_rcp_f32 v106, v106
    v_rcp_f32 v107, v107
    v_mfma_f32_16x16x32_bf16 v[152:155], a[124:127], a[20:23], v[152:155]
    ds_read_b64_tr_b16 a[134:135], v15 offset:39552
    v_mul_f32 v120, v120, v104
    v_mul_f32 v121, v121, v105
    v_mul_f32 v122, v122, v106
    v_mul_f32 v123, v123, v107
    v_mfma_f32_16x16x32_bf16 v[152:155], a[120:123], a[16:19], v[152:155]
    v_cvt_pk_bf16_f32 v104, v120, v121
    v_cvt_pk_bf16_f32 v105, v122, v123
    v_mul_f32 v108, v31, v108
    v_mul_f32 v109, v31, v109
    v_mfma_f32_16x16x32_bf16 v[148:151], a[120:123], a[8:11], v[148:151]
    ds_read_b64_tr_b16 a[104:105], v15 offset:14464
    v_mul_f32 v110, v31, v110
    v_mul_f32 v111, v31, v111
    v_exp_f32 v108, v108
    v_mfma_f32_16x16x32_bf16 v[148:151], a[124:127], a[12:15], v[148:151]
    v_exp_f32 v109, v109
    v_exp_f32 v110, v110
    v_mfma_f32_16x16x32_bf16 v[148:151], a[152:155], a[72:75], v[148:151]
    ds_read_b64_tr_b16 a[106:107], v15 offset:18048
    v_exp_f32 v111, v111
    v_add_f32 v108, 1.0, v108
    v_mfma_f32_16x16x32_bf16 v[148:151], a[156:159], a[76:79], v[148:151]
    v_add_f32 v109, 1.0, v109
    v_add_f32 v110, 1.0, v110
    v_add_f32 v111, 1.0, v111
    v_rcp_f32 v108, v108
    v_mfma_f32_16x16x32_bf16 v[144:147], a[156:159], a[68:71], v[144:147]
    ds_read_b64_tr_b16 a[108:109], v15 offset:21632
    v_rcp_f32 v109, v109
    v_rcp_f32 v110, v110
    v_mfma_f32_16x16x32_bf16 v[144:147], a[152:155], a[64:67], v[144:147]
    v_rcp_f32 v111, v111
    v_mul_f32 v124, v124, v108
    v_mfma_f32_16x16x32_bf16 v[144:147], a[124:127], a[4:7], v[144:147]
    ds_read_b64_tr_b16 a[110:111], v15 offset:25216
    v_mul_f32 v125, v125, v109
    v_mul_f32 v126, v126, v110
    v_mul_f32 v127, v127, v111
    v_cvt_pk_bf16_f32 v106, v124, v125
    v_mfma_f32_16x16x32_bf16 v[144:147], a[120:123], a[0:3], v[144:147]
    s_waitcnt lgkmcnt(4)
    v_cvt_pk_bf16_f32 v107, v126, v127
    v_permlane32_swap_b32 v104, v106
    s_nop 0
    v_permlane32_swap_b32 v105, v107
    v_mfma_f32_16x16x32_bf16 v[160:163], a[96:99], a[0:3], v[160:163]
    ds_read_b64_tr_b16 a[136:137], v15 offset:43136
    v_mul_f32 v128, v28, v128
    v_mul_f32 v129, v28, v129
    v_mul_f32 v130, v28, v130
    v_mul_f32 v131, v28, v131
    v_mfma_f32_16x16x32_bf16 v[160:163], a[100:103], a[4:7], v[160:163]
    buffer_store_dwordx4 v[104:107], v14, s[32:35], s64 offen sc1
    v_exp_f32 v128, v128
    v_exp_f32 v129, v129
    v_mfma_f32_16x16x32_bf16 v[160:163], a[128:131], a[64:67], v[160:163]
    ds_read_b64_tr_b16 a[138:139], v15 offset:46720
    v_exp_f32 v130, v130
    v_exp_f32 v131, v131
    v_mfma_f32_16x16x32_bf16 v[160:163], a[132:135], a[68:71], v[160:163]
    s_add_u32 s64, s64, 4096
    v_add_f32 v128, 1.0, v128
    v_add_f32 v129, 1.0, v129
    v_add_f32 v130, 1.0, v130
    v_add_f32 v131, 1.0, v131
    v_mfma_f32_16x16x32_bf16 v[164:167], a[132:135], a[76:79], v[164:167]
    ds_read_b64_tr_b16 a[140:141], v15 offset:50304
    v_rcp_f32 v128, v128
    v_rcp_f32 v129, v129
    v_mfma_f32_16x16x32_bf16 v[164:167], a[128:131], a[72:75], v[164:167]
    s_add_u32 m0, s69, 49152
    v_rcp_f32 v130, v130
    v_rcp_f32 v131, v131
    v_mfma_f32_16x16x32_bf16 v[164:167], a[100:103], a[12:15], v[164:167]
    ds_read_b64_tr_b16 a[142:143], v15 offset:53888
    v_mul_f32 v144, v144, v128
    v_mul_f32 v145, v145, v129
    v_mul_f32 v146, v146, v130
    v_mfma_f32_16x16x32_bf16 v[164:167], a[96:99], a[8:11], v[164:167]
    buffer_load_dwordx4 v21, s[40:43], s68 offen offset:0 lds
    v_mul_f32 v147, v147, v131
    v_cvt_pk_bf16_f32 v128, v144, v145
    v_cvt_pk_bf16_f32 v129, v146, v147
    v_mul_f32 v132, v29, v132
    v_mfma_f32_16x16x32_bf16 v[168:171], a[96:99], a[16:19], v[168:171]
    ds_read_b64_tr_b16 a[112:113], v15 offset:160
    v_mul_f32 v133, v29, v133
    v_mul_f32 v134, v29, v134
    v_mul_f32 v135, v29, v135
    v_exp_f32 v132, v132
    v_mfma_f32_16x16x32_bf16 v[168:171], a[100:103], a[20:23], v[168:171]
    buffer_load_dwordx4 v22, s[40:43], s68 offen offset:1024 lds
    v_exp_f32 v133, v133
    v_exp_f32 v134, v134
    v_mfma_f32_16x16x32_bf16 v[168:171], a[128:131], a[80:83], v[168:171]
    ds_read_b64_tr_b16 a[114:115], v15 offset:3744
    v_exp_f32 v135, v135
    v_add_f32 v132, 1.0, v132
    v_mfma_f32_16x16x32_bf16 v[168:171], a[132:135], a[84:87], v[168:171]
    buffer_load_dwordx4 v23, s[40:43], s68 offen offset:2048 lds
    v_add_f32 v133, 1.0, v133
    v_add_f32 v134, 1.0, v134
    v_add_f32 v135, 1.0, v135
    v_mfma_f32_16x16x32_bf16 v[172:175], a[132:135], a[92:95], v[172:175]
    ds_read_b64_tr_b16 a[116:117], v15 offset:7328
    v_rcp_f32 v132, v132
    v_rcp_f32 v133, v133
    v_mfma_f32_16x16x32_bf16 v[172:175], a[128:131], a[88:91], v[172:175]
    buffer_load_dwordx4 v24, s[40:43], s68 offen offset:3072 lds
    v_rcp_f32 v134, v134
    v_rcp_f32 v135, v135
    v_mul_f32 v148, v148, v132
    v_mfma_f32_16x16x32_bf16 v[172:175], a[100:103], a[28:31], v[172:175]
    ds_read_b64_tr_b16 a[118:119], v15 offset:10912
    v_mul_f32 v149, v149, v133
    v_mul_f32 v150, v150, v134
    v_mul_f32 v151, v151, v135
    v_cvt_pk_bf16_f32 v130, v148, v149
    v_mfma_f32_16x16x32_bf16 v[172:175], a[96:99], a[24:27], v[172:175]
    s_waitcnt lgkmcnt(4)
    v_cvt_pk_bf16_f32 v131, v150, v151
    v_permlane32_swap_b32 v128, v130
    s_nop 0
    v_permlane32_swap_b32 v129, v131
    v_mul_f32 v136, v30, v136
    v_mfma_f32_16x16x32_bf16 v[188:191], a[104:107], a[24:27], v[188:191]
    ds_read_b64_tr_b16 a[144:145], v15 offset:28832
    v_mul_f32 v137, v30, v137
    v_mul_f32 v138, v30, v138
    v_mul_f32 v139, v30, v139
    v_mfma_f32_16x16x32_bf16 v[188:191], a[108:111], a[28:31], v[188:191]
    buffer_store_dwordx4 v[128:131], v13, s[32:35], s64 offen sc1
    v_exp_f32 v136, v136
    v_exp_f32 v137, v137
    v_mfma_f32_16x16x32_bf16 v[188:191], a[136:139], a[88:91], v[188:191]
    ds_read_b64_tr_b16 a[146:147], v15 offset:32416
    v_exp_f32 v138, v138
    v_exp_f32 v139, v139
    v_mfma_f32_16x16x32_bf16 v[188:191], a[140:143], a[92:95], v[188:191]
    s_sub_u32 s68, s68, 884736
    v_add_f32 v136, 1.0, v136
    v_add_f32 v137, 1.0, v137
    v_add_f32 v138, 1.0, v138
    v_add_f32 v139, 1.0, v139
    v_mfma_f32_16x16x32_bf16 v[184:187], a[140:143], a[84:87], v[184:187]
    ds_read_b64_tr_b16 a[148:149], v15 offset:36000
    v_rcp_f32 v136, v136
    v_rcp_f32 v137, v137
    v_mfma_f32_16x16x32_bf16 v[184:187], a[136:139], a[80:83], v[184:187]
    v_rcp_f32 v138, v138
    v_rcp_f32 v139, v139
    v_mfma_f32_16x16x32_bf16 v[184:187], a[108:111], a[20:23], v[184:187]
    ds_read_b64_tr_b16 a[150:151], v15 offset:39584
    v_mul_f32 v152, v152, v136
    v_mul_f32 v153, v153, v137
    v_mul_f32 v154, v154, v138
    v_mul_f32 v155, v155, v139
    v_mfma_f32_16x16x32_bf16 v[184:187], a[104:107], a[16:19], v[184:187]
    v_cvt_pk_bf16_f32 v136, v152, v153
    v_cvt_pk_bf16_f32 v137, v154, v155
    v_mul_f32 v140, v31, v140
    v_mul_f32 v141, v31, v141
    v_mfma_f32_16x16x32_bf16 v[180:183], a[104:107], a[8:11], v[180:183]
    ds_read_b64_tr_b16 a[120:121], v15 offset:14496
    v_mul_f32 v142, v31, v142
    v_mul_f32 v143, v31, v143
    v_exp_f32 v140, v140
    v_mfma_f32_16x16x32_bf16 v[180:183], a[108:111], a[12:15], v[180:183]
    v_exp_f32 v141, v141
    v_exp_f32 v142, v142
    v_mfma_f32_16x16x32_bf16 v[180:183], a[136:139], a[72:75], v[180:183]
    ds_read_b64_tr_b16 a[122:123], v15 offset:18080
    v_exp_f32 v143, v143
    v_add_f32 v140, 1.0, v140
    v_mfma_f32_16x16x32_bf16 v[180:183], a[140:143], a[76:79], v[180:183]
    v_add_f32 v141, 1.0, v141
    v_add_f32 v142, 1.0, v142
    v_add_f32 v143, 1.0, v143
    v_rcp_f32 v140, v140
    v_mfma_f32_16x16x32_bf16 v[176:179], a[140:143], a[68:71], v[176:179]
    ds_read_b64_tr_b16 a[124:125], v15 offset:21664
    v_rcp_f32 v141, v141
    v_rcp_f32 v142, v142
    v_mfma_f32_16x16x32_bf16 v[176:179], a[136:139], a[64:67], v[176:179]
    buffer_load_dword v25, v9, s[48:51], s61 offen sc1
    v_rcp_f32 v143, v143
    v_mul_f32 v156, v156, v140
    v_mfma_f32_16x16x32_bf16 v[176:179], a[108:111], a[4:7], v[176:179]
    ds_read_b64_tr_b16 a[126:127], v15 offset:25248
    v_mul_f32 v157, v157, v141
    v_mul_f32 v158, v158, v142
    v_mul_f32 v159, v159, v143
    v_cvt_pk_bf16_f32 v138, v156, v157
    v_mfma_f32_16x16x32_bf16 v[176:179], a[104:107], a[0:3], v[176:179]
    s_waitcnt lgkmcnt(4)
    v_cvt_pk_bf16_f32 v139, v158, v159
    v_permlane32_swap_b32 v136, v138
    s_nop 0
    v_permlane32_swap_b32 v137, v139
    v_mfma_f32_16x16x32_bf16 v[192:195], a[112:115], a[0:3], v[192:195]
    ds_read_b64_tr_b16 a[152:153], v15 offset:43168
    v_mul_f32 v160, v28, v160
    v_mul_f32 v161, v28, v161
    v_mul_f32 v162, v28, v162
    v_mul_f32 v163, v28, v163
    v_mfma_f32_16x16x32_bf16 v[192:195], a[116:119], a[4:7], v[192:195]
    buffer_store_dwordx4 v[136:139], v14, s[32:35], s64 offen sc1
    s_add_u32 s64, s64, 4096
    v_exp_f32 v160, v160
    v_exp_f32 v161, v161
    v_mfma_f32_16x16x32_bf16 v[192:195], a[144:147], a[64:67], v[192:195]
    ds_read_b64_tr_b16 a[154:155], v15 offset:46752
    v_exp_f32 v162, v162
    v_exp_f32 v163, v163
    v_mfma_f32_16x16x32_bf16 v[192:195], a[148:151], a[68:71], v[192:195]
    s_add_u32 m0, s69, 65536
    v_add_f32 v160, 1.0, v160
    v_add_f32 v161, 1.0, v161
    v_add_f32 v162, 1.0, v162
    v_add_f32 v163, 1.0, v163
    v_mfma_f32_16x16x32_bf16 v[196:199], a[148:151], a[76:79], v[196:199]
    ds_read_b64_tr_b16 a[156:157], v15 offset:50336
    v_rcp_f32 v160, v160
    v_rcp_f32 v161, v161
    v_mfma_f32_16x16x32_bf16 v[196:199], a[144:147], a[72:75], v[196:199]
    buffer_load_dwordx4 v21, s[40:43], s68 offen offset:0 lds
    v_rcp_f32 v162, v162
    v_rcp_f32 v163, v163
    v_mfma_f32_16x16x32_bf16 v[196:199], a[116:119], a[12:15], v[196:199]
    ds_read_b64_tr_b16 a[158:159], v15 offset:53920
    v_mul_f32 v176, v176, v160
    v_mul_f32 v177, v177, v161
    v_mul_f32 v178, v178, v162
    v_mfma_f32_16x16x32_bf16 v[196:199], a[112:115], a[8:11], v[196:199]
    buffer_load_dwordx4 v22, s[40:43], s68 offen offset:1024 lds
    v_mul_f32 v179, v179, v163
    v_cvt_pk_bf16_f32 v160, v176, v177
    v_cvt_pk_bf16_f32 v161, v178, v179
    v_mul_f32 v164, v29, v164
    v_mfma_f32_16x16x32_bf16 v[200:203], a[112:115], a[16:19], v[200:203]
    ds_read_b64_tr_b16 a[96:97], v15 offset:192
    v_mul_f32 v165, v29, v165
    v_mul_f32 v166, v29, v166
    v_mul_f32 v167, v29, v167
    v_exp_f32 v164, v164
    v_mfma_f32_16x16x32_bf16 v[200:203], a[116:119], a[20:23], v[200:203]
    buffer_load_dwordx4 v23, s[40:43], s68 offen offset:2048 lds
    v_exp_f32 v165, v165
    v_exp_f32 v166, v166
    v_mfma_f32_16x16x32_bf16 v[200:203], a[144:147], a[80:83], v[200:203]
    ds_read_b64_tr_b16 a[98:99], v15 offset:3776
    v_exp_f32 v167, v167
    v_add_f32 v164, 1.0, v164
    v_mfma_f32_16x16x32_bf16 v[200:203], a[148:151], a[84:87], v[200:203]
    buffer_load_dwordx4 v24, s[40:43], s68 offen offset:3072 lds
    s_add_u32 s68, s68, 917504
    v_add_f32 v165, 1.0, v165
    v_add_f32 v166, 1.0, v166
    v_add_f32 v167, 1.0, v167
    v_mfma_f32_16x16x32_bf16 v[204:207], a[148:151], a[92:95], v[204:207]
    ds_read_b64_tr_b16 a[100:101], v15 offset:7360
    v_rcp_f32 v164, v164
    v_rcp_f32 v165, v165
    v_mfma_f32_16x16x32_bf16 v[204:207], a[144:147], a[88:91], v[204:207]
    v_rcp_f32 v166, v166
    v_rcp_f32 v167, v167
    v_mul_f32 v180, v180, v164
    v_mfma_f32_16x16x32_bf16 v[204:207], a[116:119], a[28:31], v[204:207]
    ds_read_b64_tr_b16 a[102:103], v15 offset:10944
    v_mul_f32 v181, v181, v165
    v_mul_f32 v182, v182, v166
    v_mul_f32 v183, v183, v167
    v_cvt_pk_bf16_f32 v162, v180, v181
    v_mfma_f32_16x16x32_bf16 v[204:207], a[112:115], a[24:27], v[204:207]
    s_waitcnt lgkmcnt(4)
    v_cvt_pk_bf16_f32 v163, v182, v183
    v_permlane32_swap_b32 v160, v162
    s_nop 0
    v_permlane32_swap_b32 v161, v163
    v_mul_f32 v168, v30, v168
    v_mfma_f32_16x16x32_bf16 v[220:223], a[120:123], a[24:27], v[220:223]
    ds_read_b64_tr_b16 a[128:129], v15 offset:28864
    v_mul_f32 v169, v30, v169
    v_mul_f32 v170, v30, v170
    v_mul_f32 v171, v30, v171
    v_mfma_f32_16x16x32_bf16 v[220:223], a[124:127], a[28:31], v[220:223]
    buffer_store_dwordx4 v[160:163], v13, s[32:35], s64 offen sc1
    v_exp_f32 v168, v168
    v_exp_f32 v169, v169
    v_mfma_f32_16x16x32_bf16 v[220:223], a[152:155], a[88:91], v[220:223]
    ds_read_b64_tr_b16 a[130:131], v15 offset:32448
    v_exp_f32 v170, v170
    v_exp_f32 v171, v171
    v_mfma_f32_16x16x32_bf16 v[220:223], a[156:159], a[92:95], v[220:223]
    v_add_f32 v168, 1.0, v168
    v_add_f32 v169, 1.0, v169
    v_add_f32 v170, 1.0, v170
    v_add_f32 v171, 1.0, v171
    v_mfma_f32_16x16x32_bf16 v[216:219], a[156:159], a[84:87], v[216:219]
    ds_read_b64_tr_b16 a[132:133], v15 offset:36032
    v_rcp_f32 v168, v168
    v_rcp_f32 v169, v169
    v_mfma_f32_16x16x32_bf16 v[216:219], a[152:155], a[80:83], v[216:219]
    s_waitcnt vmcnt(6)
    v_cmp_gt_u32 vcc, 1, v25
    s_nop 0
    s_cbranch_vccnz F_fpoll0
F_fpoll0_done:
    s_add_u32 s61, s61, 0x40000
    v_rcp_f32 v170, v170
    v_rcp_f32 v171, v171
    v_mfma_f32_16x16x32_bf16 v[216:219], a[124:127], a[20:23], v[216:219]
    ds_read_b64_tr_b16 a[134:135], v15 offset:39616
    v_mul_f32 v184, v184, v168
    v_mul_f32 v185, v185, v169
    v_mul_f32 v186, v186, v170
    v_mul_f32 v187, v187, v171
    v_mfma_f32_16x16x32_bf16 v[216:219], a[120:123], a[16:19], v[216:219]
    buffer_load_dwordx4 a[160:163], v1, s[32:35], s62 offen offset:0 sc1
    v_cvt_pk_bf16_f32 v168, v184, v185
    v_cvt_pk_bf16_f32 v169, v186, v187
    v_mul_f32 v172, v31, v172
    v_mul_f32 v173, v31, v173
    v_mfma_f32_16x16x32_bf16 v[212:215], a[120:123], a[8:11], v[212:215]
    ds_read_b64_tr_b16 a[104:105], v15 offset:14528
    v_mul_f32 v174, v31, v174
    v_mul_f32 v175, v31, v175
    v_exp_f32 v172, v172
    v_mfma_f32_16x16x32_bf16 v[212:215], a[124:127], a[12:15], v[212:215]
    buffer_load_dwordx4 a[164:167], v1, s[32:35], s62 offen offset:1024 sc1
    v_exp_f32 v173, v173
    v_exp_f32 v174, v174
    v_mfma_f32_16x16x32_bf16 v[212:215], a[152:155], a[72:75], v[212:215]
    ds_read_b64_tr_b16 a[106:107], v15 offset:18112
    v_exp_f32 v175, v175
    v_add_f32 v172, 1.0, v172
    v_mfma_f32_16x16x32_bf16 v[212:215], a[156:159], a[76:79], v[212:215]
    buffer_load_dwordx4 a[168:171], v12, s[32:35], s62 offen offset:0 sc1
    v_add_f32 v173, 1.0, v173
    v_add_f32 v174, 1.0, v174
    v_add_f32 v175, 1.0, v175
    v_rcp_f32 v172, v172
    v_mfma_f32_16x16x32_bf16 v[208:211], a[156:159], a[68:71], v[208:211]
    ds_read_b64_tr_b16 a[108:109], v15 offset:21696
    v_rcp_f32 v173, v173
    v_rcp_f32 v174, v174
    v_mfma_f32_16x16x32_bf16 v[208:211], a[152:155], a[64:67], v[208:211]
    buffer_load_dwordx4 a[172:175], v12, s[32:35], s62 offen offset:1024 sc1
    s_add_u32 s62, s62, 2048
    v_rcp_f32 v175, v175
    v_mul_f32 v188, v188, v172
    v_mfma_f32_16x16x32_bf16 v[208:211], a[124:127], a[4:7], v[208:211]
    ds_read_b64_tr_b16 a[110:111], v15 offset:25280
    v_mul_f32 v189, v189, v173
    v_mul_f32 v190, v190, v174
    v_mul_f32 v191, v191, v175
    v_cvt_pk_bf16_f32 v170, v188, v189
    v_mfma_f32_16x16x32_bf16 v[208:211], a[120:123], a[0:3], v[208:211]
    s_waitcnt lgkmcnt(4)
    v_cvt_pk_bf16_f32 v171, v190, v191
    v_permlane32_swap_b32 v168, v170
    s_nop 0
    v_permlane32_swap_b32 v169, v171
    v_mfma_f32_16x16x32_bf16 v[224:227], a[96:99], a[0:3], v[224:227]
    ds_read_b64_tr_b16 a[136:137], v15 offset:43200
    v_mul_f32 v192, v28, v192
    v_mul_f32 v193, v28, v193
    v_mul_f32 v194, v28, v194
    v_mul_f32 v195, v28, v195
    v_mfma_f32_16x16x32_bf16 v[224:227], a[100:103], a[4:7], v[224:227]
    buffer_store_dwordx4 v[168:171], v14, s[32:35], s64 offen sc1
    s_add_u32 s64, s64, 4096
    v_exp_f32 v192, v192
    v_exp_f32 v193, v193
    v_mfma_f32_16x16x32_bf16 v[224:227], a[128:131], a[64:67], v[224:227]
    ds_read_b64_tr_b16 a[138:139], v15 offset:46784
    v_exp_f32 v194, v194
    v_exp_f32 v195, v195
    v_mfma_f32_16x16x32_bf16 v[224:227], a[132:135], a[68:71], v[224:227]
    buffer_load_dwordx4 a[176:179], v1, s[32:35], s63 offen offset:0 sc1
    v_add_f32 v192, 1.0, v192
    v_add_f32 v193, 1.0, v193
    v_add_f32 v194, 1.0, v194
    v_add_f32 v195, 1.0, v195
    v_mfma_f32_16x16x32_bf16 v[228:231], a[132:135], a[76:79], v[228:231]
    ds_read_b64_tr_b16 a[140:141], v15 offset:50368
    v_rcp_f32 v192, v192
    v_rcp_f32 v193, v193
    v_mfma_f32_16x16x32_bf16 v[228:231], a[128:131], a[72:75], v[228:231]
    s_waitcnt vmcnt(11)
    buffer_store_dword v3, v2, s[48:51], s73 offen sc1
    s_add_u32 s73, s73, 0x40000
    v_rcp_f32 v194, v194
    v_rcp_f32 v195, v195
    v_mfma_f32_16x16x32_bf16 v[228:231], a[100:103], a[12:15], v[228:231]
    ds_read_b64_tr_b16 a[142:143], v15 offset:53952
    v_mul_f32 v208, v208, v192
    v_mul_f32 v209, v209, v193
    v_mul_f32 v210, v210, v194
    v_mfma_f32_16x16x32_bf16 v[228:231], a[96:99], a[8:11], v[228:231]
    buffer_load_dwordx4 a[180:183], v1, s[32:35], s63 offen offset:1024 sc1
    v_mul_f32 v211, v211, v195
    v_cvt_pk_bf16_f32 v192, v208, v209
    v_cvt_pk_bf16_f32 v193, v210, v211
    v_mul_f32 v196, v29, v196
    v_mfma_f32_16x16x32_bf16 v[232:235], a[96:99], a[16:19], v[232:235]
    buffer_load_dwordx4 a[184:187], v12, s[32:35], s63 offen offset:0 sc1
    v_mul_f32 v197, v29, v197
    v_mul_f32 v198, v29, v198
    v_mul_f32 v199, v29, v199
    v_exp_f32 v196, v196
    v_mfma_f32_16x16x32_bf16 v[232:235], a[100:103], a[20:23], v[232:235]
    buffer_load_dwordx4 a[188:191], v12, s[32:35], s63 offen offset:1024 sc1
    s_add_u32 s63, s63, 2048
    v_exp_f32 v197, v197
    v_exp_f32 v198, v198
    v_mfma_f32_16x16x32_bf16 v[232:235], a[128:131], a[80:83], v[232:235]
    s_add_u32 m0, s69, 81920
    v_exp_f32 v199, v199
    v_add_f32 v196, 1.0, v196
    v_mfma_f32_16x16x32_bf16 v[232:235], a[132:135], a[84:87], v[232:235]
    buffer_load_dwordx4 v21, s[40:43], s68 offen offset:0 lds
    v_add_f32 v197, 1.0, v197
    v_add_f32 v198, 1.0, v198
    v_add_f32 v199, 1.0, v199
    v_mfma_f32_16x16x32_bf16 v[236:239], a[132:135], a[92:95], v[236:239]
    buffer_load_dwordx4 v22, s[40:43], s68 offen offset:1024 lds
    v_rcp_f32 v196, v196
    v_rcp_f32 v197, v197
    v_mfma_f32_16x16x32_bf16 v[236:239], a[128:131], a[88:91], v[236:239]
    buffer_load_dwordx4 v23, s[40:43], s68 offen offset:2048 lds
    v_rcp_f32 v198, v198
    v_rcp_f32 v199, v199
    v_mul_f32 v212, v212, v196
    v_mfma_f32_16x16x32_bf16 v[236:239], a[100:103], a[28:31], v[236:239]
    buffer_load_dwordx4 v24, s[40:43], s68 offen offset:3072 lds
    s_sub_u32 s68, s68, 884736
    v_mul_f32 v213, v213, v197
    v_mul_f32 v214, v214, v198
    v_mul_f32 v215, v215, v199
    v_cvt_pk_bf16_f32 v194, v212, v213
    v_mfma_f32_16x16x32_bf16 v[236:239], a[96:99], a[24:27], v[236:239]
    s_waitcnt lgkmcnt(0)
    v_cvt_pk_bf16_f32 v195, v214, v215
    v_permlane32_swap_b32 v192, v194
    s_nop 0
    v_permlane32_swap_b32 v193, v195
    v_mul_f32 v200, v30, v200
    v_mfma_f32_16x16x32_bf16 v[252:255], a[104:107], a[24:27], v[252:255]
    s_barrier
    ds_read_b64_tr_b16 v[40:41], v16 offset:0
    v_mul_f32 v201, v30, v201
    v_mul_f32 v202, v30, v202
    v_mul_f32 v203, v30, v203
    v_mfma_f32_16x16x32_bf16 v[252:255], a[108:111], a[28:31], v[252:255]
    buffer_store_dwordx4 v[192:195], v13, s[32:35], s64 offen sc1
    v_exp_f32 v200, v200
    v_exp_f32 v201, v201
    v_mfma_f32_16x16x32_bf16 v[252:255], a[136:139], a[88:91], v[252:255]
    ds_read_b64_tr_b16 v[42:43], v16 offset:1024
    v_exp_f32 v202, v202
    v_exp_f32 v203, v203
    v_mfma_f32_16x16x32_bf16 v[252:255], a[140:143], a[92:95], v[252:255]
    buffer_load_dwordx4 a[192:195], v1, s[32:35], s62 offen offset:0 sc1
    v_add_f32 v200, 1.0, v200
    v_add_f32 v201, 1.0, v201
    v_add_f32 v202, 1.0, v202
    v_add_f32 v203, 1.0, v203
    v_mfma_f32_16x16x32_bf16 v[248:251], a[140:143], a[84:87], v[248:251]
    ds_read_b64_tr_b16 v[44:45], v16 offset:8192
    v_rcp_f32 v200, v200
    v_rcp_f32 v201, v201
    v_mfma_f32_16x16x32_bf16 v[248:251], a[136:139], a[80:83], v[248:251]
    buffer_load_dwordx4 a[196:199], v1, s[32:35], s62 offen offset:1024 sc1
    v_rcp_f32 v202, v202
    v_rcp_f32 v203, v203
    v_mfma_f32_16x16x32_bf16 v[248:251], a[108:111], a[20:23], v[248:251]
    ds_read_b64_tr_b16 v[46:47], v16 offset:9216
    v_mul_f32 v216, v216, v200
    v_mul_f32 v217, v217, v201
    v_mul_f32 v218, v218, v202
    v_mul_f32 v219, v219, v203
    v_mfma_f32_16x16x32_bf16 v[248:251], a[104:107], a[16:19], v[248:251]
    buffer_load_dwordx4 a[200:203], v12, s[32:35], s62 offen offset:0 sc1
    v_cvt_pk_bf16_f32 v200, v216, v217
    v_cvt_pk_bf16_f32 v201, v218, v219
    v_mul_f32 v204, v31, v204
    v_mul_f32 v205, v31, v205
    v_mfma_f32_16x16x32_bf16 v[244:247], a[104:107], a[8:11], v[244:247]
    ds_read_b64_tr_b16 v[48:49], v17 offset:0
    v_mul_f32 v206, v31, v206
    v_mul_f32 v207, v31, v207
    v_exp_f32 v204, v204
    v_mfma_f32_16x16x32_bf16 v[244:247], a[108:111], a[12:15], v[244:247]
    buffer_load_dwordx4 a[204:207], v12, s[32:35], s62 offen offset:1024 sc1
    s_add_u32 s62, s62, 2048
    v_exp_f32 v205, v205
    v_exp_f32 v206, v206
    v_mfma_f32_16x16x32_bf16 v[244:247], a[136:139], a[72:75], v[244:247]
    ds_read_b64_tr_b16 v[50:51], v17 offset:1024
    v_exp_f32 v207, v207
    v_add_f32 v204, 1.0, v204
    v_mfma_f32_16x16x32_bf16 v[244:247], a[140:143], a[76:79], v[244:247]
    buffer_load_dwordx4 a[208:211], v1, s[32:35], s63 offen offset:0 sc1
    v_add_f32 v205, 1.0, v205
    v_add_f32 v206, 1.0, v206
    v_add_f32 v207, 1.0, v207
    v_rcp_f32 v204, v204
    v_mfma_f32_16x16x32_bf16 v[240:243], a[140:143], a[68:71], v[240:243]
    ds_read_b64_tr_b16 v[52:53], v17 offset:8192
    v_rcp_f32 v205, v205
    v_rcp_f32 v206, v206
    v_mfma_f32_16x16x32_bf16 v[240:243], a[136:139], a[64:67], v[240:243]
    buffer_load_dwordx4 a[212:215], v1, s[32:35], s63 offen offset:1024 sc1
    v_rcp_f32 v207, v207
    v_mul_f32 v220, v220, v204
    v_mfma_f32_16x16x32_bf16 v[240:243], a[108:111], a[4:7], v[240:243]
    ds_read_b64_tr_b16 v[54:55], v17 offset:9216
    v_mul_f32 v221, v221, v205
    v_mul_f32 v222, v222, v206
    v_mul_f32 v223, v223, v207
    v_cvt_pk_bf16_f32 v202, v220, v221
    v_mfma_f32_16x16x32_bf16 v[240:243], a[104:107], a[0:3], v[240:243]
    v_cvt_pk_bf16_f32 v203, v222, v223
    v_permlane32_swap_b32 v200, v202
    s_nop 0
    v_permlane32_swap_b32 v201, v203
    s_waitcnt vmcnt(20) lgkmcnt(6)
    v_mfma_f32_16x16x32_bf16 v[96:99], v[40:43], a[160:163], 0
    ds_read_b64_tr_b16 v[56:57], v18 offset:0
    v_mul_f32 v224, v28, v224
    v_mul_f32 v225, v28, v225
    s_waitcnt vmcnt(19) lgkmcnt(5)
    v_mfma_f32_16x16x32_bf16 v[96:99], v[44:47], a[164:167], v[96:99]
    buffer_store_dwordx4 v[200:203], v14, s[32:35], s64 offen sc1
    v_mul_f32 v226, v28, v226
    v_mul_f32 v227, v28, v227
    s_waitcnt vmcnt(18)
    v_mfma_f32_16x16x32_bf16 v[100:103], v[44:47], a[172:175], 0
    ds_read_b64_tr_b16 v[58:59], v18 offset:1024
    v_exp_f32 v224, v224
    v_mfma_f32_16x16x32_bf16 v[100:103], v[40:43], a[168:171], v[100:103]
    s_add_u32 s64, s64, 4096
    v_exp_f32 v225, v225
    s_waitcnt vmcnt(16)
    v_mfma_f32_16x16x32_bf16 v[160:163], v[40:43], a[176:179], 0
    ds_read_b64_tr_b16 v[60:61], v18 offset:8192
    v_exp_f32 v226, v226
    s_waitcnt vmcnt(14)
    v_mfma_f32_16x16x32_bf16 v[160:163], v[44:47], a[180:183], v[160:163]
    buffer_load_dwordx4 a[216:219], v12, s[32:35], s63 offen offset:0 sc1
    v_exp_f32 v227, v227
    s_waitcnt vmcnt(13)
    v_mfma_f32_16x16x32_bf16 v[164:167], v[44:47], a[188:191], 0
    ds_read_b64_tr_b16 v[62:63], v18 offset:9216
    v_add_f32 v224, 1.0, v224
    v_add_f32 v225, 1.0, v225
    v_mfma_f32_16x16x32_bf16 v[164:167], v[40:43], a[184:187], v[164:167]
    s_waitcnt lgkmcnt(4)
    v_add_f32 v226, 1.0, v226
    v_add_f32 v227, 1.0, v227
    v_mfma_f32_16x16x32_bf16 v[172:175], v[48:51], a[184:187], 0
    ds_read_b64_tr_b16 v[64:65], v19 offset:0
    v_rcp_f32 v224, v224
    v_mfma_f32_16x16x32_bf16 v[172:175], v[52:55], a[188:191], v[172:175]
    buffer_load_dwordx4 a[220:223], v12, s[32:35], s63 offen offset:1024 sc1
    v_rcp_f32 v225, v225
    v_mfma_f32_16x16x32_bf16 v[168:171], v[52:55], a[180:183], 0
    ds_read_b64_tr_b16 v[66:67], v19 offset:1024
    v_rcp_f32 v226, v226
    v_mfma_f32_16x16x32_bf16 v[168:171], v[48:51], a[176:179], v[168:171]
    s_add_u32 s63, s63, 2048
    s_add_u32 m0, s69, 98304
    v_rcp_f32 v227, v227
    v_mfma_f32_16x16x32_bf16 v[108:111], v[48:51], a[168:171], 0
    ds_read_b64_tr_b16 v[68:69], v19 offset:8192
    v_mul_f32 v240, v240, v224
    v_mul_f32 v241, v241, v225
    v_mfma_f32_16x16x32_bf16 v[108:111], v[52:55], a[172:175], v[108:111]
    buffer_load_dwordx4 v21, s[40:43], s68 offen offset:0 lds
    v_mul_f32 v242, v242, v226
    v_mul_f32 v243, v243, v227
    v_mfma_f32_16x16x32_bf16 v[104:107], v[52:55], a[164:167], 0
    ds_read_b64_tr_b16 v[70:71], v19 offset:9216
    v_cvt_pk_bf16_f32 v224, v240, v241
    v_cvt_pk_bf16_f32 v225, v242, v243
    v_mfma_f32_16x16x32_bf16 v[104:107], v[48:51], a[160:163], v[104:107]
    s_waitcnt lgkmcnt(4)
    v_mul_f32 v228, v29, v228
    v_mul_f32 v229, v29, v229
    v_mfma_f32_16x16x32_bf16 v[112:115], v[56:59], a[160:163], 0
    ds_read_b64_tr_b16 v[40:41], v16 offset:2048
    v_mul_f32 v230, v29, v230
    v_mul_f32 v231, v29, v231
    v_mfma_f32_16x16x32_bf16 v[112:115], v[60:63], a[164:167], v[112:115]
    buffer_load_dwordx4 v22, s[40:43], s68 offen offset:1024 lds
    v_exp_f32 v228, v228
    v_mfma_f32_16x16x32_bf16 v[116:119], v[60:63], a[172:175], 0
    ds_read_b64_tr_b16 v[42:43], v16 offset:3072
    v_exp_f32 v229, v229
    v_mfma_f32_16x16x32_bf16 v[116:119], v[56:59], a[168:171], v[116:119]
    v_exp_f32 v230, v230
    v_mfma_f32_16x16x32_bf16 v[176:179], v[56:59], a[176:179], 0
    ds_read_b64_tr_b16 v[44:45], v16 offset:10240
    v_exp_f32 v231, v231
    v_mfma_f32_16x16x32_bf16 v[176:179], v[60:63], a[180:183], v[176:179]
    buffer_load_dwordx4 v23, s[40:43], s68 offen offset:2048 lds
    v_add_f32 v228, 1.0, v228
    v_add_f32 v229, 1.0, v229
    v_mfma_f32_16x16x32_bf16 v[180:183], v[60:63], a[188:191], 0
    ds_read_b64_tr_b16 v[46:47], v16 offset:11264
    v_add_f32 v230, 1.0, v230
    v_add_f32 v231, 1.0, v231
    v_mfma_f32_16x16x32_bf16 v[180:183], v[56:59], a[184:187], v[180:183]
    s_waitcnt lgkmcnt(4)
    v_rcp_f32 v228, v228
    v_mfma_f32_16x16x32_bf16 v[188:191], v[64:67], a[184:187], 0
    ds_read_b64_tr_b16 v[48:49], v17 offset:2048
    v_rcp_f32 v229, v229
    v_mfma_f32_16x16x32_bf16 v[188:191], v[68:71], a[188:191], v[188:191]
    buffer_load_dwordx4 v24, s[40:43], s68 offen offset:3072 lds
    v_rcp_f32 v230, v230
    v_mfma_f32_16x16x32_bf16 v[184:187], v[68:71], a[180:183], 0
    ds_read_b64_tr_b16 v[50:51], v17 offset:3072
    v_rcp_f32 v231, v231
    v_mfma_f32_16x16x32_bf16 v[184:187], v[64:67], a[176:179], v[184:187]
    s_add_u32 s68, s68, 917504
    v_mul_f32 v244, v244, v228
    v_mul_f32 v245, v245, v229
    v_mfma_f32_16x16x32_bf16 v[124:127], v[64:67], a[168:171], 0
    ds_read_b64_tr_b16 v[52:53], v17 offset:10240
    v_mul_f32 v246, v246, v230
    v_mul_f32 v247, v247, v231
    v_mfma_f32_16x16x32_bf16 v[124:127], v[68:71], a[172:175], v[124:127]
    buffer_load_dword v25, v9, s[48:51], s61 offen sc1
    v_cvt_pk_bf16_f32 v226, v244, v245
    v_cvt_pk_bf16_f32 v227, v246, v247
    v_mfma_f32_16x16x32_bf16 v[120:123], v[68:71], a[164:167], 0
    ds_read_b64_tr_b16 v[54:55], v17 offset:11264
    v_permlane32_swap_b32 v224, v226
    v_permlane32_swap_b32 v225, v227
    v_mul_f32 v232, v30, v232
    v_mfma_f32_16x16x32_bf16 v[120:123], v[64:67], a[160:163], v[120:123]
    s_waitcnt lgkmcnt(4)
    v_mul_f32 v233, v30, v233
    v_mul_f32 v234, v30, v234
    v_mfma_f32_16x16x32_bf16 v[128:131], v[40:43], a[160:163], 0
    ds_read_b64_tr_b16 v[56:57], v18 offset:2048
    v_mul_f32 v235, v30, v235
    v_mfma_f32_16x16x32_bf16 v[128:131], v[44:47], a[164:167], v[128:131]
    buffer_store_dwordx4 v[224:227], v13, s[32:35], s64 offen sc1
    v_exp_f32 v232, v232
    v_mfma_f32_16x16x32_bf16 v[132:135], v[44:47], a[172:175], 0
    ds_read_b64_tr_b16 v[58:59], v18 offset:3072
    v_exp_f32 v233, v233
    v_mfma_f32_16x16x32_bf16 v[132:135], v[40:43], a[168:171], v[132:135]
    s_add_u32 m0, s69, 114688
    v_exp_f32 v234, v234
    v_mfma_f32_16x16x32_bf16 v[192:195], v[40:43], a[176:179], 0
    ds_read_b64_tr_b16 v[60:61], v18 offset:10240
    v_exp_f32 v235, v235
    v_add_f32 v232, 1.0, v232
    v_mfma_f32_16x16x32_bf16 v[192:195], v[44:47], a[180:183], v[192:195]
    buffer_load_dwordx4 v21, s[40:43], s68 offen offset:0 lds
    v_add_f32 v233, 1.0, v233
    v_add_f32 v234, 1.0, v234
    v_mfma_f32_16x16x32_bf16 v[196:199], v[44:47], a[188:191], 0
    ds_read_b64_tr_b16 v[62:63], v18 offset:11264
    v_add_f32 v235, 1.0, v235
    v_mfma_f32_16x16x32_bf16 v[196:199], v[40:43], a[184:187], v[196:199]
    s_waitcnt lgkmcnt(4)
    v_rcp_f32 v232, v232
    v_mfma_f32_16x16x32_bf16 v[204:207], v[48:51], a[184:187], 0
    ds_read_b64_tr_b16 v[64:65], v19 offset:2048
    v_rcp_f32 v233, v233
    v_mfma_f32_16x16x32_bf16 v[204:207], v[52:55], a[188:191], v[204:207]
    buffer_load_dwordx4 v22, s[40:43], s68 offen offset:1024 lds
    v_rcp_f32 v234, v234
    v_mfma_f32_16x16x32_bf16 v[200:203], v[52:55], a[180:183], 0
    ds_read_b64_tr_b16 v[66:67], v19 offset:3072
    v_rcp_f32 v235, v235
    v_mul_f32 v248, v248, v232
    v_mfma_f32_16x16x32_bf16 v[200:203], v[48:51], a[176:179], v[200:203]
    v_mul_f32 v249, v249, v233
    v_mul_f32 v250, v250, v234
    v_mfma_f32_16x16x32_bf16 v[140:143], v[48:51], a[168:171], 0
    ds_read_b64_tr_b16 v[68:69], v19 offset:10240
    v_mul_f32 v251, v251, v235
    v_cvt_pk_bf16_f32 v232, v248, v249
    v_mfma_f32_16x16x32_bf16 v[140:143], v[52:55], a[172:175], v[140:143]
    buffer_load_dwordx4 v23, s[40:43], s68 offen offset:2048 lds
    v_cvt_pk_bf16_f32 v233, v250, v251
    v_mul_f32 v236, v31, v236
    v_mfma_f32_16x16x32_bf16 v[136:139], v[52:55], a[164:167], 0
    ds_read_b64_tr_b16 v[70:71], v19 offset:11264
    v_mul_f32 v237, v31, v237
    v_mul_f32 v238, v31, v238
    v_mfma_f32_16x16x32_bf16 v[136:139], v[48:51], a[160:163], v[136:139]
    s_waitcnt lgkmcnt(4)
    v_mul_f32 v239, v31, v239
    v_mfma_f32_16x16x32_bf16 v[144:147], v[56:59], a[160:163], 0
    ds_read_b64_tr_b16 v[40:41], v16 offset:16384
    v_exp_f32 v236, v236
    v_mfma_f32_16x16x32_bf16 v[144:147], v[60:63], a[164:167], v[144:147]
    buffer_load_dwordx4 v24, s[40:43], s68 offen offset:3072 lds
    v_exp_f32 v237, v237
    v_mfma_f32_16x16x32_bf16 v[148:151], v[60:63], a[172:175], 0
    ds_read_b64_tr_b16 v[42:43], v16 offset:17408
    v_exp_f32 v238, v238
    v_mfma_f32_16x16x32_bf16 v[148:151], v[56:59], a[168:171], v[148:151]
    s_sub_u32 s68, s68, 884736
    v_exp_f32 v239, v239
    v_add_f32 v236, 1.0, v236
    v_mfma_f32_16x16x32_bf16 v[208:211], v[56:59], a[176:179], 0
    ds_read_b64_tr_b16 v[44:45], v16 offset:24576
    v_add_f32 v237, 1.0, v237
    v_add_f32 v238, 1.0, v238
    v_mfma_f32_16x16x32_bf16 v[208:211], v[60:63], a[180:183], v[208:211]
    v_add_f32 v239, 1.0, v239
    v_mfma_f32_16x16x32_bf16 v[212:215], v[60:63], a[188:191], 0
    ds_read_b64_tr_b16 v[46:47], v16 offset:25600
    v_rcp_f32 v236, v236
    v_mfma_f32_16x16x32_bf16 v[212:215], v[56:59], a[184:187], v[212:215]
    s_waitcnt lgkmcnt(4)
    s_waitcnt vmcnt(5)
    v_cmp_gt_u32 vcc, 1, v25
    s_nop 0
    s_cbranch_vccnz F_fpoll1
F_fpoll1_done:
    s_add_u32 s61, s61, 0x40000
    v_rcp_f32 v237, v237
    v_mfma_f32_16x16x32_bf16 v[220:223], v[64:67], a[184:187], 0
    ds_read_b64_tr_b16 v[48:49], v17 offset:16384
    v_rcp_f32 v238, v238
    v_mfma_f32_16x16x32_bf16 v[220:223], v[68:71], a[188:191], v[220:223]
    buffer_load_dwordx4 a[32:35], v1, s[32:35], s62 offen offset:0 sc1
    v_rcp_f32 v239, v239
    v_mul_f32 v252, v252, v236
    v_mfma_f32_16x16x32_bf16 v[216:219], v[68:71], a[180:183], 0
    ds_read_b64_tr_b16 v[50:51], v17 offset:17408
    v_mul_f32 v253, v253, v237
    v_mul_f32 v254, v254, v238
    v_mfma_f32_16x16x32_bf16 v[216:219], v[64:67], a[176:179], v[216:219]
    v_mul_f32 v255, v255, v239
    v_cvt_pk_bf16_f32 v234, v252, v253
    v_mfma_f32_16x16x32_bf16 v[156:159], v[64:67], a[168:171], 0
    ds_read_b64_tr_b16 v[52:53], v17 offset:24576
    v_cvt_pk_bf16_f32 v235, v254, v255
    v_permlane32_swap_b32 v232, v234
    v_mfma_f32_16x16x32_bf16 v[156:159], v[68:71], a[172:175], v[156:159]
    buffer_load_dwordx4 a[36:39], v1, s[32:35], s62 offen offset:1024 sc1
    v_permlane32_swap_b32 v233, v235
    v_mfma_f32_16x16x32_bf16 v[152:155], v[68:71], a[164:167], 0
    ds_read_b64_tr_b16 v[54:55], v17 offset:25600
    v_mfma_f32_16x16x32_bf16 v[152:155], v[64:67], a[160:163], v[152:155]
    s_waitcnt lgkmcnt(4)
    v_mfma_f32_16x16x32_bf16 v[96:99], v[40:43], a[192:195], v[96:99]
    ds_read_b64_tr_b16 v[56:57], v18 offset:16384
    v_mfma_f32_16x16x32_bf16 v[96:99], v[44:47], a[196:199], v[96:99]
    buffer_store_dwordx4 v[232:235], v14, s[32:35], s64 offen sc1
    v_mfma_f32_16x16x32_bf16 v[100:103], v[44:47], a[204:207], v[100:103]
    ds_read_b64_tr_b16 v[58:59], v18 offset:17408
    v_mfma_f32_16x16x32_bf16 v[100:103], v[40:43], a[200:203], v[100:103]
    v_mfma_f32_16x16x32_bf16 v[160:163], v[40:43], a[208:211], v[160:163]
    ds_read_b64_tr_b16 v[60:61], v18 offset:24576
    v_mfma_f32_16x16x32_bf16 v[160:163], v[44:47], a[212:215], v[160:163]
    buffer_load_dwordx4 a[40:43], v12, s[32:35], s62 offen offset:0 sc1
    v_mfma_f32_16x16x32_bf16 v[164:167], v[44:47], a[220:223], v[164:167]
    ds_read_b64_tr_b16 v[62:63], v18 offset:25600
    v_mfma_f32_16x16x32_bf16 v[164:167], v[40:43], a[216:219], v[164:167]
    s_waitcnt lgkmcnt(4)
    v_mfma_f32_16x16x32_bf16 v[172:175], v[48:51], a[216:219], v[172:175]
    ds_read_b64_tr_b16 v[64:65], v19 offset:16384
    v_xor_b32 v72, 0x10000, v16
    v_mfma_f32_16x16x32_bf16 v[172:175], v[52:55], a[220:223], v[172:175]
    buffer_load_dwordx4 a[44:47], v12, s[32:35], s62 offen offset:1024 sc1
    v_mfma_f32_16x16x32_bf16 v[168:171], v[52:55], a[212:215], v[168:171]
    ds_read_b64_tr_b16 v[66:67], v19 offset:17408
    v_xor_b32 v73, 0x10000, v17
    v_mfma_f32_16x16x32_bf16 v[168:171], v[48:51], a[208:211], v[168:171]
    s_add_u32 s62, s62, 2048
    v_mfma_f32_16x16x32_bf16 v[108:111], v[48:51], a[200:203], v[108:111]
    ds_read_b64_tr_b16 v[68:69], v19 offset:24576
    v_xor_b32 v74, 0x10000, v18
    v_mfma_f32_16x16x32_bf16 v[108:111], v[52:55], a[204:207], v[108:111]
    buffer_load_dwordx4 a[48:51], v1, s[32:35], s63 offen offset:0 sc1
    v_mfma_f32_16x16x32_bf16 v[104:107], v[52:55], a[196:199], v[104:107]
    ds_read_b64_tr_b16 v[70:71], v19 offset:25600
    v_xor_b32 v75, 0x10000, v19
    v_mfma_f32_16x16x32_bf16 v[104:107], v[48:51], a[192:195], v[104:107]
    s_waitcnt lgkmcnt(4)
    s_lshl_b32 s64, s55, 6
    v_mfma_f32_16x16x32_bf16 v[112:115], v[56:59], a[192:195], v[112:115]
    ds_read_b64_tr_b16 v[40:41], v16 offset:18432
    s_add_u32 s64, s64, 32768
    v_mfma_f32_16x16x32_bf16 v[112:115], v[60:63], a[196:199], v[112:115]
    buffer_load_dwordx4 a[52:55], v1, s[32:35], s63 offen offset:1024 sc1
    v_mfma_f32_16x16x32_bf16 v[116:119], v[60:63], a[204:207], v[116:119]
    ds_read_b64_tr_b16 v[42:43], v16 offset:19456
    s_lshl_b32 s56, s53, 4
    v_mfma_f32_16x16x32_bf16 v[116:119], v[56:59], a[200:203], v[116:119]
    s_add_u32 s56, s56, s54
    v_mfma_f32_16x16x32_bf16 v[176:179], v[56:59], a[208:211], v[176:179]
    ds_read_b64_tr_b16 v[44:45], v16 offset:26624
    s_lshl_b32 s72, s56, 2
    v_mfma_f32_16x16x32_bf16 v[176:179], v[60:63], a[212:215], v[176:179]
    buffer_load_dwordx4 a[56:59], v12, s[32:35], s63 offen offset:0 sc1
    v_mfma_f32_16x16x32_bf16 v[180:183], v[60:63], a[220:223], v[180:183]
    ds_read_b64_tr_b16 v[46:47], v16 offset:27648
    s_add_u32 s72, s72, s52
    v_mfma_f32_16x16x32_bf16 v[180:183], v[56:59], a[216:219], v[180:183]
    s_waitcnt lgkmcnt(4)
    s_lshl_b32 s67, s72, 7
    v_mfma_f32_16x16x32_bf16 v[188:191], v[64:67], a[216:219], v[188:191]
    ds_read_b64_tr_b16 v[48:49], v17 offset:18432
    v_and_b32 v6, 1, v0
    v_mfma_f32_16x16x32_bf16 v[188:191], v[68:71], a[220:223], v[188:191]
    buffer_load_dwordx4 a[60:63], v12, s[32:35], s63 offen offset:1024 sc1
    v_mfma_f32_16x16x32_bf16 v[184:187], v[68:71], a[212:215], v[184:187]
    ds_read_b64_tr_b16 v[50:51], v17 offset:19456
    v_lshlrev_b32 v6, 15, v6
    v_mfma_f32_16x16x32_bf16 v[184:187], v[64:67], a[208:211], v[184:187]
    s_add_u32 s63, s63, 2048
    v_mfma_f32_16x16x32_bf16 v[124:127], v[64:67], a[200:203], v[124:127]
    ds_read_b64_tr_b16 v[52:53], v17 offset:26624
    v_xor_b32 v6, 4096, v6
    v_mfma_f32_16x16x32_bf16 v[124:127], v[68:71], a[204:207], v[124:127]
    buffer_load_dwordx4 a[0:3], v1, s[32:35], s62 offen offset:0 sc1
    v_mfma_f32_16x16x32_bf16 v[120:123], v[68:71], a[196:199], v[120:123]
    ds_read_b64_tr_b16 v[54:55], v17 offset:27648
    v_xor_b32 v26, s67, v6
    v_mfma_f32_16x16x32_bf16 v[120:123], v[64:67], a[192:195], v[120:123]
    s_waitcnt lgkmcnt(4)
    s_add_u32 s70, s67, 1179648
    v_mfma_f32_16x16x32_bf16 v[128:131], v[40:43], a[192:195], v[128:131]
    ds_read_b64_tr_b16 v[56:57], v18 offset:18432
    s_add_u32 s67, s67, 917504
    v_mfma_f32_16x16x32_bf16 v[128:131], v[44:47], a[196:199], v[128:131]
    buffer_load_dwordx4 a[4:7], v1, s[32:35], s62 offen offset:1024 sc1
    v_mfma_f32_16x16x32_bf16 v[132:135], v[44:47], a[204:207], v[132:135]
    ds_read_b64_tr_b16 v[58:59], v18 offset:19456
    s_mov_b32 s71, 1179648
    v_mfma_f32_16x16x32_bf16 v[132:135], v[40:43], a[200:203], v[132:135]
    s_lshl_b32 s72, s72, 14
    v_mfma_f32_16x16x32_bf16 v[192:195], v[40:43], a[208:211], v[192:195]
    ds_read_b64_tr_b16 v[60:61], v18 offset:26624
    s_mul_i32 s56, s52, 4608
    v_mfma_f32_16x16x32_bf16 v[192:195], v[44:47], a[212:215], v[192:195]
    buffer_load_dwordx4 a[8:11], v12, s[32:35], s62 offen offset:0 sc1
    v_mfma_f32_16x16x32_bf16 v[196:199], v[44:47], a[220:223], v[196:199]
    ds_read_b64_tr_b16 v[62:63], v18 offset:27648
    s_add_u32 s56, s56, 131072
    v_mfma_f32_16x16x32_bf16 v[196:199], v[40:43], a[216:219], v[196:199]
    s_waitcnt lgkmcnt(4)
    v_and_b32 v6, 15, v0
    v_mfma_f32_16x16x32_bf16 v[204:207], v[48:51], a[216:219], v[204:207]
    ds_read_b64_tr_b16 v[64:65], v19 offset:18432
    v_mul_u32_u24 v6, 144, v6
    v_mfma_f32_16x16x32_bf16 v[204:207], v[52:55], a[220:223], v[204:207]
    buffer_load_dwordx4 a[12:15], v12, s[32:35], s62 offen offset:1024 sc1
    v_mfma_f32_16x16x32_bf16 v[200:203], v[52:55], a[212:215], v[200:203]
    ds_read_b64_tr_b16 v[66:67], v19 offset:19456
    v_lshrrev_b32 v7, 4, v0
    v_mfma_f32_16x16x32_bf16 v[200:203], v[48:51], a[208:211], v[200:203]
    s_add_u32 s62, s62, 2048
    v_mfma_f32_16x16x32_bf16 v[140:143], v[48:51], a[200:203], v[140:143]
    ds_read_b64_tr_b16 v[68:69], v19 offset:26624
    v_lshl_add_u32 v6, v7, 3, v6
    v_mfma_f32_16x16x32_bf16 v[140:143], v[52:55], a[204:207], v[140:143]
    buffer_load_dwordx4 a[16:19], v1, s[32:35], s63 offen offset:0 sc1
    v_mfma_f32_16x16x32_bf16 v[136:139], v[52:55], a[196:199], v[136:139]
    ds_read_b64_tr_b16 v[70:71], v19 offset:27648
    v_add_u32 v30, s56, v6
    v_mfma_f32_16x16x32_bf16 v[136:139], v[48:51], a[192:195], v[136:139]
    s_waitcnt lgkmcnt(4)
    v_lshrrev_b32 v6, 3, v0
    v_mfma_f32_16x16x32_bf16 v[144:147], v[56:59], a[192:195], v[144:147]
    ds_read_b64_tr_b16 v[40:41], v16 offset:32768
    v_and_b32 v7, 7, v0
    v_mfma_f32_16x16x32_bf16 v[144:147], v[60:63], a[196:199], v[144:147]
    buffer_load_dwordx4 a[20:23], v1, s[32:35], s63 offen offset:1024 sc1
    v_mfma_f32_16x16x32_bf16 v[148:151], v[60:63], a[204:207], v[148:151]
    ds_read_b64_tr_b16 v[42:43], v16 offset:33792
    v_lshlrev_b32 v7, 4, v7
    v_mfma_f32_16x16x32_bf16 v[148:151], v[56:59], a[200:203], v[148:151]
    v_lshl_add_u32 v15, v6, 11, v7
    v_mfma_f32_16x16x32_bf16 v[208:211], v[56:59], a[208:211], v[208:211]
    ds_read_b64_tr_b16 v[44:45], v16 offset:40960
    v_mul_u32_u24 v6, 144, v6
    v_mfma_f32_16x16x32_bf16 v[208:211], v[60:63], a[212:215], v[208:211]
    buffer_load_dwordx4 a[24:27], v12, s[32:35], s63 offen offset:0 sc1
    v_mfma_f32_16x16x32_bf16 v[212:215], v[60:63], a[220:223], v[212:215]
    ds_read_b64_tr_b16 v[46:47], v16 offset:41984
    v_add3_u32 v31, v6, v7, s56
    v_mfma_f32_16x16x32_bf16 v[212:215], v[56:59], a[216:219], v[212:215]
    s_waitcnt lgkmcnt(4)
    s_lshl_b32 s66, s55, 11
    v_mfma_f32_16x16x32_bf16 v[220:223], v[64:67], a[216:219], v[220:223]
    ds_read_b64_tr_b16 v[48:49], v17 offset:32768
    s_lshl_b32 s58, s54, 7
    v_mfma_f32_16x16x32_bf16 v[220:223], v[68:71], a[220:223], v[220:223]
    buffer_load_dwordx4 a[28:31], v12, s[32:35], s63 offen offset:1024 sc1
    v_mfma_f32_16x16x32_bf16 v[216:219], v[68:71], a[212:215], v[216:219]
    ds_read_b64_tr_b16 v[50:51], v17 offset:33792
    s_add_u32 s66, s66, s58
    v_mfma_f32_16x16x32_bf16 v[216:219], v[64:67], a[208:211], v[216:219]
    s_add_u32 s63, s63, 2048
    v_mfma_f32_16x16x32_bf16 v[156:159], v[64:67], a[200:203], v[156:159]
    ds_read_b64_tr_b16 v[52:53], v17 offset:40960
    s_add_u32 s0, s72, 4096
    v_mfma_f32_16x16x32_bf16 v[156:159], v[68:71], a[204:207], v[156:159]
    buffer_load_dwordx4 a[64:67], v1, s[32:35], s62 offen offset:0 sc1
    v_mfma_f32_16x16x32_bf16 v[152:155], v[68:71], a[196:199], v[152:155]
    ds_read_b64_tr_b16 v[54:55], v17 offset:41984
    s_add_u32 s1, s72, 8192
    v_mfma_f32_16x16x32_bf16 v[152:155], v[64:67], a[192:195], v[152:155]
    s_waitcnt vmcnt(9) lgkmcnt(4)
    s_add_u32 s14, s72, 12288
    v_mfma_f32_16x16x32_bf16 v[96:99], v[40:43], a[32:35], v[96:99]
    ds_read_b64_tr_b16 v[56:57], v18 offset:32768
    s_xor_b32 s15, s0, 524288
    v_mfma_f32_16x16x32_bf16 v[96:99], v[44:47], a[36:39], v[96:99]
    buffer_load_dwordx4 a[68:71], v1, s[32:35], s62 offen offset:1024 sc1
    v_mfma_f32_16x16x32_bf16 v[100:103], v[44:47], a[44:47], v[100:103]
    ds_read_b64_tr_b16 v[58:59], v18 offset:33792
    s_xor_b32 s74, s1, 4194304
    v_mfma_f32_16x16x32_bf16 v[100:103], v[40:43], a[40:43], v[100:103]
    s_xor_b32 s75, s14, 4718592
    v_mfma_f32_16x16x32_bf16 v[160:163], v[40:43], a[48:51], v[160:163]
    ds_read_b64_tr_b16 v[60:61], v18 offset:40960
    s_mov_b32 s57, 0x3a800000
    v_mfma_f32_16x16x32_bf16 v[160:163], v[44:47], a[52:55], v[160:163]
    buffer_load_dwordx4 a[72:75], v12, s[32:35], s62 offen offset:0 sc1
    v_mfma_f32_16x16x32_bf16 v[164:167], v[44:47], a[60:63], v[164:167]
    ds_read_b64_tr_b16 v[62:63], v18 offset:41984
    v_mov_b32 v8, 0x3727c5ac
    v_mfma_f32_16x16x32_bf16 v[164:167], v[40:43], a[56:59], v[164:167]
    s_waitcnt lgkmcnt(4)
    s_mov_b64 s[28:29], s[22:23]
    v_mfma_f32_16x16x32_bf16 v[172:175], v[48:51], a[56:59], v[172:175]
    ds_read_b64_tr_b16 v[64:65], v19 offset:32768
    s_mov_b32 s30, 0x400000
    v_mfma_f32_16x16x32_bf16 v[172:175], v[52:55], a[60:63], v[172:175]
    buffer_load_dwordx4 a[76:79], v12, s[32:35], s62 offen offset:1024 sc1
    v_mfma_f32_16x16x32_bf16 v[168:171], v[52:55], a[52:55], v[168:171]
    ds_read_b64_tr_b16 v[66:67], v19 offset:33792
    s_mov_b32 s31, 0x20000
    v_mfma_f32_16x16x32_bf16 v[168:171], v[48:51], a[48:51], v[168:171]
    s_add_u32 s62, s62, 2048
    v_mfma_f32_16x16x32_bf16 v[108:111], v[48:51], a[40:43], v[108:111]
    ds_read_b64_tr_b16 v[68:69], v19 offset:40960
    v_accvgpr_read_b32 v225, a240
    v_mfma_f32_16x16x32_bf16 v[108:111], v[52:55], a[44:47], v[108:111]
    buffer_store_dword v3, v2, s[48:51], s73 offen sc1
    v_mfma_f32_16x16x32_bf16 v[104:107], v[52:55], a[36:39], v[104:107]
    ds_read_b64_tr_b16 v[70:71], v19 offset:41984
    v_accvgpr_read_b32 v227, a241
    v_mfma_f32_16x16x32_bf16 v[104:107], v[48:51], a[32:35], v[104:107]
    s_waitcnt lgkmcnt(4)
    s_add_u32 s73, s73, 0x40000
    v_mfma_f32_16x16x32_bf16 v[112:115], v[56:59], a[32:35], v[112:115]
    ds_read_b64_tr_b16 v[40:41], v16 offset:34816
    v_lshlrev_b32 v224, 16, v225
    v_mfma_f32_16x16x32_bf16 v[112:115], v[60:63], a[36:39], v[112:115]
    buffer_load_dwordx4 a[80:83], v1, s[32:35], s63 offen offset:0 sc1
    v_mfma_f32_16x16x32_bf16 v[116:119], v[60:63], a[44:47], v[116:119]
    ds_read_b64_tr_b16 v[42:43], v16 offset:35840
    v_lshlrev_b32 v226, 16, v227
    v_mfma_f32_16x16x32_bf16 v[116:119], v[56:59], a[40:43], v[116:119]
    v_and_b32 v225, 0xffff0000, v225
    v_mfma_f32_16x16x32_bf16 v[176:179], v[56:59], a[48:51], v[176:179]
    ds_read_b64_tr_b16 v[44:45], v16 offset:43008
    v_and_b32 v227, 0xffff0000, v227
    v_mfma_f32_16x16x32_bf16 v[176:179], v[60:63], a[52:55], v[176:179]
    buffer_load_dwordx4 a[84:87], v1, s[32:35], s63 offen offset:1024 sc1
    v_mfma_f32_16x16x32_bf16 v[180:183], v[60:63], a[60:63], v[180:183]
    ds_read_b64_tr_b16 v[46:47], v16 offset:44032
    v_accvgpr_read_b32 v233, a242
    v_mfma_f32_16x16x32_bf16 v[180:183], v[56:59], a[56:59], v[180:183]
    s_waitcnt lgkmcnt(4)
    v_accvgpr_read_b32 v235, a243
    v_mfma_f32_16x16x32_bf16 v[188:191], v[64:67], a[56:59], v[188:191]
    ds_read_b64_tr_b16 v[48:49], v17 offset:34816
    v_lshlrev_b32 v232, 16, v233
    v_mfma_f32_16x16x32_bf16 v[188:191], v[68:71], a[60:63], v[188:191]
    buffer_load_dwordx4 a[88:91], v12, s[32:35], s63 offen offset:0 sc1
    v_mfma_f32_16x16x32_bf16 v[184:187], v[68:71], a[52:55], v[184:187]
    ds_read_b64_tr_b16 v[50:51], v17 offset:35840
    v_lshlrev_b32 v234, 16, v235
    v_mfma_f32_16x16x32_bf16 v[184:187], v[64:67], a[48:51], v[184:187]
    v_and_b32 v233, 0xffff0000, v233
    v_mfma_f32_16x16x32_bf16 v[124:127], v[64:67], a[40:43], v[124:127]
    ds_read_b64_tr_b16 v[52:53], v17 offset:43008
    v_and_b32 v235, 0xffff0000, v235
    v_mfma_f32_16x16x32_bf16 v[124:127], v[68:71], a[44:47], v[124:127]
    buffer_load_dwordx4 a[92:95], v12, s[32:35], s63 offen offset:1024 sc1
    v_mfma_f32_16x16x32_bf16 v[120:123], v[68:71], a[36:39], v[120:123]
    ds_read_b64_tr_b16 v[54:55], v17 offset:44032
    v_accvgpr_read_b32 v241, a244
    v_mfma_f32_16x16x32_bf16 v[120:123], v[64:67], a[32:35], v[120:123]
    s_waitcnt lgkmcnt(4)
    s_add_u32 s63, s63, 2048
    v_mfma_f32_16x16x32_bf16 v[128:131], v[40:43], a[32:35], v[128:131]
    ds_read_b64_tr_b16 v[56:57], v18 offset:34816
    v_accvgpr_read_b32 v243, a245
    v_mfma_f32_16x16x32_bf16 v[128:131], v[44:47], a[36:39], v[128:131]
    buffer_load_dwordx4 a[96:99], v1, s[32:35], s62 offen offset:0 sc1
    v_mfma_f32_16x16x32_bf16 v[132:135], v[44:47], a[44:47], v[132:135]
    ds_read_b64_tr_b16 v[58:59], v18 offset:35840
    v_lshlrev_b32 v240, 16, v241
    v_mfma_f32_16x16x32_bf16 v[132:135], v[40:43], a[40:43], v[132:135]
    v_lshlrev_b32 v242, 16, v243
    v_mfma_f32_16x16x32_bf16 v[192:195], v[40:43], a[48:51], v[192:195]
    ds_read_b64_tr_b16 v[60:61], v18 offset:43008
    v_and_b32 v241, 0xffff0000, v241
    v_mfma_f32_16x16x32_bf16 v[192:195], v[44:47], a[52:55], v[192:195]
    buffer_load_dwordx4 a[100:103], v1, s[32:35], s62 offen offset:1024 sc1
    v_mfma_f32_16x16x32_bf16 v[196:199], v[44:47], a[60:63], v[196:199]
    ds_read_b64_tr_b16 v[62:63], v18 offset:44032
    v_and_b32 v243, 0xffff0000, v243
    v_mfma_f32_16x16x32_bf16 v[196:199], v[40:43], a[56:59], v[196:199]
    s_waitcnt lgkmcnt(4)
    v_accvgpr_read_b32 v249, a246
    v_mfma_f32_16x16x32_bf16 v[204:207], v[48:51], a[56:59], v[204:207]
    ds_read_b64_tr_b16 v[64:65], v19 offset:34816
    v_accvgpr_read_b32 v251, a247
    v_mfma_f32_16x16x32_bf16 v[204:207], v[52:55], a[60:63], v[204:207]
    buffer_load_dwordx4 a[104:107], v12, s[32:35], s62 offen offset:0 sc1
    v_mfma_f32_16x16x32_bf16 v[200:203], v[52:55], a[52:55], v[200:203]
    ds_read_b64_tr_b16 v[66:67], v19 offset:35840
    v_lshlrev_b32 v248, 16, v249
    v_mfma_f32_16x16x32_bf16 v[200:203], v[48:51], a[48:51], v[200:203]
    v_lshlrev_b32 v250, 16, v251
    v_mfma_f32_16x16x32_bf16 v[140:143], v[48:51], a[40:43], v[140:143]
    ds_read_b64_tr_b16 v[68:69], v19 offset:43008
    v_and_b32 v249, 0xffff0000, v249
    v_mfma_f32_16x16x32_bf16 v[140:143], v[52:55], a[44:47], v[140:143]
    buffer_load_dwordx4 a[108:111], v12, s[32:35], s62 offen offset:1024 sc1
    v_mfma_f32_16x16x32_bf16 v[136:139], v[52:55], a[36:39], v[136:139]
    ds_read_b64_tr_b16 v[70:71], v19 offset:44032
    v_and_b32 v251, 0xffff0000, v251
    v_mfma_f32_16x16x32_bf16 v[136:139], v[48:51], a[32:35], v[136:139]
    s_waitcnt lgkmcnt(4)
    s_add_u32 s62, s62, 2048
    v_mfma_f32_16x16x32_bf16 v[144:147], v[56:59], a[32:35], v[144:147]
    s_barrier
    ds_read_b64_tr_b16 v[40:41], v16 offset:49152
    v_accvgpr_read_b32 v229, a248
    v_mfma_f32_16x16x32_bf16 v[144:147], v[60:63], a[36:39], v[144:147]
    buffer_load_dwordx4 a[112:115], v1, s[32:35], s63 offen offset:0 sc1
    v_mfma_f32_16x16x32_bf16 v[148:151], v[60:63], a[44:47], v[148:151]
    ds_read_b64_tr_b16 v[42:43], v16 offset:50176
    v_accvgpr_read_b32 v231, a249
    v_mfma_f32_16x16x32_bf16 v[148:151], v[56:59], a[40:43], v[148:151]
    v_lshlrev_b32 v228, 16, v229
    v_mfma_f32_16x16x32_bf16 v[208:211], v[56:59], a[48:51], v[208:211]
    ds_read_b64_tr_b16 v[44:45], v16 offset:57344
    v_lshlrev_b32 v230, 16, v231
    v_mfma_f32_16x16x32_bf16 v[208:211], v[60:63], a[52:55], v[208:211]
    buffer_load_dwordx4 a[116:119], v1, s[32:35], s63 offen offset:1024 sc1
    v_mfma_f32_16x16x32_bf16 v[212:215], v[60:63], a[60:63], v[212:215]
    ds_read_b64_tr_b16 v[46:47], v16 offset:58368
    v_and_b32 v229, 0xffff0000, v229
    v_mfma_f32_16x16x32_bf16 v[212:215], v[56:59], a[56:59], v[212:215]
    s_waitcnt lgkmcnt(4)
    v_and_b32 v231, 0xffff0000, v231
    v_mfma_f32_16x16x32_bf16 v[220:223], v[64:67], a[56:59], v[220:223]
    ds_read_b64_tr_b16 v[48:49], v17 offset:49152
    v_accvgpr_read_b32 v237, a250
    v_mfma_f32_16x16x32_bf16 v[220:223], v[68:71], a[60:63], v[220:223]
    buffer_load_dwordx4 a[120:123], v12, s[32:35], s63 offen offset:0 sc1
    v_mfma_f32_16x16x32_bf16 v[216:219], v[68:71], a[52:55], v[216:219]
    ds_read_b64_tr_b16 v[50:51], v17 offset:50176
    v_accvgpr_read_b32 v239, a251
    v_mfma_f32_16x16x32_bf16 v[216:219], v[64:67], a[48:51], v[216:219]
    v_lshlrev_b32 v236, 16, v237
    v_mfma_f32_16x16x32_bf16 v[156:159], v[64:67], a[40:43], v[156:159]
    ds_read_b64_tr_b16 v[52:53], v17 offset:57344
    v_lshlrev_b32 v238, 16, v239
    v_mfma_f32_16x16x32_bf16 v[156:159], v[68:71], a[44:47], v[156:159]
    buffer_load_dwordx4 a[124:127], v12, s[32:35], s63 offen offset:1024 sc1
    v_mfma_f32_16x16x32_bf16 v[152:155], v[68:71], a[36:39], v[152:155]
    ds_read_b64_tr_b16 v[54:55], v17 offset:58368
    v_and_b32 v237, 0xffff0000, v237
    v_mfma_f32_16x16x32_bf16 v[152:155], v[64:67], a[32:35], v[152:155]
    s_waitcnt vmcnt(17) lgkmcnt(4)
    s_add_u32 s63, s63, 2048
    v_mfma_f32_16x16x32_bf16 v[96:99], v[40:43], a[0:3], v[96:99]
    ds_read_b64_tr_b16 v[56:57], v18 offset:49152
    v_and_b32 v239, 0xffff0000, v239
    v_mfma_f32_16x16x32_bf16 v[96:99], v[44:47], a[4:7], v[96:99]
    v_accvgpr_read_b32 v245, a252
    v_mfma_f32_16x16x32_bf16 v[100:103], v[44:47], a[12:15], v[100:103]
    ds_read_b64_tr_b16 v[58:59], v18 offset:50176
    v_accvgpr_read_b32 v247, a253
    v_mfma_f32_16x16x32_bf16 v[100:103], v[40:43], a[8:11], v[100:103]
    s_add_u32 m0, s69, 0
    v_mfma_f32_16x16x32_bf16 v[160:163], v[40:43], a[16:19], v[160:163]
    ds_read_b64_tr_b16 v[60:61], v18 offset:57344
    v_lshlrev_b32 v244, 16, v245
    v_mfma_f32_16x16x32_bf16 v[160:163], v[44:47], a[20:23], v[160:163]
    buffer_load_dwordx4 v21, s[40:43], s68 offen offset:0 lds
    v_mfma_f32_16x16x32_bf16 v[164:167], v[44:47], a[28:31], v[164:167]
    ds_read_b64_tr_b16 v[62:63], v18 offset:58368
    v_lshlrev_b32 v246, 16, v247
    v_mfma_f32_16x16x32_bf16 v[164:167], v[40:43], a[24:27], v[164:167]
    s_waitcnt lgkmcnt(4)
    v_and_b32 v245, 0xffff0000, v245
    v_mfma_f32_16x16x32_bf16 v[172:175], v[48:51], a[24:27], v[172:175]
    ds_read_b64_tr_b16 v[64:65], v19 offset:49152
    v_and_b32 v247, 0xffff0000, v247
    v_mfma_f32_16x16x32_bf16 v[172:175], v[52:55], a[28:31], v[172:175]
    buffer_load_dwordx4 v22, s[40:43], s68 offen offset:1024 lds
    v_mfma_f32_16x16x32_bf16 v[168:171], v[52:55], a[20:23], v[168:171]
    ds_read_b64_tr_b16 v[66:67], v19 offset:50176
    v_accvgpr_read_b32 v253, a254
    v_mfma_f32_16x16x32_bf16 v[168:171], v[48:51], a[16:19], v[168:171]
    v_accvgpr_read_b32 v255, a255
    v_mfma_f32_16x16x32_bf16 v[108:111], v[48:51], a[8:11], v[108:111]
    ds_read_b64_tr_b16 v[68:69], v19 offset:57344
    v_lshlrev_b32 v252, 16, v253
    v_mfma_f32_16x16x32_bf16 v[108:111], v[52:55], a[12:15], v[108:111]
    buffer_load_dwordx4 v23, s[40:43], s68 offen offset:2048 lds
    v_mfma_f32_16x16x32_bf16 v[104:107], v[52:55], a[4:7], v[104:107]
    ds_read_b64_tr_b16 v[70:71], v19 offset:58368
    v_lshlrev_b32 v254, 16, v255
    v_mfma_f32_16x16x32_bf16 v[104:107], v[48:51], a[0:3], v[104:107]
    s_waitcnt lgkmcnt(4)
    v_and_b32 v253, 0xffff0000, v253
    v_mfma_f32_16x16x32_bf16 v[112:115], v[56:59], a[0:3], v[112:115]
    ds_read_b64_tr_b16 v[40:41], v16 offset:51200
    v_and_b32 v255, 0xffff0000, v255
    v_mfma_f32_16x16x32_bf16 v[112:115], v[60:63], a[4:7], v[112:115]
    buffer_load_dwordx4 v24, s[40:43], s68 offen offset:3072 lds
    v_mfma_f32_16x16x32_bf16 v[116:119], v[60:63], a[12:15], v[116:119]
    ds_read_b64_tr_b16 v[42:43], v16 offset:52224
    v_mfma_f32_16x16x32_bf16 v[116:119], v[56:59], a[8:11], v[116:119]
    s_add_u32 s68, s68, 917504
    s_add_u32 m0, s69, 16384
    v_mfma_f32_16x16x32_bf16 v[176:179], v[56:59], a[16:19], v[176:179]
    ds_read_b64_tr_b16 v[44:45], v16 offset:59392
    v_mfma_f32_16x16x32_bf16 v[176:179], v[60:63], a[20:23], v[176:179]
    buffer_load_dwordx4 v21, s[40:43], s68 offen offset:0 lds
    v_mfma_f32_16x16x32_bf16 v[180:183], v[60:63], a[28:31], v[180:183]
    ds_read_b64_tr_b16 v[46:47], v16 offset:60416
    v_mfma_f32_16x16x32_bf16 v[180:183], v[56:59], a[24:27], v[180:183]
    s_waitcnt lgkmcnt(4)
    v_mfma_f32_16x16x32_bf16 v[188:191], v[64:67], a[24:27], v[188:191]
    ds_read_b64_tr_b16 v[48:49], v17 offset:51200
    v_mfma_f32_16x16x32_bf16 v[188:191], v[68:71], a[28:31], v[188:191]
    buffer_load_dwordx4 v22, s[40:43], s68 offen offset:1024 lds
    v_mfma_f32_16x16x32_bf16 v[184:187], v[68:71], a[20:23], v[184:187]
    ds_read_b64_tr_b16 v[50:51], v17 offset:52224
    v_mfma_f32_16x16x32_bf16 v[184:187], v[64:67], a[16:19], v[184:187]
    v_mfma_f32_16x16x32_bf16 v[124:127], v[64:67], a[8:11], v[124:127]
    ds_read_b64_tr_b16 v[52:53], v17 offset:59392
    v_mfma_f32_16x16x32_bf16 v[124:127], v[68:71], a[12:15], v[124:127]
    buffer_load_dwordx4 v23, s[40:43], s68 offen offset:2048 lds
    v_mfma_f32_16x16x32_bf16 v[120:123], v[68:71], a[4:7], v[120:123]
    ds_read_b64_tr_b16 v[54:55], v17 offset:60416
    v_mfma_f32_16x16x32_bf16 v[120:123], v[64:67], a[0:3], v[120:123]
    s_waitcnt lgkmcnt(4)
    v_mfma_f32_16x16x32_bf16 v[128:131], v[40:43], a[0:3], v[128:131]
    ds_read_b64_tr_b16 v[56:57], v18 offset:51200
    v_mfma_f32_16x16x32_bf16 v[128:131], v[44:47], a[4:7], v[128:131]
    buffer_load_dwordx4 v24, s[40:43], s68 offen offset:3072 lds
    v_mfma_f32_16x16x32_bf16 v[132:135], v[44:47], a[12:15], v[132:135]
    ds_read_b64_tr_b16 v[58:59], v18 offset:52224
    v_mfma_f32_16x16x32_bf16 v[132:135], v[40:43], a[8:11], v[132:135]
    s_sub_u32 s68, s68, 884736
    v_mfma_f32_16x16x32_bf16 v[192:195], v[40:43], a[16:19], v[192:195]
    ds_read_b64_tr_b16 v[60:61], v18 offset:59392
    v_mfma_f32_16x16x32_bf16 v[192:195], v[44:47], a[20:23], v[192:195]
    buffer_load_dwordx4 a[128:131], v1, s[32:35], s62 offen offset:0 sc1
    v_mfma_f32_16x16x32_bf16 v[196:199], v[44:47], a[28:31], v[196:199]
    ds_read_b64_tr_b16 v[62:63], v18 offset:60416
    v_mfma_f32_16x16x32_bf16 v[196:199], v[40:43], a[24:27], v[196:199]
    s_waitcnt lgkmcnt(4)
    v_mfma_f32_16x16x32_bf16 v[204:207], v[48:51], a[24:27], v[204:207]
    ds_read_b64_tr_b16 v[64:65], v19 offset:51200
    v_mfma_f32_16x16x32_bf16 v[204:207], v[52:55], a[28:31], v[204:207]
    buffer_load_dwordx4 a[132:135], v1, s[32:35], s62 offen offset:1024 sc1
    v_mfma_f32_16x16x32_bf16 v[200:203], v[52:55], a[20:23], v[200:203]
    ds_read_b64_tr_b16 v[66:67], v19 offset:52224
    v_mfma_f32_16x16x32_bf16 v[200:203], v[48:51], a[16:19], v[200:203]
    v_mfma_f32_16x16x32_bf16 v[140:143], v[48:51], a[8:11], v[140:143]
    ds_read_b64_tr_b16 v[68:69], v19 offset:59392
    v_mfma_f32_16x16x32_bf16 v[140:143], v[52:55], a[12:15], v[140:143]
    buffer_load_dwordx4 a[136:139], v12, s[32:35], s62 offen offset:0 sc1
    v_mfma_f32_16x16x32_bf16 v[136:139], v[52:55], a[4:7], v[136:139]
    ds_read_b64_tr_b16 v[70:71], v19 offset:60416
    v_mfma_f32_16x16x32_bf16 v[136:139], v[48:51], a[0:3], v[136:139]
    s_waitcnt lgkmcnt(4)
    v_mfma_f32_16x16x32_bf16 v[144:147], v[56:59], a[0:3], v[144:147]
    ds_read_b64_tr_b16 v[40:41], v72 offset:0
    v_mfma_f32_16x16x32_bf16 v[144:147], v[60:63], a[4:7], v[144:147]
    buffer_load_dwordx4 a[140:143], v12, s[32:35], s62 offen offset:1024 sc1
    v_mfma_f32_16x16x32_bf16 v[148:151], v[60:63], a[12:15], v[148:151]
    ds_read_b64_tr_b16 v[42:43], v72 offset:1024
    v_mfma_f32_16x16x32_bf16 v[148:151], v[56:59], a[8:11], v[148:151]
    s_add_u32 s62, s62, 2048
    v_mfma_f32_16x16x32_bf16 v[208:211], v[56:59], a[16:19], v[208:211]
    ds_read_b64_tr_b16 v[44:45], v72 offset:8192
    v_mfma_f32_16x16x32_bf16 v[208:211], v[60:63], a[20:23], v[208:211]
    buffer_load_dwordx4 a[144:147], v1, s[32:35], s63 offen offset:0 sc1
    v_mfma_f32_16x16x32_bf16 v[212:215], v[60:63], a[28:31], v[212:215]
    ds_read_b64_tr_b16 v[46:47], v72 offset:9216
    v_mfma_f32_16x16x32_bf16 v[212:215], v[56:59], a[24:27], v[212:215]
    s_waitcnt lgkmcnt(4)
    v_mfma_f32_16x16x32_bf16 v[220:223], v[64:67], a[24:27], v[220:223]
    ds_read_b64_tr_b16 v[48:49], v73 offset:0
    v_mfma_f32_16x16x32_bf16 v[220:223], v[68:71], a[28:31], v[220:223]
    buffer_load_dwordx4 a[148:151], v1, s[32:35], s63 offen offset:1024 sc1
    v_mfma_f32_16x16x32_bf16 v[216:219], v[68:71], a[20:23], v[216:219]
    ds_read_b64_tr_b16 v[50:51], v73 offset:1024
    v_mfma_f32_16x16x32_bf16 v[216:219], v[64:67], a[16:19], v[216:219]
    v_mfma_f32_16x16x32_bf16 v[156:159], v[64:67], a[8:11], v[156:159]
    ds_read_b64_tr_b16 v[52:53], v73 offset:8192
    v_mfma_f32_16x16x32_bf16 v[156:159], v[68:71], a[12:15], v[156:159]
    buffer_load_dwordx4 a[152:155], v12, s[32:35], s63 offen offset:0 sc1
    v_mfma_f32_16x16x32_bf16 v[152:155], v[68:71], a[4:7], v[152:155]
    ds_read_b64_tr_b16 v[54:55], v73 offset:9216
    v_mfma_f32_16x16x32_bf16 v[152:155], v[64:67], a[0:3], v[152:155]
    s_waitcnt vmcnt(23) lgkmcnt(4)
    v_mfma_f32_16x16x32_bf16 v[96:99], v[40:43], a[64:67], v[96:99]
    ds_read_b64_tr_b16 v[56:57], v74 offset:0
    v_mfma_f32_16x16x32_bf16 v[96:99], v[44:47], a[68:71], v[96:99]
    buffer_load_dwordx4 a[156:159], v12, s[32:35], s63 offen offset:1024 sc1
    v_mfma_f32_16x16x32_bf16 v[100:103], v[44:47], a[76:79], v[100:103]
    ds_read_b64_tr_b16 v[58:59], v74 offset:1024
    v_mfma_f32_16x16x32_bf16 v[100:103], v[40:43], a[72:75], v[100:103]
    s_add_u32 s63, s63, 2048
    v_mfma_f32_16x16x32_bf16 v[160:163], v[40:43], a[80:83], v[160:163]
    ds_read_b64_tr_b16 v[60:61], v74 offset:8192
    v_mfma_f32_16x16x32_bf16 v[160:163], v[44:47], a[84:87], v[160:163]
    buffer_load_dword v25, v9, s[48:51], s61 offen sc1
    v_mfma_f32_16x16x32_bf16 v[164:167], v[44:47], a[92:95], v[164:167]
    ds_read_b64_tr_b16 v[62:63], v74 offset:9216
    v_mfma_f32_16x16x32_bf16 v[164:167], v[40:43], a[88:91], v[164:167]
    s_waitcnt lgkmcnt(4)
    v_mfma_f32_16x16x32_bf16 v[172:175], v[48:51], a[88:91], v[172:175]
    ds_read_b64_tr_b16 v[64:65], v75 offset:0
    v_mfma_f32_16x16x32_bf16 v[172:175], v[52:55], a[92:95], v[172:175]
    buffer_load_dwordx4 a[160:163], v1, s[32:35], s62 offen offset:0 sc1
    v_mfma_f32_16x16x32_bf16 v[168:171], v[52:55], a[84:87], v[168:171]
    ds_read_b64_tr_b16 v[66:67], v75 offset:1024
    v_mfma_f32_16x16x32_bf16 v[168:171], v[48:51], a[80:83], v[168:171]
    v_mfma_f32_16x16x32_bf16 v[108:111], v[48:51], a[72:75], v[108:111]
    ds_read_b64_tr_b16 v[68:69], v75 offset:8192
    v_mfma_f32_16x16x32_bf16 v[108:111], v[52:55], a[76:79], v[108:111]
    buffer_load_dwordx4 a[164:167], v1, s[32:35], s62 offen offset:1024 sc1
    v_mfma_f32_16x16x32_bf16 v[104:107], v[52:55], a[68:71], v[104:107]
    ds_read_b64_tr_b16 v[70:71], v75 offset:9216
    v_mfma_f32_16x16x32_bf16 v[104:107], v[48:51], a[64:67], v[104:107]
    s_waitcnt lgkmcnt(4)
    v_mfma_f32_16x16x32_bf16 v[112:115], v[56:59], a[64:67], v[112:115]
    ds_read_b64_tr_b16 v[40:41], v72 offset:2048
    v_mfma_f32_16x16x32_bf16 v[112:115], v[60:63], a[68:71], v[112:115]
    buffer_load_dwordx4 a[168:171], v12, s[32:35], s62 offen offset:0 sc1
    v_mfma_f32_16x16x32_bf16 v[116:119], v[60:63], a[76:79], v[116:119]
    ds_read_b64_tr_b16 v[42:43], v72 offset:3072
    v_mfma_f32_16x16x32_bf16 v[116:119], v[56:59], a[72:75], v[116:119]
    v_mfma_f32_16x16x32_bf16 v[176:179], v[56:59], a[80:83], v[176:179]
    ds_read_b64_tr_b16 v[44:45], v72 offset:10240
    v_mfma_f32_16x16x32_bf16 v[176:179], v[60:63], a[84:87], v[176:179]
    buffer_load_dwordx4 a[172:175], v12, s[32:35], s62 offen offset:1024 sc1
    v_mfma_f32_16x16x32_bf16 v[180:183], v[60:63], a[92:95], v[180:183]
    ds_read_b64_tr_b16 v[46:47], v72 offset:11264
    v_mfma_f32_16x16x32_bf16 v[180:183], v[56:59], a[88:91], v[180:183]
    s_waitcnt lgkmcnt(4)
    s_add_u32 s62, s62, 2048
    v_mfma_f32_16x16x32_bf16 v[188:191], v[64:67], a[88:91], v[188:191]
    ds_read_b64_tr_b16 v[48:49], v73 offset:2048
    v_mfma_f32_16x16x32_bf16 v[188:191], v[68:71], a[92:95], v[188:191]
    buffer_load_dwordx4 a[176:179], v1, s[32:35], s63 offen offset:0 sc1
    v_mfma_f32_16x16x32_bf16 v[184:187], v[68:71], a[84:87], v[184:187]
    ds_read_b64_tr_b16 v[50:51], v73 offset:3072
    v_mfma_f32_16x16x32_bf16 v[184:187], v[64:67], a[80:83], v[184:187]
    v_mfma_f32_16x16x32_bf16 v[124:127], v[64:67], a[72:75], v[124:127]
    ds_read_b64_tr_b16 v[52:53], v73 offset:10240
    v_mfma_f32_16x16x32_bf16 v[124:127], v[68:71], a[76:79], v[124:127]
    buffer_load_dwordx4 a[180:183], v1, s[32:35], s63 offen offset:1024 sc1
    v_mfma_f32_16x16x32_bf16 v[120:123], v[68:71], a[68:71], v[120:123]
    ds_read_b64_tr_b16 v[54:55], v73 offset:11264
    v_mfma_f32_16x16x32_bf16 v[120:123], v[64:67], a[64:67], v[120:123]
    s_waitcnt lgkmcnt(4)
    v_mfma_f32_16x16x32_bf16 v[128:131], v[40:43], a[64:67], v[128:131]
    ds_read_b64_tr_b16 v[56:57], v74 offset:2048
    v_mfma_f32_16x16x32_bf16 v[128:131], v[44:47], a[68:71], v[128:131]
    buffer_load_dwordx4 a[184:187], v12, s[32:35], s63 offen offset:0 sc1
    v_mfma_f32_16x16x32_bf16 v[132:135], v[44:47], a[76:79], v[132:135]
    ds_read_b64_tr_b16 v[58:59], v74 offset:3072
    v_mfma_f32_16x16x32_bf16 v[132:135], v[40:43], a[72:75], v[132:135]
    v_mfma_f32_16x16x32_bf16 v[192:195], v[40:43], a[80:83], v[192:195]
    ds_read_b64_tr_b16 v[60:61], v74 offset:10240
    v_mfma_f32_16x16x32_bf16 v[192:195], v[44:47], a[84:87], v[192:195]
    buffer_load_dwordx4 a[188:191], v12, s[32:35], s63 offen offset:1024 sc1
    v_mfma_f32_16x16x32_bf16 v[196:199], v[44:47], a[92:95], v[196:199]
    ds_read_b64_tr_b16 v[62:63], v74 offset:11264
    v_mfma_f32_16x16x32_bf16 v[196:199], v[40:43], a[88:91], v[196:199]
    s_waitcnt lgkmcnt(4)
    s_add_u32 s63, s63, 2048
    v_mfma_f32_16x16x32_bf16 v[204:207], v[48:51], a[88:91], v[204:207]
    ds_read_b64_tr_b16 v[64:65], v75 offset:2048
    v_mfma_f32_16x16x32_bf16 v[204:207], v[52:55], a[92:95], v[204:207]
    v_mfma_f32_16x16x32_bf16 v[200:203], v[52:55], a[84:87], v[200:203]
    ds_read_b64_tr_b16 v[66:67], v75 offset:3072
    v_mfma_f32_16x16x32_bf16 v[200:203], v[48:51], a[80:83], v[200:203]
    s_waitcnt vmcnt(8)
    v_cmp_gt_u32 vcc, 1, v25
    s_nop 0
    s_cbranch_vccnz F_fpoll2
F_fpoll2_done:
    s_add_u32 s61, s61, 0x40000
    v_mfma_f32_16x16x32_bf16 v[140:143], v[48:51], a[72:75], v[140:143]
    ds_read_b64_tr_b16 v[68:69], v75 offset:10240
    v_mfma_f32_16x16x32_bf16 v[140:143], v[52:55], a[76:79], v[140:143]
    buffer_load_dwordx4 a[192:195], v1, s[32:35], s62 offen offset:0 sc1
    v_mfma_f32_16x16x32_bf16 v[136:139], v[52:55], a[68:71], v[136:139]
    ds_read_b64_tr_b16 v[70:71], v75 offset:11264
    v_mfma_f32_16x16x32_bf16 v[136:139], v[48:51], a[64:67], v[136:139]
    s_waitcnt lgkmcnt(4)
    v_mfma_f32_16x16x32_bf16 v[144:147], v[56:59], a[64:67], v[144:147]
    s_barrier
    ds_read_b64_tr_b16 v[40:41], v72 offset:16384
    v_mfma_f32_16x16x32_bf16 v[144:147], v[60:63], a[68:71], v[144:147]
    buffer_load_dwordx4 a[196:199], v1, s[32:35], s62 offen offset:1024 sc1
    v_mfma_f32_16x16x32_bf16 v[148:151], v[60:63], a[76:79], v[148:151]
    ds_read_b64_tr_b16 v[42:43], v72 offset:17408
    v_mfma_f32_16x16x32_bf16 v[148:151], v[56:59], a[72:75], v[148:151]
    v_mfma_f32_16x16x32_bf16 v[208:211], v[56:59], a[80:83], v[208:211]
    ds_read_b64_tr_b16 v[44:45], v72 offset:24576
    v_mfma_f32_16x16x32_bf16 v[208:211], v[60:63], a[84:87], v[208:211]
    buffer_load_dwordx4 a[200:203], v12, s[32:35], s62 offen offset:0 sc1
    v_mfma_f32_16x16x32_bf16 v[212:215], v[60:63], a[92:95], v[212:215]
    ds_read_b64_tr_b16 v[46:47], v72 offset:25600
    v_mfma_f32_16x16x32_bf16 v[212:215], v[56:59], a[88:91], v[212:215]
    s_waitcnt lgkmcnt(4)
    v_mfma_f32_16x16x32_bf16 v[220:223], v[64:67], a[88:91], v[220:223]
    ds_read_b64_tr_b16 v[48:49], v73 offset:16384
    v_mfma_f32_16x16x32_bf16 v[220:223], v[68:71], a[92:95], v[220:223]
    buffer_load_dwordx4 a[204:207], v12, s[32:35], s62 offen offset:1024 sc1
    v_mfma_f32_16x16x32_bf16 v[216:219], v[68:71], a[84:87], v[216:219]
    ds_read_b64_tr_b16 v[50:51], v73 offset:17408
    v_mfma_f32_16x16x32_bf16 v[216:219], v[64:67], a[80:83], v[216:219]
    s_add_u32 s62, s62, 2048
    v_mfma_f32_16x16x32_bf16 v[156:159], v[64:67], a[72:75], v[156:159]
    ds_read_b64_tr_b16 v[52:53], v73 offset:24576
    v_mfma_f32_16x16x32_bf16 v[156:159], v[68:71], a[76:79], v[156:159]
    buffer_load_dwordx4 a[208:211], v1, s[32:35], s63 offen offset:0 sc1
    v_mfma_f32_16x16x32_bf16 v[152:155], v[68:71], a[68:71], v[152:155]
    ds_read_b64_tr_b16 v[54:55], v73 offset:25600
    v_mfma_f32_16x16x32_bf16 v[152:155], v[64:67], a[64:67], v[152:155]
    s_waitcnt lgkmcnt(4)
    v_mfma_f32_16x16x32_bf16 v[96:99], v[40:43], a[96:99], v[96:99]
    ds_read_b64_tr_b16 v[56:57], v74 offset:16384
    v_mfma_f32_16x16x32_bf16 v[96:99], v[44:47], a[100:103], v[96:99]
    buffer_load_dwordx4 a[212:215], v1, s[32:35], s63 offen offset:1024 sc1
    v_mfma_f32_16x16x32_bf16 v[100:103], v[44:47], a[108:111], v[100:103]
    ds_read_b64_tr_b16 v[58:59], v74 offset:17408
    v_mfma_f32_16x16x32_bf16 v[100:103], v[40:43], a[104:107], v[100:103]
    v_mfma_f32_16x16x32_bf16 v[160:163], v[40:43], a[112:115], v[160:163]
    ds_read_b64_tr_b16 v[60:61], v74 offset:24576
    v_mfma_f32_16x16x32_bf16 v[160:163], v[44:47], a[116:119], v[160:163]
    buffer_load_dwordx4 a[216:219], v12, s[32:35], s63 offen offset:0 sc1
    v_mfma_f32_16x16x32_bf16 v[164:167], v[44:47], a[124:127], v[164:167]
    ds_read_b64_tr_b16 v[62:63], v74 offset:25600
    v_mfma_f32_16x16x32_bf16 v[164:167], v[40:43], a[120:123], v[164:167]
    s_waitcnt lgkmcnt(4)
    v_mfma_f32_16x16x32_bf16 v[172:175], v[48:51], a[120:123], v[172:175]
    ds_read_b64_tr_b16 v[64:65], v75 offset:16384
    v_mfma_f32_16x16x32_bf16 v[172:175], v[52:55], a[124:127], v[172:175]
    buffer_load_dwordx4 a[220:223], v12, s[32:35], s63 offen offset:1024 sc1
    v_mfma_f32_16x16x32_bf16 v[168:171], v[52:55], a[116:119], v[168:171]
    ds_read_b64_tr_b16 v[66:67], v75 offset:17408
    v_mfma_f32_16x16x32_bf16 v[168:171], v[48:51], a[112:115], v[168:171]
    s_add_u32 s63, s63, 2048
    s_add_u32 m0, s69, 32768
    v_mfma_f32_16x16x32_bf16 v[108:111], v[48:51], a[104:107], v[108:111]
    ds_read_b64_tr_b16 v[68:69], v75 offset:24576
    v_mfma_f32_16x16x32_bf16 v[108:111], v[52:55], a[108:111], v[108:111]
    buffer_load_dwordx4 v21, s[40:43], s68 offen offset:0 lds
    v_mfma_f32_16x16x32_bf16 v[104:107], v[52:55], a[100:103], v[104:107]
    ds_read_b64_tr_b16 v[70:71], v75 offset:25600
    v_mfma_f32_16x16x32_bf16 v[104:107], v[48:51], a[96:99], v[104:107]
    s_waitcnt lgkmcnt(4)
    v_mfma_f32_16x16x32_bf16 v[112:115], v[56:59], a[96:99], v[112:115]
    ds_read_b64_tr_b16 v[40:41], v72 offset:18432
    v_mfma_f32_16x16x32_bf16 v[112:115], v[60:63], a[100:103], v[112:115]
    buffer_load_dwordx4 v22, s[40:43], s68 offen offset:1024 lds
    v_mfma_f32_16x16x32_bf16 v[116:119], v[60:63], a[108:111], v[116:119]
    ds_read_b64_tr_b16 v[42:43], v72 offset:19456
    v_mfma_f32_16x16x32_bf16 v[116:119], v[56:59], a[104:107], v[116:119]
    v_mfma_f32_16x16x32_bf16 v[176:179], v[56:59], a[112:115], v[176:179]
    ds_read_b64_tr_b16 v[44:45], v72 offset:26624
    v_mfma_f32_16x16x32_bf16 v[176:179], v[60:63], a[116:119], v[176:179]
    buffer_load_dwordx4 v23, s[40:43], s68 offen offset:2048 lds
    v_mfma_f32_16x16x32_bf16 v[180:183], v[60:63], a[124:127], v[180:183]
    ds_read_b64_tr_b16 v[46:47], v72 offset:27648
    v_mfma_f32_16x16x32_bf16 v[180:183], v[56:59], a[120:123], v[180:183]
    s_waitcnt lgkmcnt(4)
    v_mfma_f32_16x16x32_bf16 v[188:191], v[64:67], a[120:123], v[188:191]
    ds_read_b64_tr_b16 v[48:49], v73 offset:18432
    v_mfma_f32_16x16x32_bf16 v[188:191], v[68:71], a[124:127], v[188:191]
    buffer_load_dwordx4 v24, s[40:43], s68 offen offset:3072 lds
    v_mfma_f32_16x16x32_bf16 v[184:187], v[68:71], a[116:119], v[184:187]
    ds_read_b64_tr_b16 v[50:51], v73 offset:19456
    v_mfma_f32_16x16x32_bf16 v[184:187], v[64:67], a[112:115], v[184:187]
    s_add_u32 s68, s68, 917504
    s_add_u32 m0, s69, 49152
    v_mfma_f32_16x16x32_bf16 v[124:127], v[64:67], a[104:107], v[124:127]
    ds_read_b64_tr_b16 v[52:53], v73 offset:26624
    v_mfma_f32_16x16x32_bf16 v[124:127], v[68:71], a[108:111], v[124:127]
    buffer_load_dwordx4 v21, s[40:43], s68 offen offset:0 lds
    v_mfma_f32_16x16x32_bf16 v[120:123], v[68:71], a[100:103], v[120:123]
    ds_read_b64_tr_b16 v[54:55], v73 offset:27648
    v_mfma_f32_16x16x32_bf16 v[120:123], v[64:67], a[96:99], v[120:123]
    s_waitcnt lgkmcnt(4)
    v_mfma_f32_16x16x32_bf16 v[128:131], v[40:43], a[96:99], v[128:131]
    ds_read_b64_tr_b16 v[56:57], v74 offset:18432
    v_mfma_f32_16x16x32_bf16 v[128:131], v[44:47], a[100:103], v[128:131]
    buffer_load_dwordx4 v22, s[40:43], s68 offen offset:1024 lds
    v_mfma_f32_16x16x32_bf16 v[132:135], v[44:47], a[108:111], v[132:135]
    ds_read_b64_tr_b16 v[58:59], v74 offset:19456
    v_mfma_f32_16x16x32_bf16 v[132:135], v[40:43], a[104:107], v[132:135]
    v_mfma_f32_16x16x32_bf16 v[192:195], v[40:43], a[112:115], v[192:195]
    ds_read_b64_tr_b16 v[60:61], v74 offset:26624
    v_mfma_f32_16x16x32_bf16 v[192:195], v[44:47], a[116:119], v[192:195]
    buffer_load_dwordx4 v23, s[40:43], s68 offen offset:2048 lds
    v_mfma_f32_16x16x32_bf16 v[196:199], v[44:47], a[124:127], v[196:199]
    ds_read_b64_tr_b16 v[62:63], v74 offset:27648
    v_mfma_f32_16x16x32_bf16 v[196:199], v[40:43], a[120:123], v[196:199]
    s_waitcnt lgkmcnt(4)
    v_mfma_f32_16x16x32_bf16 v[204:207], v[48:51], a[120:123], v[204:207]
    ds_read_b64_tr_b16 v[64:65], v75 offset:18432
    v_mfma_f32_16x16x32_bf16 v[204:207], v[52:55], a[124:127], v[204:207]
    buffer_load_dwordx4 v24, s[40:43], s68 offen offset:3072 lds
    v_mfma_f32_16x16x32_bf16 v[200:203], v[52:55], a[116:119], v[200:203]
    ds_read_b64_tr_b16 v[66:67], v75 offset:19456
    v_mfma_f32_16x16x32_bf16 v[200:203], v[48:51], a[112:115], v[200:203]
    s_sub_u32 s68, s68, 884736
    v_mfma_f32_16x16x32_bf16 v[140:143], v[48:51], a[104:107], v[140:143]
    ds_read_b64_tr_b16 v[68:69], v75 offset:26624
    v_mfma_f32_16x16x32_bf16 v[140:143], v[52:55], a[108:111], v[140:143]
    buffer_load_dwordx4 a[32:35], v1, s[32:35], s62 offen offset:0 sc1
    v_mfma_f32_16x16x32_bf16 v[136:139], v[52:55], a[100:103], v[136:139]
    ds_read_b64_tr_b16 v[70:71], v75 offset:27648
    v_mfma_f32_16x16x32_bf16 v[136:139], v[48:51], a[96:99], v[136:139]
    s_waitcnt lgkmcnt(4)
    v_mfma_f32_16x16x32_bf16 v[144:147], v[56:59], a[96:99], v[144:147]
    ds_read_b64_tr_b16 v[40:41], v72 offset:32768
    v_mfma_f32_16x16x32_bf16 v[144:147], v[60:63], a[100:103], v[144:147]
    buffer_load_dwordx4 a[36:39], v1, s[32:35], s62 offen offset:1024 sc1
    v_mfma_f32_16x16x32_bf16 v[148:151], v[60:63], a[108:111], v[148:151]
    ds_read_b64_tr_b16 v[42:43], v72 offset:33792
    v_mfma_f32_16x16x32_bf16 v[148:151], v[56:59], a[104:107], v[148:151]
    v_mfma_f32_16x16x32_bf16 v[208:211], v[56:59], a[112:115], v[208:211]
    ds_read_b64_tr_b16 v[44:45], v72 offset:40960
    v_mfma_f32_16x16x32_bf16 v[208:211], v[60:63], a[116:119], v[208:211]
    buffer_load_dwordx4 a[40:43], v12, s[32:35], s62 offen offset:0 sc1
    v_mfma_f32_16x16x32_bf16 v[212:215], v[60:63], a[124:127], v[212:215]
    ds_read_b64_tr_b16 v[46:47], v72 offset:41984
    v_mfma_f32_16x16x32_bf16 v[212:215], v[56:59], a[120:123], v[212:215]
    s_waitcnt lgkmcnt(4)
    v_mfma_f32_16x16x32_bf16 v[220:223], v[64:67], a[120:123], v[220:223]
    ds_read_b64_tr_b16 v[48:49], v73 offset:32768
    v_mfma_f32_16x16x32_bf16 v[220:223], v[68:71], a[124:127], v[220:223]
    buffer_load_dwordx4 a[44:47], v12, s[32:35], s62 offen offset:1024 sc1
    v_mfma_f32_16x16x32_bf16 v[216:219], v[68:71], a[116:119], v[216:219]
    ds_read_b64_tr_b16 v[50:51], v73 offset:33792
    v_mfma_f32_16x16x32_bf16 v[216:219], v[64:67], a[112:115], v[216:219]
    s_add_u32 s62, s62, 2048
    v_mfma_f32_16x16x32_bf16 v[156:159], v[64:67], a[104:107], v[156:159]
    ds_read_b64_tr_b16 v[52:53], v73 offset:40960
    v_mfma_f32_16x16x32_bf16 v[156:159], v[68:71], a[108:111], v[156:159]
    buffer_load_dwordx4 a[48:51], v1, s[32:35], s63 offen offset:0 sc1
    v_mfma_f32_16x16x32_bf16 v[152:155], v[68:71], a[100:103], v[152:155]
    ds_read_b64_tr_b16 v[54:55], v73 offset:41984
    v_mfma_f32_16x16x32_bf16 v[152:155], v[64:67], a[96:99], v[152:155]
    s_waitcnt lgkmcnt(4)
    v_mfma_f32_16x16x32_bf16 v[96:99], v[40:43], a[128:131], v[96:99]
    ds_read_b64_tr_b16 v[56:57], v74 offset:32768
    v_mfma_f32_16x16x32_bf16 v[96:99], v[44:47], a[132:135], v[96:99]
    buffer_load_dwordx4 a[52:55], v1, s[32:35], s63 offen offset:1024 sc1
    v_mfma_f32_16x16x32_bf16 v[100:103], v[44:47], a[140:143], v[100:103]
    ds_read_b64_tr_b16 v[58:59], v74 offset:33792
    v_mfma_f32_16x16x32_bf16 v[100:103], v[40:43], a[136:139], v[100:103]
    v_mfma_f32_16x16x32_bf16 v[160:163], v[40:43], a[144:147], v[160:163]
    ds_read_b64_tr_b16 v[60:61], v74 offset:40960
    v_mfma_f32_16x16x32_bf16 v[160:163], v[44:47], a[148:151], v[160:163]
    buffer_load_dwordx4 a[56:59], v12, s[32:35], s63 offen offset:0 sc1
    v_mfma_f32_16x16x32_bf16 v[164:167], v[44:47], a[156:159], v[164:167]
    ds_read_b64_tr_b16 v[62:63], v74 offset:41984
    v_mfma_f32_16x16x32_bf16 v[164:167], v[40:43], a[152:155], v[164:167]
    s_waitcnt lgkmcnt(4)
    v_mfma_f32_16x16x32_bf16 v[172:175], v[48:51], a[152:155], v[172:175]
    ds_read_b64_tr_b16 v[64:65], v75 offset:32768
    v_mfma_f32_16x16x32_bf16 v[172:175], v[52:55], a[156:159], v[172:175]
    buffer_load_dwordx4 a[60:63], v12, s[32:35], s63 offen offset:1024 sc1
    v_mfma_f32_16x16x32_bf16 v[168:171], v[52:55], a[148:151], v[168:171]
    ds_read_b64_tr_b16 v[66:67], v75 offset:33792
    v_mfma_f32_16x16x32_bf16 v[168:171], v[48:51], a[144:147], v[168:171]
    s_add_u32 s63, s63, 2048
    v_mfma_f32_16x16x32_bf16 v[108:111], v[48:51], a[136:139], v[108:111]
    ds_read_b64_tr_b16 v[68:69], v75 offset:40960
    v_mfma_f32_16x16x32_bf16 v[108:111], v[52:55], a[140:143], v[108:111]
    buffer_load_dwordx4 a[0:3], v1, s[32:35], s62 offen offset:0 sc1
    v_mfma_f32_16x16x32_bf16 v[104:107], v[52:55], a[132:135], v[104:107]
    ds_read_b64_tr_b16 v[70:71], v75 offset:41984
    v_mfma_f32_16x16x32_bf16 v[104:107], v[48:51], a[128:131], v[104:107]
    s_waitcnt lgkmcnt(4)
    v_mfma_f32_16x16x32_bf16 v[112:115], v[56:59], a[128:131], v[112:115]
    ds_read_b64_tr_b16 v[40:41], v72 offset:34816
    v_mfma_f32_16x16x32_bf16 v[112:115], v[60:63], a[132:135], v[112:115]
    buffer_load_dwordx4 a[4:7], v1, s[32:35], s62 offen offset:1024 sc1
    v_mfma_f32_16x16x32_bf16 v[116:119], v[60:63], a[140:143], v[116:119]
    ds_read_b64_tr_b16 v[42:43], v72 offset:35840
    v_mfma_f32_16x16x32_bf16 v[116:119], v[56:59], a[136:139], v[116:119]
    v_mfma_f32_16x16x32_bf16 v[176:179], v[56:59], a[144:147], v[176:179]
    ds_read_b64_tr_b16 v[44:45], v72 offset:43008
    v_mfma_f32_16x16x32_bf16 v[176:179], v[60:63], a[148:151], v[176:179]
    buffer_load_dwordx4 a[8:11], v12, s[32:35], s62 offen offset:0 sc1
    v_mfma_f32_16x16x32_bf16 v[180:183], v[60:63], a[156:159], v[180:183]
    ds_read_b64_tr_b16 v[46:47], v72 offset:44032
    v_mfma_f32_16x16x32_bf16 v[180:183], v[56:59], a[152:155], v[180:183]
    s_waitcnt lgkmcnt(4)
    v_mfma_f32_16x16x32_bf16 v[188:191], v[64:67], a[152:155], v[188:191]
    ds_read_b64_tr_b16 v[48:49], v73 offset:34816
    v_mfma_f32_16x16x32_bf16 v[188:191], v[68:71], a[156:159], v[188:191]
    buffer_load_dwordx4 a[12:15], v12, s[32:35], s62 offen offset:1024 sc1
    v_mfma_f32_16x16x32_bf16 v[184:187], v[68:71], a[148:151], v[184:187]
    ds_read_b64_tr_b16 v[50:51], v73 offset:35840
    v_mfma_f32_16x16x32_bf16 v[184:187], v[64:67], a[144:147], v[184:187]
    s_add_u32 s62, s62, 2048
    v_mfma_f32_16x16x32_bf16 v[124:127], v[64:67], a[136:139], v[124:127]
    ds_read_b64_tr_b16 v[52:53], v73 offset:43008
    v_mfma_f32_16x16x32_bf16 v[124:127], v[68:71], a[140:143], v[124:127]
    buffer_load_dwordx4 a[16:19], v1, s[32:35], s63 offen offset:0 sc1
    v_mfma_f32_16x16x32_bf16 v[120:123], v[68:71], a[132:135], v[120:123]
    ds_read_b64_tr_b16 v[54:55], v73 offset:44032
    v_mfma_f32_16x16x32_bf16 v[120:123], v[64:67], a[128:131], v[120:123]
    s_waitcnt lgkmcnt(4)
    v_mfma_f32_16x16x32_bf16 v[128:131], v[40:43], a[128:131], v[128:131]
    ds_read_b64_tr_b16 v[56:57], v74 offset:34816
    v_mfma_f32_16x16x32_bf16 v[128:131], v[44:47], a[132:135], v[128:131]
    buffer_load_dwordx4 a[20:23], v1, s[32:35], s63 offen offset:1024 sc1
    v_mfma_f32_16x16x32_bf16 v[132:135], v[44:47], a[140:143], v[132:135]
    ds_read_b64_tr_b16 v[58:59], v74 offset:35840
    v_mfma_f32_16x16x32_bf16 v[132:135], v[40:43], a[136:139], v[132:135]
    v_mfma_f32_16x16x32_bf16 v[192:195], v[40:43], a[144:147], v[192:195]
    ds_read_b64_tr_b16 v[60:61], v74 offset:43008
    v_mfma_f32_16x16x32_bf16 v[192:195], v[44:47], a[148:151], v[192:195]
    buffer_load_dwordx4 a[24:27], v12, s[32:35], s63 offen offset:0 sc1
    v_mfma_f32_16x16x32_bf16 v[196:199], v[44:47], a[156:159], v[196:199]
    ds_read_b64_tr_b16 v[62:63], v74 offset:44032
    v_mfma_f32_16x16x32_bf16 v[196:199], v[40:43], a[152:155], v[196:199]
    s_waitcnt lgkmcnt(4)
    v_mfma_f32_16x16x32_bf16 v[204:207], v[48:51], a[152:155], v[204:207]
    ds_read_b64_tr_b16 v[64:65], v75 offset:34816
    v_mfma_f32_16x16x32_bf16 v[204:207], v[52:55], a[156:159], v[204:207]
    buffer_load_dwordx4 a[28:31], v12, s[32:35], s63 offen offset:1024 sc1
    v_mfma_f32_16x16x32_bf16 v[200:203], v[52:55], a[148:151], v[200:203]
    ds_read_b64_tr_b16 v[66:67], v75 offset:35840
    v_mfma_f32_16x16x32_bf16 v[200:203], v[48:51], a[144:147], v[200:203]
    s_add_u32 s63, s63, 2048
    v_mfma_f32_16x16x32_bf16 v[140:143], v[48:51], a[136:139], v[140:143]
    ds_read_b64_tr_b16 v[68:69], v75 offset:43008
    v_mfma_f32_16x16x32_bf16 v[140:143], v[52:55], a[140:143], v[140:143]
    buffer_load_dwordx4 a[64:67], v1, s[32:35], s62 offen offset:0 sc1
    v_mfma_f32_16x16x32_bf16 v[136:139], v[52:55], a[132:135], v[136:139]
    ds_read_b64_tr_b16 v[70:71], v75 offset:44032
    v_mfma_f32_16x16x32_bf16 v[136:139], v[48:51], a[128:131], v[136:139]
    s_waitcnt lgkmcnt(4)
    v_mfma_f32_16x16x32_bf16 v[144:147], v[56:59], a[128:131], v[144:147]
    s_waitcnt vmcnt(17)
    s_barrier
    ds_read_b64_tr_b16 v[40:41], v72 offset:49152
    v_mfma_f32_16x16x32_bf16 v[144:147], v[60:63], a[132:135], v[144:147]
    buffer_load_dwordx4 a[68:71], v1, s[32:35], s62 offen offset:1024 sc1
    v_mfma_f32_16x16x32_bf16 v[148:151], v[60:63], a[140:143], v[148:151]
    ds_read_b64_tr_b16 v[42:43], v72 offset:50176
    v_mfma_f32_16x16x32_bf16 v[148:151], v[56:59], a[136:139], v[148:151]
    v_mfma_f32_16x16x32_bf16 v[208:211], v[56:59], a[144:147], v[208:211]
    ds_read_b64_tr_b16 v[44:45], v72 offset:57344
    v_mfma_f32_16x16x32_bf16 v[208:211], v[60:63], a[148:151], v[208:211]
    buffer_load_dwordx4 a[72:75], v12, s[32:35], s62 offen offset:0 sc1
    v_mfma_f32_16x16x32_bf16 v[212:215], v[60:63], a[156:159], v[212:215]
    ds_read_b64_tr_b16 v[46:47], v72 offset:58368
    v_mfma_f32_16x16x32_bf16 v[212:215], v[56:59], a[152:155], v[212:215]
    s_waitcnt lgkmcnt(4)
    v_mfma_f32_16x16x32_bf16 v[220:223], v[64:67], a[152:155], v[220:223]
    ds_read_b64_tr_b16 v[48:49], v73 offset:49152
    v_mfma_f32_16x16x32_bf16 v[220:223], v[68:71], a[156:159], v[220:223]
    buffer_load_dwordx4 a[76:79], v12, s[32:35], s62 offen offset:1024 sc1
    v_mfma_f32_16x16x32_bf16 v[216:219], v[68:71], a[148:151], v[216:219]
    ds_read_b64_tr_b16 v[50:51], v73 offset:50176
    v_mfma_f32_16x16x32_bf16 v[216:219], v[64:67], a[144:147], v[216:219]
    s_add_u32 s62, s62, 2048
    v_mfma_f32_16x16x32_bf16 v[156:159], v[64:67], a[136:139], v[156:159]
    ds_read_b64_tr_b16 v[52:53], v73 offset:57344
    v_mfma_f32_16x16x32_bf16 v[156:159], v[68:71], a[140:143], v[156:159]
    buffer_load_dwordx4 a[80:83], v1, s[32:35], s63 offen offset:0 sc1
    v_mfma_f32_16x16x32_bf16 v[152:155], v[68:71], a[132:135], v[152:155]
    ds_read_b64_tr_b16 v[54:55], v73 offset:58368
    v_mfma_f32_16x16x32_bf16 v[152:155], v[64:67], a[128:131], v[152:155]
    s_waitcnt lgkmcnt(4)
    v_mfma_f32_16x16x32_bf16 v[96:99], v[40:43], a[160:163], v[96:99]
    ds_read_b64_tr_b16 v[56:57], v74 offset:49152
    v_mfma_f32_16x16x32_bf16 v[96:99], v[44:47], a[164:167], v[96:99]
    buffer_load_dwordx4 a[84:87], v1, s[32:35], s63 offen offset:1024 sc1
    v_mfma_f32_16x16x32_bf16 v[100:103], v[44:47], a[172:175], v[100:103]
    ds_read_b64_tr_b16 v[58:59], v74 offset:50176
    v_mfma_f32_16x16x32_bf16 v[100:103], v[40:43], a[168:171], v[100:103]
    v_mfma_f32_16x16x32_bf16 v[160:163], v[40:43], a[176:179], v[160:163]
    ds_read_b64_tr_b16 v[60:61], v74 offset:57344
    v_mfma_f32_16x16x32_bf16 v[160:163], v[44:47], a[180:183], v[160:163]
    buffer_load_dwordx4 a[88:91], v12, s[32:35], s63 offen offset:0 sc1
    v_mfma_f32_16x16x32_bf16 v[164:167], v[44:47], a[188:191], v[164:167]
    ds_read_b64_tr_b16 v[62:63], v74 offset:58368
    v_mfma_f32_16x16x32_bf16 v[164:167], v[40:43], a[184:187], v[164:167]
    s_waitcnt lgkmcnt(4)
    v_mfma_f32_16x16x32_bf16 v[172:175], v[48:51], a[184:187], v[172:175]
    ds_read_b64_tr_b16 v[64:65], v75 offset:49152
    v_mfma_f32_16x16x32_bf16 v[172:175], v[52:55], a[188:191], v[172:175]
    buffer_load_dwordx4 a[92:95], v12, s[32:35], s63 offen offset:1024 sc1
    v_mfma_f32_16x16x32_bf16 v[168:171], v[52:55], a[180:183], v[168:171]
    ds_read_b64_tr_b16 v[66:67], v75 offset:50176
    v_mfma_f32_16x16x32_bf16 v[168:171], v[48:51], a[176:179], v[168:171]
    s_add_u32 s63, s63, 2048
    s_add_u32 m0, s69, 65536
    v_mfma_f32_16x16x32_bf16 v[108:111], v[48:51], a[168:171], v[108:111]
    ds_read_b64_tr_b16 v[68:69], v75 offset:57344
    v_mfma_f32_16x16x32_bf16 v[108:111], v[52:55], a[172:175], v[108:111]
    buffer_load_dwordx4 v21, s[40:43], s68 offen offset:0 lds
    v_mfma_f32_16x16x32_bf16 v[104:107], v[52:55], a[164:167], v[104:107]
    ds_read_b64_tr_b16 v[70:71], v75 offset:58368
    v_mfma_f32_16x16x32_bf16 v[104:107], v[48:51], a[160:163], v[104:107]
    s_waitcnt lgkmcnt(4)
    v_mfma_f32_16x16x32_bf16 v[112:115], v[56:59], a[160:163], v[112:115]
    ds_read_b64_tr_b16 v[40:41], v72 offset:51200
    v_mfma_f32_16x16x32_bf16 v[112:115], v[60:63], a[164:167], v[112:115]
    buffer_load_dwordx4 v22, s[40:43], s68 offen offset:1024 lds
    v_mfma_f32_16x16x32_bf16 v[116:119], v[60:63], a[172:175], v[116:119]
    ds_read_b64_tr_b16 v[42:43], v72 offset:52224
    v_mfma_f32_16x16x32_bf16 v[116:119], v[56:59], a[168:171], v[116:119]
    v_mfma_f32_16x16x32_bf16 v[176:179], v[56:59], a[176:179], v[176:179]
    ds_read_b64_tr_b16 v[44:45], v72 offset:59392
    v_mfma_f32_16x16x32_bf16 v[176:179], v[60:63], a[180:183], v[176:179]
    buffer_load_dwordx4 v23, s[40:43], s68 offen offset:2048 lds
    v_mfma_f32_16x16x32_bf16 v[180:183], v[60:63], a[188:191], v[180:183]
    ds_read_b64_tr_b16 v[46:47], v72 offset:60416
    v_mfma_f32_16x16x32_bf16 v[180:183], v[56:59], a[184:187], v[180:183]
    s_waitcnt lgkmcnt(4)
    v_mfma_f32_16x16x32_bf16 v[188:191], v[64:67], a[184:187], v[188:191]
    ds_read_b64_tr_b16 v[48:49], v73 offset:51200
    v_mfma_f32_16x16x32_bf16 v[188:191], v[68:71], a[188:191], v[188:191]
    buffer_load_dwordx4 v24, s[40:43], s68 offen offset:3072 lds
    v_mfma_f32_16x16x32_bf16 v[184:187], v[68:71], a[180:183], v[184:187]
    ds_read_b64_tr_b16 v[50:51], v73 offset:52224
    v_mfma_f32_16x16x32_bf16 v[184:187], v[64:67], a[176:179], v[184:187]
    s_add_u32 s68, s68, 917504
    s_add_u32 m0, s69, 81920
    v_mfma_f32_16x16x32_bf16 v[124:127], v[64:67], a[168:171], v[124:127]
    ds_read_b64_tr_b16 v[52:53], v73 offset:59392
    v_mfma_f32_16x16x32_bf16 v[124:127], v[68:71], a[172:175], v[124:127]
    buffer_load_dwordx4 v21, s[40:43], s68 offen offset:0 lds
    v_mfma_f32_16x16x32_bf16 v[120:123], v[68:71], a[164:167], v[120:123]
    ds_read_b64_tr_b16 v[54:55], v73 offset:60416
    v_mfma_f32_16x16x32_bf16 v[120:123], v[64:67], a[160:163], v[120:123]
    s_waitcnt lgkmcnt(4)
    v_mfma_f32_16x16x32_bf16 v[128:131], v[40:43], a[160:163], v[128:131]
    ds_read_b64_tr_b16 v[56:57], v74 offset:51200
    v_mfma_f32_16x16x32_bf16 v[128:131], v[44:47], a[164:167], v[128:131]
    buffer_load_dwordx4 v22, s[40:43], s68 offen offset:1024 lds
    v_mfma_f32_16x16x32_bf16 v[132:135], v[44:47], a[172:175], v[132:135]
    ds_read_b64_tr_b16 v[58:59], v74 offset:52224
    v_mfma_f32_16x16x32_bf16 v[132:135], v[40:43], a[168:171], v[132:135]
    v_mfma_f32_16x16x32_bf16 v[192:195], v[40:43], a[176:179], v[192:195]
    ds_read_b64_tr_b16 v[60:61], v74 offset:59392
    v_mfma_f32_16x16x32_bf16 v[192:195], v[44:47], a[180:183], v[192:195]
    buffer_load_dwordx4 v23, s[40:43], s68 offen offset:2048 lds
    v_mfma_f32_16x16x32_bf16 v[196:199], v[44:47], a[188:191], v[196:199]
    ds_read_b64_tr_b16 v[62:63], v74 offset:60416
    v_mfma_f32_16x16x32_bf16 v[196:199], v[40:43], a[184:187], v[196:199]
    s_waitcnt lgkmcnt(4)
    v_mfma_f32_16x16x32_bf16 v[204:207], v[48:51], a[184:187], v[204:207]
    ds_read_b64_tr_b16 v[64:65], v75 offset:51200
    v_mfma_f32_16x16x32_bf16 v[204:207], v[52:55], a[188:191], v[204:207]
    buffer_load_dwordx4 v24, s[40:43], s68 offen offset:3072 lds
    v_mfma_f32_16x16x32_bf16 v[200:203], v[52:55], a[180:183], v[200:203]
    ds_read_b64_tr_b16 v[66:67], v75 offset:52224
    v_mfma_f32_16x16x32_bf16 v[200:203], v[48:51], a[176:179], v[200:203]
    s_sub_u32 s68, s68, 884736
    v_mfma_f32_16x16x32_bf16 v[140:143], v[48:51], a[168:171], v[140:143]
    ds_read_b64_tr_b16 v[68:69], v75 offset:59392
    v_mfma_f32_16x16x32_bf16 v[140:143], v[52:55], a[172:175], v[140:143]
    buffer_load_dwordx4 a[96:99], v1, s[32:35], s62 offen offset:0 sc1
    v_mfma_f32_16x16x32_bf16 v[136:139], v[52:55], a[164:167], v[136:139]
    ds_read_b64_tr_b16 v[70:71], v75 offset:60416
    v_mfma_f32_16x16x32_bf16 v[136:139], v[48:51], a[160:163], v[136:139]
    s_waitcnt lgkmcnt(4)
    v_mfma_f32_16x16x32_bf16 v[144:147], v[56:59], a[160:163], v[144:147]
    ds_read_b64_tr_b16 v[40:41], v16 offset:2048
    v_mfma_f32_16x16x32_bf16 v[144:147], v[60:63], a[164:167], v[144:147]
    buffer_load_dwordx4 a[100:103], v1, s[32:35], s62 offen offset:1024 sc1
    v_mfma_f32_16x16x32_bf16 v[148:151], v[60:63], a[172:175], v[148:151]
    ds_read_b64_tr_b16 v[42:43], v16 offset:3072
    v_mfma_f32_16x16x32_bf16 v[148:151], v[56:59], a[168:171], v[148:151]
    v_mfma_f32_16x16x32_bf16 v[208:211], v[56:59], a[176:179], v[208:211]
    ds_read_b64_tr_b16 v[44:45], v16 offset:10240
    v_mfma_f32_16x16x32_bf16 v[208:211], v[60:63], a[180:183], v[208:211]
    buffer_load_dwordx4 a[104:107], v12, s[32:35], s62 offen offset:0 sc1
    v_mfma_f32_16x16x32_bf16 v[212:215], v[60:63], a[188:191], v[212:215]
    ds_read_b64_tr_b16 v[46:47], v16 offset:11264
    v_mfma_f32_16x16x32_bf16 v[212:215], v[56:59], a[184:187], v[212:215]
    s_waitcnt lgkmcnt(4)
    v_mfma_f32_16x16x32_bf16 v[220:223], v[64:67], a[184:187], v[220:223]
    ds_read_b64_tr_b16 v[48:49], v17 offset:2048
    v_mfma_f32_16x16x32_bf16 v[220:223], v[68:71], a[188:191], v[220:223]
    buffer_load_dwordx4 a[108:111], v12, s[32:35], s62 offen offset:1024 sc1
    v_mfma_f32_16x16x32_bf16 v[216:219], v[68:71], a[180:183], v[216:219]
    ds_read_b64_tr_b16 v[50:51], v17 offset:3072
    v_mfma_f32_16x16x32_bf16 v[216:219], v[64:67], a[176:179], v[216:219]
    s_add_u32 s62, s62, 2048
    v_mfma_f32_16x16x32_bf16 v[156:159], v[64:67], a[168:171], v[156:159]
    ds_read_b64_tr_b16 v[52:53], v17 offset:10240
    v_mfma_f32_16x16x32_bf16 v[156:159], v[68:71], a[172:175], v[156:159]
    buffer_load_dwordx4 a[112:115], v1, s[32:35], s63 offen offset:0 sc1
    v_mfma_f32_16x16x32_bf16 v[152:155], v[68:71], a[164:167], v[152:155]
    ds_read_b64_tr_b16 v[54:55], v17 offset:11264
    v_mfma_f32_16x16x32_bf16 v[152:155], v[64:67], a[160:163], v[152:155]
    s_waitcnt lgkmcnt(4)
    v_mfma_f32_16x16x32_bf16 v[128:131], v[40:43], a[192:195], v[128:131]
    ds_read_b64_tr_b16 v[56:57], v18 offset:2048
    v_mfma_f32_16x16x32_bf16 v[128:131], v[44:47], a[196:199], v[128:131]
    buffer_load_dwordx4 a[116:119], v1, s[32:35], s63 offen offset:1024 sc1
    v_mfma_f32_16x16x32_bf16 v[132:135], v[44:47], a[204:207], v[132:135]
    ds_read_b64_tr_b16 v[58:59], v18 offset:3072
    v_mfma_f32_16x16x32_bf16 v[132:135], v[40:43], a[200:203], v[132:135]
    v_mfma_f32_16x16x32_bf16 v[192:195], v[40:43], a[208:211], v[192:195]
    ds_read_b64_tr_b16 v[60:61], v18 offset:10240
    v_mfma_f32_16x16x32_bf16 v[192:195], v[44:47], a[212:215], v[192:195]
    buffer_load_dwordx4 a[120:123], v12, s[32:35], s63 offen offset:0 sc1
    v_mfma_f32_16x16x32_bf16 v[196:199], v[44:47], a[220:223], v[196:199]
    ds_read_b64_tr_b16 v[62:63], v18 offset:11264
    v_mfma_f32_16x16x32_bf16 v[196:199], v[40:43], a[216:219], v[196:199]
    s_waitcnt lgkmcnt(4)
    v_mfma_f32_16x16x32_bf16 v[204:207], v[48:51], a[216:219], v[204:207]
    ds_read_b64_tr_b16 v[64:65], v19 offset:2048
    v_mfma_f32_16x16x32_bf16 v[204:207], v[52:55], a[220:223], v[204:207]
    buffer_load_dwordx4 a[124:127], v12, s[32:35], s63 offen offset:1024 sc1
    v_mfma_f32_16x16x32_bf16 v[200:203], v[52:55], a[212:215], v[200:203]
    ds_read_b64_tr_b16 v[66:67], v19 offset:3072
    v_mfma_f32_16x16x32_bf16 v[200:203], v[48:51], a[208:211], v[200:203]
    s_add_u32 s63, s63, 2048
    v_mfma_f32_16x16x32_bf16 v[140:143], v[48:51], a[200:203], v[140:143]
    ds_read_b64_tr_b16 v[68:69], v19 offset:10240
    v_mfma_f32_16x16x32_bf16 v[140:143], v[52:55], a[204:207], v[140:143]
    buffer_load_dwordx4 a[128:131], v1, s[32:35], s62 offen offset:0 sc1
    v_mfma_f32_16x16x32_bf16 v[136:139], v[52:55], a[196:199], v[136:139]
    ds_read_b64_tr_b16 v[70:71], v19 offset:11264
    v_mfma_f32_16x16x32_bf16 v[136:139], v[48:51], a[192:195], v[136:139]
    s_waitcnt lgkmcnt(4)
    v_mfma_f32_16x16x32_bf16 v[144:147], v[56:59], a[192:195], v[144:147]
    ds_read_b64_tr_b16 v[40:41], v16 offset:18432
    v_mfma_f32_16x16x32_bf16 v[144:147], v[60:63], a[196:199], v[144:147]
    buffer_load_dwordx4 a[132:135], v1, s[32:35], s62 offen offset:1024 sc1
    v_mfma_f32_16x16x32_bf16 v[148:151], v[60:63], a[204:207], v[148:151]
    ds_read_b64_tr_b16 v[42:43], v16 offset:19456
    v_mfma_f32_16x16x32_bf16 v[148:151], v[56:59], a[200:203], v[148:151]
    v_mfma_f32_16x16x32_bf16 v[208:211], v[56:59], a[208:211], v[208:211]
    ds_read_b64_tr_b16 v[44:45], v16 offset:26624
    v_mfma_f32_16x16x32_bf16 v[208:211], v[60:63], a[212:215], v[208:211]
    buffer_load_dwordx4 a[136:139], v12, s[32:35], s62 offen offset:0 sc1
    v_mfma_f32_16x16x32_bf16 v[212:215], v[60:63], a[220:223], v[212:215]
    ds_read_b64_tr_b16 v[46:47], v16 offset:27648
    v_mfma_f32_16x16x32_bf16 v[212:215], v[56:59], a[216:219], v[212:215]
    s_waitcnt lgkmcnt(4)
    v_mfma_f32_16x16x32_bf16 v[220:223], v[64:67], a[216:219], v[220:223]
    ds_read_b64_tr_b16 v[48:49], v17 offset:18432
    v_mfma_f32_16x16x32_bf16 v[220:223], v[68:71], a[220:223], v[220:223]
    buffer_load_dwordx4 a[140:143], v12, s[32:35], s62 offen offset:1024 sc1
    v_mfma_f32_16x16x32_bf16 v[216:219], v[68:71], a[212:215], v[216:219]
    ds_read_b64_tr_b16 v[50:51], v17 offset:19456
    v_mfma_f32_16x16x32_bf16 v[216:219], v[64:67], a[208:211], v[216:219]
    s_add_u32 s62, s62, 2048
    v_mfma_f32_16x16x32_bf16 v[156:159], v[64:67], a[200:203], v[156:159]
    ds_read_b64_tr_b16 v[52:53], v17 offset:26624
    v_mfma_f32_16x16x32_bf16 v[156:159], v[68:71], a[204:207], v[156:159]
    buffer_load_dwordx4 a[144:147], v1, s[32:35], s63 offen offset:0 sc1
    v_mfma_f32_16x16x32_bf16 v[152:155], v[68:71], a[196:199], v[152:155]
    ds_read_b64_tr_b16 v[54:55], v17 offset:27648
    v_mfma_f32_16x16x32_bf16 v[152:155], v[64:67], a[192:195], v[152:155]
    s_waitcnt vmcnt(37) lgkmcnt(4)
    v_mfma_f32_16x16x32_bf16 v[128:131], v[40:43], a[32:35], v[128:131]
    ds_read_b64_tr_b16 v[56:57], v18 offset:18432
    v_mfma_f32_16x16x32_bf16 v[128:131], v[44:47], a[36:39], v[128:131]
    buffer_load_dwordx4 a[148:151], v1, s[32:35], s63 offen offset:1024 sc1
    v_mfma_f32_16x16x32_bf16 v[132:135], v[44:47], a[44:47], v[132:135]
    ds_read_b64_tr_b16 v[58:59], v18 offset:19456
    v_mfma_f32_16x16x32_bf16 v[132:135], v[40:43], a[40:43], v[132:135]
    v_mfma_f32_16x16x32_bf16 v[192:195], v[40:43], a[48:51], v[192:195]
    ds_read_b64_tr_b16 v[60:61], v18 offset:26624
    v_mfma_f32_16x16x32_bf16 v[192:195], v[44:47], a[52:55], v[192:195]
    buffer_load_dwordx4 a[152:155], v12, s[32:35], s63 offen offset:0 sc1
    v_mfma_f32_16x16x32_bf16 v[196:199], v[44:47], a[60:63], v[196:199]
    ds_read_b64_tr_b16 v[62:63], v18 offset:27648
    v_mfma_f32_16x16x32_bf16 v[196:199], v[40:43], a[56:59], v[196:199]
    s_waitcnt lgkmcnt(4)
    v_mfma_f32_16x16x32_bf16 v[204:207], v[48:51], a[56:59], v[204:207]
    ds_read_b64_tr_b16 v[64:65], v19 offset:18432
    v_mfma_f32_16x16x32_bf16 v[204:207], v[52:55], a[60:63], v[204:207]
    buffer_load_dwordx4 a[156:159], v12, s[32:35], s63 offen offset:1024 sc1
    v_mfma_f32_16x16x32_bf16 v[200:203], v[52:55], a[52:55], v[200:203]
    ds_read_b64_tr_b16 v[66:67], v19 offset:19456
    v_mfma_f32_16x16x32_bf16 v[200:203], v[48:51], a[48:51], v[200:203]
    s_add_u32 s63, s63, 2048
    v_mfma_f32_16x16x32_bf16 v[140:143], v[48:51], a[40:43], v[140:143]
    ds_read_b64_tr_b16 v[68:69], v19 offset:26624
    v_mfma_f32_16x16x32_bf16 v[140:143], v[52:55], a[44:47], v[140:143]
    v_mfma_f32_16x16x32_bf16 v[136:139], v[52:55], a[36:39], v[136:139]
    ds_read_b64_tr_b16 v[70:71], v19 offset:27648
    v_mfma_f32_16x16x32_bf16 v[136:139], v[48:51], a[32:35], v[136:139]
    s_waitcnt lgkmcnt(4)
    v_mfma_f32_16x16x32_bf16 v[144:147], v[56:59], a[32:35], v[144:147]
    s_waitcnt vmcnt(16)
    s_barrier
    ds_read_b64_tr_b16 v[40:41], v16 offset:34816
    v_mfma_f32_16x16x32_bf16 v[144:147], v[60:63], a[36:39], v[144:147]
    v_mfma_f32_16x16x32_bf16 v[148:151], v[60:63], a[44:47], v[148:151]
    ds_read_b64_tr_b16 v[42:43], v16 offset:35840
    v_mfma_f32_16x16x32_bf16 v[148:151], v[56:59], a[40:43], v[148:151]
    v_mfma_f32_16x16x32_bf16 v[208:211], v[56:59], a[48:51], v[208:211]
    ds_read_b64_tr_b16 v[44:45], v16 offset:43008
    v_mfma_f32_16x16x32_bf16 v[208:211], v[60:63], a[52:55], v[208:211]
    v_mfma_f32_16x16x32_bf16 v[212:215], v[60:63], a[60:63], v[212:215]
    ds_read_b64_tr_b16 v[46:47], v16 offset:44032
    v_mfma_f32_16x16x32_bf16 v[212:215], v[56:59], a[56:59], v[212:215]
    s_waitcnt lgkmcnt(4)
    v_mfma_f32_16x16x32_bf16 v[220:223], v[64:67], a[56:59], v[220:223]
    ds_read_b64_tr_b16 v[48:49], v16 offset:51200
    v_mfma_f32_16x16x32_bf16 v[220:223], v[68:71], a[60:63], v[220:223]
    v_mfma_f32_16x16x32_bf16 v[216:219], v[68:71], a[52:55], v[216:219]
    ds_read_b64_tr_b16 v[50:51], v16 offset:52224
    v_mfma_f32_16x16x32_bf16 v[216:219], v[64:67], a[48:51], v[216:219]
    v_mfma_f32_16x16x32_bf16 v[156:159], v[64:67], a[40:43], v[156:159]
    ds_read_b64_tr_b16 v[52:53], v16 offset:59392
    v_mfma_f32_16x16x32_bf16 v[156:159], v[68:71], a[44:47], v[156:159]
    v_mfma_f32_16x16x32_bf16 v[152:155], v[68:71], a[36:39], v[152:155]
    ds_read_b64_tr_b16 v[54:55], v16 offset:60416
    v_mfma_f32_16x16x32_bf16 v[152:155], v[64:67], a[32:35], v[152:155]
    s_waitcnt lgkmcnt(4)
    v_mfma_f32_16x16x32_bf16 v[128:131], v[40:43], a[0:3], v[128:131]
    ds_read_b64_tr_b16 v[56:57], v72 offset:2048
    v_mfma_f32_16x16x32_bf16 v[128:131], v[44:47], a[4:7], v[128:131]
    v_mfma_f32_16x16x32_bf16 v[132:135], v[44:47], a[12:15], v[132:135]
    ds_read_b64_tr_b16 v[58:59], v72 offset:3072
    v_mfma_f32_16x16x32_bf16 v[132:135], v[40:43], a[8:11], v[132:135]
    v_mfma_f32_16x16x32_bf16 v[192:195], v[40:43], a[16:19], v[192:195]
    ds_read_b64_tr_b16 v[60:61], v72 offset:10240
    v_mfma_f32_16x16x32_bf16 v[192:195], v[44:47], a[20:23], v[192:195]
    v_mfma_f32_16x16x32_bf16 v[196:199], v[44:47], a[28:31], v[196:199]
    ds_read_b64_tr_b16 v[62:63], v72 offset:11264
    v_mfma_f32_16x16x32_bf16 v[196:199], v[40:43], a[24:27], v[196:199]
    s_waitcnt lgkmcnt(4)
    v_mfma_f32_16x16x32_bf16 v[196:199], v[48:51], a[88:91], v[196:199]
    ds_read_b64_tr_b16 v[64:65], v72 offset:18432
    v_mfma_f32_16x16x32_bf16 v[196:199], v[52:55], a[92:95], v[196:199]
    v_mfma_f32_16x16x32_bf16 v[192:195], v[52:55], a[84:87], v[192:195]
    ds_read_b64_tr_b16 v[66:67], v72 offset:19456
    v_mfma_f32_16x16x32_bf16 v[192:195], v[48:51], a[80:83], v[192:195]
    v_mfma_f32_16x16x32_bf16 v[132:135], v[48:51], a[72:75], v[132:135]
    ds_read_b64_tr_b16 v[68:69], v72 offset:26624
    v_mfma_f32_16x16x32_bf16 v[132:135], v[52:55], a[76:79], v[132:135]
    v_mfma_f32_16x16x32_bf16 v[128:131], v[52:55], a[68:71], v[128:131]
    ds_read_b64_tr_b16 v[70:71], v72 offset:27648
    v_mfma_f32_16x16x32_bf16 v[128:131], v[48:51], a[64:67], v[128:131]
    s_waitcnt vmcnt(8) lgkmcnt(4)
    v_mfma_f32_16x16x32_bf16 v[128:131], v[56:59], a[96:99], v[128:131]
    ds_read_b64_tr_b16 v[40:41], v17 offset:34816
    v_mfma_f32_16x16x32_bf16 v[128:131], v[60:63], a[100:103], v[128:131]
    buffer_load_dwordx2 v[32:33], v20, s[48:51], s64 offen offset:0 sc1
    v_mfma_f32_16x16x32_bf16 v[132:135], v[60:63], a[108:111], v[132:135]
    ds_read_b64_tr_b16 v[42:43], v17 offset:35840
    v_mfma_f32_16x16x32_bf16 v[132:135], v[56:59], a[104:107], v[132:135]
    v_mfma_f32_16x16x32_bf16 v[192:195], v[56:59], a[112:115], v[192:195]
    ds_read_b64_tr_b16 v[44:45], v17 offset:43008
    v_mfma_f32_16x16x32_bf16 v[192:195], v[60:63], a[116:119], v[192:195]
    buffer_load_dwordx2 v[34:35], v20, s[48:51], s64 offen offset:128 sc1
    v_mfma_f32_16x16x32_bf16 v[196:199], v[60:63], a[124:127], v[196:199]
    ds_read_b64_tr_b16 v[46:47], v17 offset:44032
    v_mfma_f32_16x16x32_bf16 v[196:199], v[56:59], a[120:123], v[196:199]
    s_waitcnt vmcnt(2) lgkmcnt(4)
    v_mfma_f32_16x16x32_bf16 v[196:199], v[64:67], a[152:155], v[196:199]
    ds_read_b64_tr_b16 v[48:49], v17 offset:51200
    v_mfma_f32_16x16x32_bf16 v[196:199], v[68:71], a[156:159], v[196:199]
    buffer_load_dwordx2 v[36:37], v20, s[48:51], s64 offen offset:256 sc1
    v_mfma_f32_16x16x32_bf16 v[192:195], v[68:71], a[148:151], v[192:195]
    ds_read_b64_tr_b16 v[50:51], v17 offset:52224
    v_mfma_f32_16x16x32_bf16 v[192:195], v[64:67], a[144:147], v[192:195]
    v_mfma_f32_16x16x32_bf16 v[132:135], v[64:67], a[136:139], v[132:135]
    ds_read_b64_tr_b16 v[52:53], v17 offset:59392
    v_mfma_f32_16x16x32_bf16 v[132:135], v[68:71], a[140:143], v[132:135]
    buffer_load_dwordx2 v[38:39], v20, s[48:51], s64 offen offset:384 sc1
    v_mfma_f32_16x16x32_bf16 v[128:131], v[68:71], a[132:135], v[128:131]
    ds_read_b64_tr_b16 v[54:55], v17 offset:60416
    v_mfma_f32_16x16x32_bf16 v[128:131], v[64:67], a[128:131], v[128:131]
    s_waitcnt lgkmcnt(4)
    v_mfma_f32_16x16x32_bf16 v[136:139], v[40:43], a[0:3], v[136:139]
    ds_read_b64_tr_b16 v[56:57], v73 offset:2048
    v_mfma_f32_16x16x32_bf16 v[136:139], v[44:47], a[4:7], v[136:139]
    v_mfma_f32_16x16x32_bf16 v[140:143], v[44:47], a[12:15], v[140:143]
    ds_read_b64_tr_b16 v[58:59], v73 offset:3072
    v_mfma_f32_16x16x32_bf16 v[140:143], v[40:43], a[8:11], v[140:143]
    s_nop 0
    v_cvt_pk_bf16_f32 v128, v128, v129
    v_mfma_f32_16x16x32_bf16 v[200:203], v[40:43], a[16:19], v[200:203]
    ds_read_b64_tr_b16 v[60:61], v73 offset:10240
    v_cvt_pk_bf16_f32 v129, v130, v131
    v_mfma_f32_16x16x32_bf16 v[200:203], v[44:47], a[20:23], v[200:203]
    v_cvt_pk_bf16_f32 v130, v132, v133
    v_mfma_f32_16x16x32_bf16 v[204:207], v[44:47], a[28:31], v[204:207]
    ds_read_b64_tr_b16 v[62:63], v73 offset:11264
    v_cvt_pk_bf16_f32 v131, v134, v135
    v_mfma_f32_16x16x32_bf16 v[204:207], v[40:43], a[24:27], v[204:207]
    s_waitcnt lgkmcnt(4)
    v_mfma_f32_16x16x32_bf16 v[204:207], v[48:51], a[88:91], v[204:207]
    ds_read_b64_tr_b16 v[64:65], v73 offset:18432
    v_cvt_pk_bf16_f32 v192, v192, v193
    v_mfma_f32_16x16x32_bf16 v[204:207], v[52:55], a[92:95], v[204:207]
    buffer_store_dwordx4 v[128:131], v1, s[36:39], s0 offen offset:0 sc1
    v_mfma_f32_16x16x32_bf16 v[200:203], v[52:55], a[84:87], v[200:203]
    ds_read_b64_tr_b16 v[66:67], v73 offset:19456
    v_cvt_pk_bf16_f32 v193, v194, v195
    v_mfma_f32_16x16x32_bf16 v[200:203], v[48:51], a[80:83], v[200:203]
    v_cvt_pk_bf16_f32 v194, v196, v197
    v_mfma_f32_16x16x32_bf16 v[140:143], v[48:51], a[72:75], v[140:143]
    ds_read_b64_tr_b16 v[68:69], v73 offset:26624
    v_cvt_pk_bf16_f32 v195, v198, v199
    v_mfma_f32_16x16x32_bf16 v[140:143], v[52:55], a[76:79], v[140:143]
    v_mfma_f32_16x16x32_bf16 v[136:139], v[52:55], a[68:71], v[136:139]
    ds_read_b64_tr_b16 v[70:71], v73 offset:27648
    v_mfma_f32_16x16x32_bf16 v[136:139], v[48:51], a[64:67], v[136:139]
    s_waitcnt lgkmcnt(4)
    v_mfma_f32_16x16x32_bf16 v[136:139], v[56:59], a[96:99], v[136:139]
    ds_read_b64_tr_b16 v[40:41], v18 offset:34816
    v_mfma_f32_16x16x32_bf16 v[136:139], v[60:63], a[100:103], v[136:139]
    buffer_store_dwordx4 v[192:195], v1, s[36:39], s14 offen offset:0 sc1
    v_mfma_f32_16x16x32_bf16 v[140:143], v[60:63], a[108:111], v[140:143]
    ds_read_b64_tr_b16 v[42:43], v18 offset:35840
    v_mfma_f32_16x16x32_bf16 v[140:143], v[56:59], a[104:107], v[140:143]
    v_mfma_f32_16x16x32_bf16 v[200:203], v[56:59], a[112:115], v[200:203]
    ds_read_b64_tr_b16 v[44:45], v18 offset:43008
    v_mfma_f32_16x16x32_bf16 v[200:203], v[60:63], a[116:119], v[200:203]
    v_mfma_f32_16x16x32_bf16 v[204:207], v[60:63], a[124:127], v[204:207]
    ds_read_b64_tr_b16 v[46:47], v18 offset:44032
    v_mfma_f32_16x16x32_bf16 v[204:207], v[56:59], a[120:123], v[204:207]
    s_waitcnt lgkmcnt(4)
    v_mfma_f32_16x16x32_bf16 v[204:207], v[64:67], a[152:155], v[204:207]
    ds_read_b64_tr_b16 v[48:49], v18 offset:51200
    v_mfma_f32_16x16x32_bf16 v[204:207], v[68:71], a[156:159], v[204:207]
    v_mfma_f32_16x16x32_bf16 v[200:203], v[68:71], a[148:151], v[200:203]
    ds_read_b64_tr_b16 v[50:51], v18 offset:52224
    v_mfma_f32_16x16x32_bf16 v[200:203], v[64:67], a[144:147], v[200:203]
    v_mfma_f32_16x16x32_bf16 v[140:143], v[64:67], a[136:139], v[140:143]
    ds_read_b64_tr_b16 v[52:53], v18 offset:59392
    v_mfma_f32_16x16x32_bf16 v[140:143], v[68:71], a[140:143], v[140:143]
    v_mfma_f32_16x16x32_bf16 v[136:139], v[68:71], a[132:135], v[136:139]
    ds_read_b64_tr_b16 v[54:55], v18 offset:60416
    v_mfma_f32_16x16x32_bf16 v[136:139], v[64:67], a[128:131], v[136:139]
    s_waitcnt lgkmcnt(4)
    v_mfma_f32_16x16x32_bf16 v[144:147], v[40:43], a[0:3], v[144:147]
    ds_read_b64_tr_b16 v[56:57], v74 offset:2048
    v_mfma_f32_16x16x32_bf16 v[144:147], v[44:47], a[4:7], v[144:147]
    v_mfma_f32_16x16x32_bf16 v[148:151], v[44:47], a[12:15], v[148:151]
    ds_read_b64_tr_b16 v[58:59], v74 offset:3072
    v_mfma_f32_16x16x32_bf16 v[148:151], v[40:43], a[8:11], v[148:151]
    s_nop 0
    v_cvt_pk_bf16_f32 v136, v136, v137
    v_mfma_f32_16x16x32_bf16 v[208:211], v[40:43], a[16:19], v[208:211]
    ds_read_b64_tr_b16 v[60:61], v74 offset:10240
    v_cvt_pk_bf16_f32 v137, v138, v139
    v_mfma_f32_16x16x32_bf16 v[208:211], v[44:47], a[20:23], v[208:211]
    v_cvt_pk_bf16_f32 v138, v140, v141
    v_mfma_f32_16x16x32_bf16 v[212:215], v[44:47], a[28:31], v[212:215]
    ds_read_b64_tr_b16 v[62:63], v74 offset:11264
    v_cvt_pk_bf16_f32 v139, v142, v143
    v_mfma_f32_16x16x32_bf16 v[212:215], v[40:43], a[24:27], v[212:215]
    s_waitcnt lgkmcnt(4)
    v_mfma_f32_16x16x32_bf16 v[212:215], v[48:51], a[88:91], v[212:215]
    ds_read_b64_tr_b16 v[64:65], v74 offset:18432
    v_cvt_pk_bf16_f32 v200, v200, v201
    v_mfma_f32_16x16x32_bf16 v[212:215], v[52:55], a[92:95], v[212:215]
    buffer_store_dwordx4 v[136:139], v1, s[36:39], s0 offen offset:1024 sc1
    v_mfma_f32_16x16x32_bf16 v[208:211], v[52:55], a[84:87], v[208:211]
    ds_read_b64_tr_b16 v[66:67], v74 offset:19456
    v_cvt_pk_bf16_f32 v201, v202, v203
    v_mfma_f32_16x16x32_bf16 v[208:211], v[48:51], a[80:83], v[208:211]
    v_cvt_pk_bf16_f32 v202, v204, v205
    v_mfma_f32_16x16x32_bf16 v[148:151], v[48:51], a[72:75], v[148:151]
    ds_read_b64_tr_b16 v[68:69], v74 offset:26624
    v_cvt_pk_bf16_f32 v203, v206, v207
    v_mfma_f32_16x16x32_bf16 v[148:151], v[52:55], a[76:79], v[148:151]
    v_mfma_f32_16x16x32_bf16 v[144:147], v[52:55], a[68:71], v[144:147]
    ds_read_b64_tr_b16 v[70:71], v74 offset:27648
    v_mfma_f32_16x16x32_bf16 v[144:147], v[48:51], a[64:67], v[144:147]
    s_waitcnt lgkmcnt(4)
    v_mfma_f32_16x16x32_bf16 v[144:147], v[56:59], a[96:99], v[144:147]
    ds_read_b64_tr_b16 v[40:41], v19 offset:34816
    v_mfma_f32_16x16x32_bf16 v[144:147], v[60:63], a[100:103], v[144:147]
    buffer_store_dwordx4 v[200:203], v1, s[36:39], s14 offen offset:1024 sc1
    v_mfma_f32_16x16x32_bf16 v[148:151], v[60:63], a[108:111], v[148:151]
    ds_read_b64_tr_b16 v[42:43], v19 offset:35840
    v_mfma_f32_16x16x32_bf16 v[148:151], v[56:59], a[104:107], v[148:151]
    v_mfma_f32_16x16x32_bf16 v[208:211], v[56:59], a[112:115], v[208:211]
    ds_read_b64_tr_b16 v[44:45], v19 offset:43008
    v_mfma_f32_16x16x32_bf16 v[208:211], v[60:63], a[116:119], v[208:211]
    v_mfma_f32_16x16x32_bf16 v[212:215], v[60:63], a[124:127], v[212:215]
    ds_read_b64_tr_b16 v[46:47], v19 offset:44032
    v_mfma_f32_16x16x32_bf16 v[212:215], v[56:59], a[120:123], v[212:215]
    s_waitcnt lgkmcnt(4)
    v_mfma_f32_16x16x32_bf16 v[212:215], v[64:67], a[152:155], v[212:215]
    ds_read_b64_tr_b16 v[48:49], v19 offset:51200
    v_mfma_f32_16x16x32_bf16 v[212:215], v[68:71], a[156:159], v[212:215]
    v_mfma_f32_16x16x32_bf16 v[208:211], v[68:71], a[148:151], v[208:211]
    ds_read_b64_tr_b16 v[50:51], v19 offset:52224
    v_mfma_f32_16x16x32_bf16 v[208:211], v[64:67], a[144:147], v[208:211]
    v_mfma_f32_16x16x32_bf16 v[148:151], v[64:67], a[136:139], v[148:151]
    ds_read_b64_tr_b16 v[52:53], v19 offset:59392
    v_mfma_f32_16x16x32_bf16 v[148:151], v[68:71], a[140:143], v[148:151]
    v_mfma_f32_16x16x32_bf16 v[144:147], v[68:71], a[132:135], v[144:147]
    ds_read_b64_tr_b16 v[54:55], v19 offset:60416
    v_mfma_f32_16x16x32_bf16 v[144:147], v[64:67], a[128:131], v[144:147]
    s_waitcnt lgkmcnt(4)
    v_mfma_f32_16x16x32_bf16 v[152:155], v[40:43], a[0:3], v[152:155]
    ds_read_b64_tr_b16 v[56:57], v75 offset:2048
    v_mfma_f32_16x16x32_bf16 v[152:155], v[44:47], a[4:7], v[152:155]
    v_mfma_f32_16x16x32_bf16 v[156:159], v[44:47], a[12:15], v[156:159]
    ds_read_b64_tr_b16 v[58:59], v75 offset:3072
    v_mfma_f32_16x16x32_bf16 v[156:159], v[40:43], a[8:11], v[156:159]
    s_nop 0
    v_cvt_pk_bf16_f32 v144, v144, v145
    v_mfma_f32_16x16x32_bf16 v[216:219], v[40:43], a[16:19], v[216:219]
    ds_read_b64_tr_b16 v[60:61], v75 offset:10240
    v_cvt_pk_bf16_f32 v145, v146, v147
    v_mfma_f32_16x16x32_bf16 v[216:219], v[44:47], a[20:23], v[216:219]
    v_cvt_pk_bf16_f32 v146, v148, v149
    v_mfma_f32_16x16x32_bf16 v[220:223], v[44:47], a[28:31], v[220:223]
    ds_read_b64_tr_b16 v[62:63], v75 offset:11264
    v_cvt_pk_bf16_f32 v147, v150, v151
    v_mfma_f32_16x16x32_bf16 v[220:223], v[40:43], a[24:27], v[220:223]
    s_waitcnt lgkmcnt(4)
    v_mfma_f32_16x16x32_bf16 v[220:223], v[48:51], a[88:91], v[220:223]
    ds_read_b64_tr_b16 v[64:65], v75 offset:18432
    v_cvt_pk_bf16_f32 v208, v208, v209
    v_mfma_f32_16x16x32_bf16 v[220:223], v[52:55], a[92:95], v[220:223]
    buffer_store_dwordx4 v[144:147], v1, s[36:39], s0 offen offset:2048 sc1
    v_mfma_f32_16x16x32_bf16 v[216:219], v[52:55], a[84:87], v[216:219]
    ds_read_b64_tr_b16 v[66:67], v75 offset:19456
    v_cvt_pk_bf16_f32 v209, v210, v211
    v_mfma_f32_16x16x32_bf16 v[216:219], v[48:51], a[80:83], v[216:219]
    v_cvt_pk_bf16_f32 v210, v212, v213
    v_mfma_f32_16x16x32_bf16 v[156:159], v[48:51], a[72:75], v[156:159]
    ds_read_b64_tr_b16 v[68:69], v75 offset:26624
    v_cvt_pk_bf16_f32 v211, v214, v215
    v_mfma_f32_16x16x32_bf16 v[156:159], v[52:55], a[76:79], v[156:159]
    v_mfma_f32_16x16x32_bf16 v[152:155], v[52:55], a[68:71], v[152:155]
    ds_read_b64_tr_b16 v[70:71], v75 offset:27648
    v_mfma_f32_16x16x32_bf16 v[152:155], v[48:51], a[64:67], v[152:155]
    s_waitcnt lgkmcnt(4)
    v_mfma_f32_16x16x32_bf16 v[152:155], v[56:59], a[96:99], v[152:155]
    ds_read_b64_tr_b16 v[40:41], v16 offset:0
    v_mfma_f32_16x16x32_bf16 v[152:155], v[60:63], a[100:103], v[152:155]
    buffer_store_dwordx4 v[208:211], v1, s[36:39], s14 offen offset:2048 sc1
    v_mfma_f32_16x16x32_bf16 v[156:159], v[60:63], a[108:111], v[156:159]
    ds_read_b64_tr_b16 v[42:43], v16 offset:1024
    v_mfma_f32_16x16x32_bf16 v[156:159], v[56:59], a[104:107], v[156:159]
    v_mfma_f32_16x16x32_bf16 v[216:219], v[56:59], a[112:115], v[216:219]
    ds_read_b64_tr_b16 v[44:45], v16 offset:8192
    v_mfma_f32_16x16x32_bf16 v[216:219], v[60:63], a[116:119], v[216:219]
    v_mfma_f32_16x16x32_bf16 v[220:223], v[60:63], a[124:127], v[220:223]
    ds_read_b64_tr_b16 v[46:47], v16 offset:9216
    v_mfma_f32_16x16x32_bf16 v[220:223], v[56:59], a[120:123], v[220:223]
    s_waitcnt lgkmcnt(4)
    v_mfma_f32_16x16x32_bf16 v[220:223], v[64:67], a[152:155], v[220:223]
    ds_read_b64_tr_b16 v[48:49], v16 offset:16384
    v_mfma_f32_16x16x32_bf16 v[220:223], v[68:71], a[156:159], v[220:223]
    v_mfma_f32_16x16x32_bf16 v[216:219], v[68:71], a[148:151], v[216:219]
    ds_read_b64_tr_b16 v[50:51], v16 offset:17408
    v_mfma_f32_16x16x32_bf16 v[216:219], v[64:67], a[144:147], v[216:219]
    v_mfma_f32_16x16x32_bf16 v[156:159], v[64:67], a[136:139], v[156:159]
    ds_read_b64_tr_b16 v[52:53], v16 offset:24576
    v_mfma_f32_16x16x32_bf16 v[156:159], v[68:71], a[140:143], v[156:159]
    v_mfma_f32_16x16x32_bf16 v[152:155], v[68:71], a[132:135], v[152:155]
    ds_read_b64_tr_b16 v[54:55], v16 offset:25600
    v_mfma_f32_16x16x32_bf16 v[152:155], v[64:67], a[128:131], v[152:155]
    s_waitcnt lgkmcnt(4)
    v_mfma_f32_16x16x32_bf16 v[160:163], v[40:43], a[208:211], v[160:163]
    ds_read_b64_tr_b16 v[56:57], v16 offset:32768
    v_mfma_f32_16x16x32_bf16 v[160:163], v[44:47], a[212:215], v[160:163]
    ds_read_b64_tr_b16 v[58:59], v16 offset:33792
    v_mfma_f32_16x16x32_bf16 v[164:167], v[44:47], a[220:223], v[164:167]
    ds_read_b64_tr_b16 v[60:61], v16 offset:40960
    v_mfma_f32_16x16x32_bf16 v[164:167], v[40:43], a[216:219], v[164:167]
    ds_read_b64_tr_b16 v[62:63], v16 offset:41984
    s_waitcnt lgkmcnt(4)
    v_cvt_pk_bf16_f32 v152, v152, v153
    v_mfma_f32_16x16x32_bf16 v[164:167], v[48:51], a[56:59], v[164:167]
    ds_read_b64_tr_b16 v[64:65], v16 offset:49152
    v_cvt_pk_bf16_f32 v153, v154, v155
    v_mfma_f32_16x16x32_bf16 v[164:167], v[52:55], a[60:63], v[164:167]
    ds_read_b64_tr_b16 v[66:67], v16 offset:50176
    v_cvt_pk_bf16_f32 v154, v156, v157
    v_mfma_f32_16x16x32_bf16 v[160:163], v[52:55], a[52:55], v[160:163]
    ds_read_b64_tr_b16 v[68:69], v16 offset:57344
    v_cvt_pk_bf16_f32 v155, v158, v159
    v_mfma_f32_16x16x32_bf16 v[160:163], v[48:51], a[48:51], v[160:163]
    ds_read_b64_tr_b16 v[70:71], v16 offset:58368
    s_waitcnt lgkmcnt(4)
    v_mfma_f32_16x16x32_bf16 v[160:163], v[56:59], a[16:19], v[160:163]
    ds_read_b64_tr_b16 v[40:41], v72 offset:0
    v_cvt_pk_bf16_f32 v216, v216, v217
    v_mfma_f32_16x16x32_bf16 v[160:163], v[60:63], a[20:23], v[160:163]
    ds_read_b64_tr_b16 v[42:43], v72 offset:1024
    buffer_store_dwordx4 v[152:155], v1, s[36:39], s0 offen offset:3072 sc1
    v_mfma_f32_16x16x32_bf16 v[164:167], v[60:63], a[28:31], v[164:167]
    ds_read_b64_tr_b16 v[44:45], v72 offset:8192
    v_cvt_pk_bf16_f32 v217, v218, v219
    v_mfma_f32_16x16x32_bf16 v[164:167], v[56:59], a[24:27], v[164:167]
    ds_read_b64_tr_b16 v[46:47], v72 offset:9216
    s_waitcnt lgkmcnt(4)
    v_cvt_pk_bf16_f32 v218, v220, v221
    v_mfma_f32_16x16x32_bf16 v[164:167], v[64:67], a[88:91], v[164:167]
    ds_read_b64_tr_b16 v[48:49], v72 offset:16384
    v_cvt_pk_bf16_f32 v219, v222, v223
    v_mfma_f32_16x16x32_bf16 v[164:167], v[68:71], a[92:95], v[164:167]
    ds_read_b64_tr_b16 v[50:51], v72 offset:17408
    s_waitcnt vmcnt(3)
    buffer_store_dword v3, v2, s[48:51], s70 offen sc1
    v_mfma_f32_16x16x32_bf16 v[160:163], v[68:71], a[84:87], v[160:163]
    ds_read_b64_tr_b16 v[52:53], v72 offset:24576
    v_mfma_f32_16x16x32_bf16 v[160:163], v[64:67], a[80:83], v[160:163]
    ds_read_b64_tr_b16 v[54:55], v72 offset:25600
    s_waitcnt lgkmcnt(4)
    s_add_u32 s70, s70, 0x40000
    v_mfma_f32_16x16x32_bf16 v[160:163], v[40:43], a[112:115], v[160:163]
    ds_read_b64_tr_b16 v[56:57], v17 offset:0
    v_mfma_f32_16x16x32_bf16 v[160:163], v[44:47], a[116:119], v[160:163]
    ds_read_b64_tr_b16 v[58:59], v17 offset:1024
    buffer_store_dwordx4 v[216:219], v1, s[36:39], s14 offen offset:3072 sc1
    v_mfma_f32_16x16x32_bf16 v[164:167], v[44:47], a[124:127], v[164:167]
    ds_read_b64_tr_b16 v[60:61], v17 offset:8192
    v_mfma_f32_16x16x32_bf16 v[164:167], v[40:43], a[120:123], v[164:167]
    ds_read_b64_tr_b16 v[62:63], v17 offset:9216
    s_waitcnt lgkmcnt(4)
    v_mfma_f32_16x16x32_bf16 v[164:167], v[48:51], a[152:155], v[164:167]
    ds_read_b64_tr_b16 v[64:65], v17 offset:16384
    v_mfma_f32_16x16x32_bf16 v[164:167], v[52:55], a[156:159], v[164:167]
    ds_read_b64_tr_b16 v[66:67], v17 offset:17408
    v_mfma_f32_16x16x32_bf16 v[160:163], v[52:55], a[148:151], v[160:163]
    ds_read_b64_tr_b16 v[68:69], v17 offset:24576
    v_mfma_f32_16x16x32_bf16 v[160:163], v[48:51], a[144:147], v[160:163]
    ds_read_b64_tr_b16 v[70:71], v17 offset:25600
    s_waitcnt lgkmcnt(4)
    v_mfma_f32_16x16x32_bf16 v[168:171], v[56:59], a[208:211], v[168:171]
    ds_read_b64_tr_b16 v[40:41], v17 offset:32768
    v_mfma_f32_16x16x32_bf16 v[168:171], v[60:63], a[212:215], v[168:171]
    ds_read_b64_tr_b16 v[42:43], v17 offset:33792
    v_mfma_f32_16x16x32_bf16 v[172:175], v[60:63], a[220:223], v[172:175]
    ds_read_b64_tr_b16 v[44:45], v17 offset:40960
    v_mfma_f32_16x16x32_bf16 v[172:175], v[56:59], a[216:219], v[172:175]
    ds_read_b64_tr_b16 v[46:47], v17 offset:41984
    s_waitcnt lgkmcnt(4)
    v_cvt_pk_bf16_f32 v160, v160, v161
    v_mfma_f32_16x16x32_bf16 v[172:175], v[64:67], a[56:59], v[172:175]
    ds_read_b64_tr_b16 v[48:49], v17 offset:49152
    v_cvt_pk_bf16_f32 v161, v162, v163
    v_mfma_f32_16x16x32_bf16 v[172:175], v[68:71], a[60:63], v[172:175]
    ds_read_b64_tr_b16 v[50:51], v17 offset:50176
    v_cvt_pk_bf16_f32 v162, v164, v165
    v_mfma_f32_16x16x32_bf16 v[168:171], v[68:71], a[52:55], v[168:171]
    ds_read_b64_tr_b16 v[52:53], v17 offset:57344
    v_cvt_pk_bf16_f32 v163, v166, v167
    v_mfma_f32_16x16x32_bf16 v[168:171], v[64:67], a[48:51], v[168:171]
    ds_read_b64_tr_b16 v[54:55], v17 offset:58368
    s_waitcnt lgkmcnt(4)
    v_mfma_f32_16x16x32_bf16 v[168:171], v[40:43], a[16:19], v[168:171]
    ds_read_b64_tr_b16 v[56:57], v73 offset:0
    v_add_f32 v32, v32, v34
    v_mfma_f32_16x16x32_bf16 v[168:171], v[44:47], a[20:23], v[168:171]
    ds_read_b64_tr_b16 v[58:59], v73 offset:1024
    buffer_store_dwordx4 v[160:163], v1, s[36:39], s1 offen offset:0 sc1
    v_mfma_f32_16x16x32_bf16 v[172:175], v[44:47], a[28:31], v[172:175]
    ds_read_b64_tr_b16 v[60:61], v73 offset:8192
    v_add_f32 v36, v36, v38
    v_mfma_f32_16x16x32_bf16 v[172:175], v[40:43], a[24:27], v[172:175]
    ds_read_b64_tr_b16 v[62:63], v73 offset:9216
    s_waitcnt lgkmcnt(4)
    v_add_f32 v28, v32, v36
    v_mfma_f32_16x16x32_bf16 v[172:175], v[48:51], a[88:91], v[172:175]
    ds_read_b64_tr_b16 v[64:65], v73 offset:16384
    v_mov_b32 v4, v28
    v_mfma_f32_16x16x32_bf16 v[172:175], v[52:55], a[92:95], v[172:175]
    ds_read_b64_tr_b16 v[66:67], v73 offset:17408
    v_permlane16_swap_b32 v28, v4
    v_mfma_f32_16x16x32_bf16 v[168:171], v[52:55], a[84:87], v[168:171]
    ds_read_b64_tr_b16 v[68:69], v73 offset:24576
    v_add_f32 v28, v28, v4
    v_mfma_f32_16x16x32_bf16 v[168:171], v[48:51], a[80:83], v[168:171]
    ds_read_b64_tr_b16 v[70:71], v73 offset:25600
    s_waitcnt lgkmcnt(4)
    v_mov_b32 v4, v28
    v_mfma_f32_16x16x32_bf16 v[168:171], v[56:59], a[112:115], v[168:171]
    ds_read_b64_tr_b16 v[40:41], v18 offset:0
    v_permlane32_swap_b32 v28, v4
    v_mfma_f32_16x16x32_bf16 v[168:171], v[60:63], a[116:119], v[168:171]
    ds_read_b64_tr_b16 v[42:43], v18 offset:1024
    v_add_f32 v28, v28, v4
    v_mfma_f32_16x16x32_bf16 v[172:175], v[60:63], a[124:127], v[172:175]
    ds_read_b64_tr_b16 v[44:45], v18 offset:8192
    v_fma_f32 v28, v28, s57, v8
    v_mfma_f32_16x16x32_bf16 v[172:175], v[56:59], a[120:123], v[172:175]
    ds_read_b64_tr_b16 v[46:47], v18 offset:9216
    s_waitcnt lgkmcnt(4)
    v_rsq_f32 v28, v28
    v_mfma_f32_16x16x32_bf16 v[172:175], v[64:67], a[152:155], v[172:175]
    ds_read_b64_tr_b16 v[48:49], v18 offset:16384
    v_add_f32 v33, v33, v35
    v_mfma_f32_16x16x32_bf16 v[172:175], v[68:71], a[156:159], v[172:175]
    ds_read_b64_tr_b16 v[50:51], v18 offset:17408
    v_add_f32 v37, v37, v39
    v_mfma_f32_16x16x32_bf16 v[168:171], v[68:71], a[148:151], v[168:171]
    ds_read_b64_tr_b16 v[52:53], v18 offset:24576
    v_add_f32 v29, v33, v37
    v_mfma_f32_16x16x32_bf16 v[168:171], v[64:67], a[144:147], v[168:171]
    ds_read_b64_tr_b16 v[54:55], v18 offset:25600
    s_waitcnt lgkmcnt(4)
    v_mov_b32 v4, v29
    v_mfma_f32_16x16x32_bf16 v[176:179], v[40:43], a[208:211], v[176:179]
    ds_read_b64_tr_b16 v[56:57], v18 offset:32768
    v_permlane16_swap_b32 v29, v4
    v_mfma_f32_16x16x32_bf16 v[176:179], v[44:47], a[212:215], v[176:179]
    ds_read_b64_tr_b16 v[58:59], v18 offset:33792
    v_add_f32 v29, v29, v4
    v_mfma_f32_16x16x32_bf16 v[180:183], v[44:47], a[220:223], v[180:183]
    ds_read_b64_tr_b16 v[60:61], v18 offset:40960
    v_mov_b32 v4, v29
    v_mfma_f32_16x16x32_bf16 v[180:183], v[40:43], a[216:219], v[180:183]
    ds_read_b64_tr_b16 v[62:63], v18 offset:41984
    s_waitcnt lgkmcnt(4)
    v_permlane32_swap_b32 v29, v4
    v_mfma_f32_16x16x32_bf16 v[180:183], v[48:51], a[56:59], v[180:183]
    ds_read_b64_tr_b16 v[64:65], v18 offset:49152
    v_add_f32 v29, v29, v4
    v_mfma_f32_16x16x32_bf16 v[180:183], v[52:55], a[60:63], v[180:183]
    ds_read_b64_tr_b16 v[66:67], v18 offset:50176
    v_fma_f32 v29, v29, s57, v8
    v_mfma_f32_16x16x32_bf16 v[176:179], v[52:55], a[52:55], v[176:179]
    ds_read_b64_tr_b16 v[68:69], v18 offset:57344
    v_rsq_f32 v29, v29
    v_mfma_f32_16x16x32_bf16 v[176:179], v[48:51], a[48:51], v[176:179]
    ds_read_b64_tr_b16 v[70:71], v18 offset:58368
    s_waitcnt lgkmcnt(4)
    v_cvt_pk_bf16_f32 v168, v168, v169
    v_mfma_f32_16x16x32_bf16 v[176:179], v[56:59], a[16:19], v[176:179]
    ds_read_b64_tr_b16 v[40:41], v74 offset:0
    v_cvt_pk_bf16_f32 v169, v170, v171
    v_mfma_f32_16x16x32_bf16 v[176:179], v[60:63], a[20:23], v[176:179]
    ds_read_b64_tr_b16 v[42:43], v74 offset:1024
    v_cvt_pk_bf16_f32 v170, v172, v173
    v_mfma_f32_16x16x32_bf16 v[180:183], v[60:63], a[28:31], v[180:183]
    ds_read_b64_tr_b16 v[44:45], v74 offset:8192
    v_cvt_pk_bf16_f32 v171, v174, v175
    v_mfma_f32_16x16x32_bf16 v[180:183], v[56:59], a[24:27], v[180:183]
    ds_read_b64_tr_b16 v[46:47], v74 offset:9216
    s_waitcnt lgkmcnt(4)
    v_mfma_f32_16x16x32_bf16 v[180:183], v[64:67], a[88:91], v[180:183]
    ds_read_b64_tr_b16 v[48:49], v74 offset:16384
    v_mfma_f32_16x16x32_bf16 v[180:183], v[68:71], a[92:95], v[180:183]
    ds_read_b64_tr_b16 v[50:51], v74 offset:17408
    buffer_store_dwordx4 v[168:171], v1, s[36:39], s1 offen offset:1024 sc1
    v_mfma_f32_16x16x32_bf16 v[176:179], v[68:71], a[84:87], v[176:179]
    ds_read_b64_tr_b16 v[52:53], v74 offset:24576
    v_mfma_f32_16x16x32_bf16 v[176:179], v[64:67], a[80:83], v[176:179]
    ds_read_b64_tr_b16 v[54:55], v74 offset:25600
    s_waitcnt lgkmcnt(4)
    v_mfma_f32_16x16x32_bf16 v[176:179], v[40:43], a[112:115], v[176:179]
    ds_read_b64_tr_b16 v[56:57], v19 offset:0
    v_mfma_f32_16x16x32_bf16 v[176:179], v[44:47], a[116:119], v[176:179]
    ds_read_b64_tr_b16 v[58:59], v19 offset:1024
    v_mfma_f32_16x16x32_bf16 v[180:183], v[44:47], a[124:127], v[180:183]
    ds_read_b64_tr_b16 v[60:61], v19 offset:8192
    v_mfma_f32_16x16x32_bf16 v[180:183], v[40:43], a[120:123], v[180:183]
    ds_read_b64_tr_b16 v[62:63], v19 offset:9216
    s_waitcnt lgkmcnt(4)
    v_mfma_f32_16x16x32_bf16 v[180:183], v[48:51], a[152:155], v[180:183]
    ds_read_b64_tr_b16 v[64:65], v19 offset:16384
    v_mfma_f32_16x16x32_bf16 v[180:183], v[52:55], a[156:159], v[180:183]
    ds_read_b64_tr_b16 v[66:67], v19 offset:17408
    v_mfma_f32_16x16x32_bf16 v[176:179], v[52:55], a[148:151], v[176:179]
    ds_read_b64_tr_b16 v[68:69], v19 offset:24576
    v_mfma_f32_16x16x32_bf16 v[176:179], v[48:51], a[144:147], v[176:179]
    ds_read_b64_tr_b16 v[70:71], v19 offset:25600
    s_waitcnt lgkmcnt(4)
    v_mfma_f32_16x16x32_bf16 v[184:187], v[56:59], a[208:211], v[184:187]
    ds_read_b64_tr_b16 v[40:41], v19 offset:32768
    v_mfma_f32_16x16x32_bf16 v[184:187], v[60:63], a[212:215], v[184:187]
    ds_read_b64_tr_b16 v[42:43], v19 offset:33792
    v_mfma_f32_16x16x32_bf16 v[188:191], v[60:63], a[220:223], v[188:191]
    ds_read_b64_tr_b16 v[44:45], v19 offset:40960
    v_mfma_f32_16x16x32_bf16 v[188:191], v[56:59], a[216:219], v[188:191]
    ds_read_b64_tr_b16 v[46:47], v19 offset:41984
    s_waitcnt lgkmcnt(4)
    v_cvt_pk_bf16_f32 v176, v176, v177
    v_mfma_f32_16x16x32_bf16 v[188:191], v[64:67], a[56:59], v[188:191]
    ds_read_b64_tr_b16 v[48:49], v19 offset:49152
    v_cvt_pk_bf16_f32 v177, v178, v179
    v_mfma_f32_16x16x32_bf16 v[188:191], v[68:71], a[60:63], v[188:191]
    ds_read_b64_tr_b16 v[50:51], v19 offset:50176
    buffer_load_dword v25, v26, s[48:51], s71 offen sc1
    v_mfma_f32_16x16x32_bf16 v[184:187], v[68:71], a[52:55], v[184:187]
    ds_read_b64_tr_b16 v[52:53], v19 offset:57344
    v_cvt_pk_bf16_f32 v178, v180, v181
    v_mfma_f32_16x16x32_bf16 v[184:187], v[64:67], a[48:51], v[184:187]
    ds_read_b64_tr_b16 v[54:55], v19 offset:58368
    s_waitcnt lgkmcnt(4)
    v_cvt_pk_bf16_f32 v179, v182, v183
    v_mfma_f32_16x16x32_bf16 v[184:187], v[40:43], a[16:19], v[184:187]
    ds_read_b64_tr_b16 v[56:57], v75 offset:0
    v_mfma_f32_16x16x32_bf16 v[184:187], v[44:47], a[20:23], v[184:187]
    ds_read_b64_tr_b16 v[58:59], v75 offset:1024
    buffer_store_dwordx4 v[176:179], v1, s[36:39], s1 offen offset:2048 sc1
    v_mfma_f32_16x16x32_bf16 v[188:191], v[44:47], a[28:31], v[188:191]
    ds_read_b64_tr_b16 v[60:61], v75 offset:8192
    v_mfma_f32_16x16x32_bf16 v[188:191], v[40:43], a[24:27], v[188:191]
    ds_read_b64_tr_b16 v[62:63], v75 offset:9216
    s_waitcnt lgkmcnt(4)
    v_mfma_f32_16x16x32_bf16 v[188:191], v[48:51], a[88:91], v[188:191]
    ds_read_b64_tr_b16 v[64:65], v75 offset:16384
    v_mfma_f32_16x16x32_bf16 v[188:191], v[52:55], a[92:95], v[188:191]
    ds_read_b64_tr_b16 v[66:67], v75 offset:17408
    s_waitcnt vmcnt(4)
    buffer_store_dword v3, v2, s[48:51], s70 offen sc1
    v_mfma_f32_16x16x32_bf16 v[184:187], v[52:55], a[84:87], v[184:187]
    ds_read_b64_tr_b16 v[68:69], v75 offset:24576
    v_mfma_f32_16x16x32_bf16 v[184:187], v[48:51], a[80:83], v[184:187]
    ds_read_b64_tr_b16 v[70:71], v75 offset:25600
    s_waitcnt lgkmcnt(4)
    s_add_u32 s70, s70, 0x40000
    v_mfma_f32_16x16x32_bf16 v[184:187], v[56:59], a[112:115], v[184:187]
    ds_read_b64_tr_b16 v[40:41], v16 offset:0
    v_mfma_f32_16x16x32_bf16 v[184:187], v[60:63], a[116:119], v[184:187]
    ds_read_b64_tr_b16 v[42:43], v16 offset:1024
    v_mfma_f32_16x16x32_bf16 v[188:191], v[60:63], a[124:127], v[188:191]
    ds_read_b64_tr_b16 v[44:45], v16 offset:8192
    v_mfma_f32_16x16x32_bf16 v[188:191], v[56:59], a[120:123], v[188:191]
    ds_read_b64_tr_b16 v[46:47], v16 offset:9216
    s_waitcnt lgkmcnt(4)
    v_mfma_f32_16x16x32_bf16 v[188:191], v[64:67], a[152:155], v[188:191]
    ds_read_b64_tr_b16 v[48:49], v16 offset:16384
    v_mfma_f32_16x16x32_bf16 v[188:191], v[68:71], a[156:159], v[188:191]
    ds_read_b64_tr_b16 v[50:51], v16 offset:17408
    v_mfma_f32_16x16x32_bf16 v[184:187], v[68:71], a[148:151], v[184:187]
    ds_read_b64_tr_b16 v[52:53], v16 offset:24576
    v_mfma_f32_16x16x32_bf16 v[184:187], v[64:67], a[144:147], v[184:187]
    ds_read_b64_tr_b16 v[54:55], v16 offset:25600
    s_waitcnt lgkmcnt(4)
    v_mfma_f32_16x16x32_bf16 v[96:99], v[40:43], a[192:195], v[96:99]
    ds_read_b64_tr_b16 v[56:57], v16 offset:32768
    v_mfma_f32_16x16x32_bf16 v[96:99], v[44:47], a[196:199], v[96:99]
    ds_read_b64_tr_b16 v[58:59], v16 offset:33792
    v_mfma_f32_16x16x32_bf16 v[100:103], v[44:47], a[204:207], v[100:103]
    ds_read_b64_tr_b16 v[60:61], v16 offset:40960
    v_mfma_f32_16x16x32_bf16 v[100:103], v[40:43], a[200:203], v[100:103]
    ds_read_b64_tr_b16 v[62:63], v16 offset:41984
    s_waitcnt lgkmcnt(4)
    v_cvt_pk_bf16_f32 v184, v184, v185
    v_mfma_f32_16x16x32_bf16 v[100:103], v[48:51], a[40:43], v[100:103]
    ds_read_b64_tr_b16 v[64:65], v16 offset:49152
    v_cvt_pk_bf16_f32 v185, v186, v187
    v_mfma_f32_16x16x32_bf16 v[100:103], v[52:55], a[44:47], v[100:103]
    ds_read_b64_tr_b16 v[66:67], v16 offset:50176
    v_cvt_pk_bf16_f32 v186, v188, v189
    v_mfma_f32_16x16x32_bf16 v[96:99], v[52:55], a[36:39], v[96:99]
    ds_read_b64_tr_b16 v[68:69], v16 offset:57344
    v_cvt_pk_bf16_f32 v187, v190, v191
    v_mfma_f32_16x16x32_bf16 v[96:99], v[48:51], a[32:35], v[96:99]
    ds_read_b64_tr_b16 v[70:71], v16 offset:58368
    s_waitcnt lgkmcnt(4)
    v_mfma_f32_16x16x32_bf16 v[96:99], v[56:59], a[0:3], v[96:99]
    ds_read_b64_tr_b16 v[40:41], v72 offset:0
    v_mfma_f32_16x16x32_bf16 v[96:99], v[60:63], a[4:7], v[96:99]
    ds_read_b64_tr_b16 v[42:43], v72 offset:1024
    buffer_store_dwordx4 v[184:187], v1, s[36:39], s1 offen offset:3072 sc1
    v_mfma_f32_16x16x32_bf16 v[100:103], v[60:63], a[12:15], v[100:103]
    ds_read_b64_tr_b16 v[44:45], v72 offset:8192
    v_mfma_f32_16x16x32_bf16 v[100:103], v[56:59], a[8:11], v[100:103]
    ds_read_b64_tr_b16 v[46:47], v72 offset:9216
    s_waitcnt lgkmcnt(4)
    v_mfma_f32_16x16x32_bf16 v[100:103], v[64:67], a[72:75], v[100:103]
    ds_read_b64_tr_b16 v[48:49], v72 offset:16384
    v_mfma_f32_16x16x32_bf16 v[100:103], v[68:71], a[76:79], v[100:103]
    ds_read_b64_tr_b16 v[50:51], v72 offset:17408
    v_mfma_f32_16x16x32_bf16 v[96:99], v[68:71], a[68:71], v[96:99]
    ds_read_b64_tr_b16 v[52:53], v72 offset:24576
    v_mfma_f32_16x16x32_bf16 v[96:99], v[64:67], a[64:67], v[96:99]
    ds_read_b64_tr_b16 v[54:55], v72 offset:25600
    s_waitcnt lgkmcnt(4)
    v_mfma_f32_16x16x32_bf16 v[96:99], v[40:43], a[96:99], v[96:99]
    ds_read_b64_tr_b16 v[56:57], v17 offset:0
    v_mfma_f32_16x16x32_bf16 v[96:99], v[44:47], a[100:103], v[96:99]
    ds_read_b64_tr_b16 v[58:59], v17 offset:1024
    v_mfma_f32_16x16x32_bf16 v[100:103], v[44:47], a[108:111], v[100:103]
    ds_read_b64_tr_b16 v[60:61], v17 offset:8192
    v_mfma_f32_16x16x32_bf16 v[100:103], v[40:43], a[104:107], v[100:103]
    ds_read_b64_tr_b16 v[62:63], v17 offset:9216
    s_waitcnt lgkmcnt(4)
    v_mfma_f32_16x16x32_bf16 v[100:103], v[48:51], a[136:139], v[100:103]
    ds_read_b64_tr_b16 v[64:65], v17 offset:16384
    v_mfma_f32_16x16x32_bf16 v[100:103], v[52:55], a[140:143], v[100:103]
    ds_read_b64_tr_b16 v[66:67], v17 offset:17408
    v_mfma_f32_16x16x32_bf16 v[96:99], v[52:55], a[132:135], v[96:99]
    ds_read_b64_tr_b16 v[68:69], v17 offset:24576
    v_mfma_f32_16x16x32_bf16 v[96:99], v[48:51], a[128:131], v[96:99]
    ds_read_b64_tr_b16 v[70:71], v17 offset:25600
    s_waitcnt lgkmcnt(4)
    v_mfma_f32_16x16x32_bf16 v[104:107], v[56:59], a[192:195], v[104:107]
    ds_read_b64_tr_b16 v[40:41], v17 offset:32768
    v_mfma_f32_16x16x32_bf16 v[104:107], v[60:63], a[196:199], v[104:107]
    ds_read_b64_tr_b16 v[42:43], v17 offset:33792
    v_mfma_f32_16x16x32_bf16 v[108:111], v[60:63], a[204:207], v[108:111]
    ds_read_b64_tr_b16 v[44:45], v17 offset:40960
    v_mfma_f32_16x16x32_bf16 v[108:111], v[56:59], a[200:203], v[108:111]
    ds_read_b64_tr_b16 v[46:47], v17 offset:41984
    s_waitcnt lgkmcnt(4)
    s_waitcnt vmcnt(3)
    v_cmp_gt_u32 vcc, 1, v25
    s_nop 0
    s_cbranch_vccnz F_ypoll0
F_ypoll0_done:
    s_add_u32 s71, s71, 0x40000
    v_mfma_f32_16x16x32_bf16 v[108:111], v[64:67], a[40:43], v[108:111]
    ds_read_b64_tr_b16 v[48:49], v17 offset:49152
    v_mfma_f32_16x16x32_bf16 v[108:111], v[68:71], a[44:47], v[108:111]
    ds_read_b64_tr_b16 v[50:51], v17 offset:50176
    buffer_load_dwordx4 v[128:131], v1, s[36:39], s15 offen offset:0 sc1
    v_mfma_f32_16x16x32_bf16 v[104:107], v[68:71], a[36:39], v[104:107]
    ds_read_b64_tr_b16 v[52:53], v17 offset:57344
    v_mfma_f32_16x16x32_bf16 v[104:107], v[64:67], a[32:35], v[104:107]
    ds_read_b64_tr_b16 v[54:55], v17 offset:58368
    s_waitcnt lgkmcnt(4)
    v_mfma_f32_16x16x32_bf16 v[104:107], v[40:43], a[0:3], v[104:107]
    ds_read_b64_tr_b16 v[56:57], v73 offset:0
    v_mfma_f32_16x16x32_bf16 v[104:107], v[44:47], a[4:7], v[104:107]
    ds_read_b64_tr_b16 v[58:59], v73 offset:1024
    buffer_load_dwordx4 v[192:195], v1, s[36:39], s75 offen offset:0 sc1
    v_mfma_f32_16x16x32_bf16 v[108:111], v[44:47], a[12:15], v[108:111]
    ds_read_b64_tr_b16 v[60:61], v73 offset:8192
    v_mfma_f32_16x16x32_bf16 v[108:111], v[40:43], a[8:11], v[108:111]
    ds_read_b64_tr_b16 v[62:63], v73 offset:9216
    s_waitcnt lgkmcnt(4)
    v_mfma_f32_16x16x32_bf16 v[108:111], v[48:51], a[72:75], v[108:111]
    ds_read_b64_tr_b16 v[64:65], v73 offset:16384
    v_mfma_f32_16x16x32_bf16 v[108:111], v[52:55], a[76:79], v[108:111]
    ds_read_b64_tr_b16 v[66:67], v73 offset:17408
    buffer_load_dwordx4 v[136:139], v1, s[36:39], s15 offen offset:1024 sc1
    v_mfma_f32_16x16x32_bf16 v[104:107], v[52:55], a[68:71], v[104:107]
    ds_read_b64_tr_b16 v[68:69], v73 offset:24576
    v_mfma_f32_16x16x32_bf16 v[104:107], v[48:51], a[64:67], v[104:107]
    ds_read_b64_tr_b16 v[70:71], v73 offset:25600
    s_waitcnt lgkmcnt(4)
    v_mfma_f32_16x16x32_bf16 v[104:107], v[56:59], a[96:99], v[104:107]
    ds_read_b64_tr_b16 v[40:41], v18 offset:0
    v_mfma_f32_16x16x32_bf16 v[104:107], v[60:63], a[100:103], v[104:107]
    ds_read_b64_tr_b16 v[42:43], v18 offset:1024
    buffer_load_dwordx4 v[200:203], v1, s[36:39], s75 offen offset:1024 sc1
    v_mfma_f32_16x16x32_bf16 v[108:111], v[60:63], a[108:111], v[108:111]
    ds_read_b64_tr_b16 v[44:45], v18 offset:8192
    v_mfma_f32_16x16x32_bf16 v[108:111], v[56:59], a[104:107], v[108:111]
    ds_read_b64_tr_b16 v[46:47], v18 offset:9216
    s_waitcnt lgkmcnt(4)
    v_mfma_f32_16x16x32_bf16 v[108:111], v[64:67], a[136:139], v[108:111]
    ds_read_b64_tr_b16 v[48:49], v18 offset:16384
    v_mfma_f32_16x16x32_bf16 v[108:111], v[68:71], a[140:143], v[108:111]
    ds_read_b64_tr_b16 v[50:51], v18 offset:17408
    v_mfma_f32_16x16x32_bf16 v[104:107], v[68:71], a[132:135], v[104:107]
    ds_read_b64_tr_b16 v[52:53], v18 offset:24576
    v_mfma_f32_16x16x32_bf16 v[104:107], v[64:67], a[128:131], v[104:107]
    ds_read_b64_tr_b16 v[54:55], v18 offset:25600
    s_waitcnt lgkmcnt(4)
    v_mfma_f32_16x16x32_bf16 v[112:115], v[40:43], a[192:195], v[112:115]
    ds_read_b64_tr_b16 v[56:57], v18 offset:32768
    v_mfma_f32_16x16x32_bf16 v[112:115], v[44:47], a[196:199], v[112:115]
    ds_read_b64_tr_b16 v[58:59], v18 offset:33792
    buffer_load_dword v25, v26, s[48:51], s71 offen sc1
    v_mfma_f32_16x16x32_bf16 v[116:119], v[44:47], a[204:207], v[116:119]
    ds_read_b64_tr_b16 v[60:61], v18 offset:40960
    v_mfma_f32_16x16x32_bf16 v[116:119], v[40:43], a[200:203], v[116:119]
    ds_read_b64_tr_b16 v[62:63], v18 offset:41984
    s_waitcnt lgkmcnt(4)
    v_mfma_f32_16x16x32_bf16 v[116:119], v[48:51], a[40:43], v[116:119]
    ds_read_b64_tr_b16 v[64:65], v18 offset:49152
    v_mfma_f32_16x16x32_bf16 v[116:119], v[52:55], a[44:47], v[116:119]
    ds_read_b64_tr_b16 v[66:67], v18 offset:50176
    v_mfma_f32_16x16x32_bf16 v[112:115], v[52:55], a[36:39], v[112:115]
    ds_read_b64_tr_b16 v[68:69], v18 offset:57344
    v_mfma_f32_16x16x32_bf16 v[112:115], v[48:51], a[32:35], v[112:115]
    ds_read_b64_tr_b16 v[70:71], v18 offset:58368
    s_waitcnt lgkmcnt(4)
    v_mfma_f32_16x16x32_bf16 v[112:115], v[56:59], a[0:3], v[112:115]
    ds_read_b64_tr_b16 v[40:41], v74 offset:0
    v_mfma_f32_16x16x32_bf16 v[112:115], v[60:63], a[4:7], v[112:115]
    ds_read_b64_tr_b16 v[42:43], v74 offset:1024
    v_mfma_f32_16x16x32_bf16 v[116:119], v[60:63], a[12:15], v[116:119]
    ds_read_b64_tr_b16 v[44:45], v74 offset:8192
    v_mfma_f32_16x16x32_bf16 v[116:119], v[56:59], a[8:11], v[116:119]
    ds_read_b64_tr_b16 v[46:47], v74 offset:9216
    s_waitcnt lgkmcnt(4)
    v_mfma_f32_16x16x32_bf16 v[116:119], v[64:67], a[72:75], v[116:119]
    ds_read_b64_tr_b16 v[48:49], v74 offset:16384
    v_mfma_f32_16x16x32_bf16 v[116:119], v[68:71], a[76:79], v[116:119]
    ds_read_b64_tr_b16 v[50:51], v74 offset:17408
    v_mfma_f32_16x16x32_bf16 v[112:115], v[68:71], a[68:71], v[112:115]
    ds_read_b64_tr_b16 v[52:53], v74 offset:24576
    v_mfma_f32_16x16x32_bf16 v[112:115], v[64:67], a[64:67], v[112:115]
    ds_read_b64_tr_b16 v[54:55], v74 offset:25600
    s_waitcnt lgkmcnt(4)
    v_mfma_f32_16x16x32_bf16 v[112:115], v[40:43], a[96:99], v[112:115]
    ds_read_b64_tr_b16 v[56:57], v19 offset:0
    v_mfma_f32_16x16x32_bf16 v[112:115], v[44:47], a[100:103], v[112:115]
    ds_read_b64_tr_b16 v[58:59], v19 offset:1024
    v_mfma_f32_16x16x32_bf16 v[116:119], v[44:47], a[108:111], v[116:119]
    ds_read_b64_tr_b16 v[60:61], v19 offset:8192
    v_mfma_f32_16x16x32_bf16 v[116:119], v[40:43], a[104:107], v[116:119]
    ds_read_b64_tr_b16 v[62:63], v19 offset:9216
    s_waitcnt lgkmcnt(4)
    v_mfma_f32_16x16x32_bf16 v[116:119], v[48:51], a[136:139], v[116:119]
    ds_read_b64_tr_b16 v[64:65], v19 offset:16384
    v_mfma_f32_16x16x32_bf16 v[116:119], v[52:55], a[140:143], v[116:119]
    ds_read_b64_tr_b16 v[66:67], v19 offset:17408
    v_mfma_f32_16x16x32_bf16 v[112:115], v[52:55], a[132:135], v[112:115]
    ds_read_b64_tr_b16 v[68:69], v19 offset:24576
    v_mfma_f32_16x16x32_bf16 v[112:115], v[48:51], a[128:131], v[112:115]
    ds_read_b64_tr_b16 v[70:71], v19 offset:25600
    s_waitcnt lgkmcnt(4)
    v_mfma_f32_16x16x32_bf16 v[120:123], v[56:59], a[192:195], v[120:123]
    ds_read_b64_tr_b16 v[40:41], v19 offset:32768
    v_mfma_f32_16x16x32_bf16 v[120:123], v[60:63], a[196:199], v[120:123]
    ds_read_b64_tr_b16 v[42:43], v19 offset:33792
    s_waitcnt vmcnt(5)
    buffer_store_dword v3, v2, s[48:51], s67 offen sc1
    v_mfma_f32_16x16x32_bf16 v[124:127], v[60:63], a[204:207], v[124:127]
    ds_read_b64_tr_b16 v[44:45], v19 offset:40960
    v_mfma_f32_16x16x32_bf16 v[124:127], v[56:59], a[200:203], v[124:127]
    ds_read_b64_tr_b16 v[46:47], v19 offset:41984
    s_waitcnt lgkmcnt(4)
    s_xor_b32 s67, s67, 32768
    v_mfma_f32_16x16x32_bf16 v[124:127], v[64:67], a[40:43], v[124:127]
    ds_read_b64_tr_b16 v[48:49], v19 offset:49152
    v_mfma_f32_16x16x32_bf16 v[124:127], v[68:71], a[44:47], v[124:127]
    ds_read_b64_tr_b16 v[50:51], v19 offset:50176
    v_mfma_f32_16x16x32_bf16 v[120:123], v[68:71], a[36:39], v[120:123]
    ds_read_b64_tr_b16 v[52:53], v19 offset:57344
    v_mfma_f32_16x16x32_bf16 v[120:123], v[64:67], a[32:35], v[120:123]
    ds_read_b64_tr_b16 v[54:55], v19 offset:58368
    s_waitcnt lgkmcnt(4)
    s_waitcnt vmcnt(1)
    v_cmp_gt_u32 vcc, 1, v25
    s_nop 0
    s_cbranch_vccnz F_ypoll1
F_ypoll1_done:
    s_add_u32 s71, s71, 0x40000
    v_mfma_f32_16x16x32_bf16 v[120:123], v[40:43], a[0:3], v[120:123]
    ds_read_b64_tr_b16 v[56:57], v75 offset:0
    v_mfma_f32_16x16x32_bf16 v[120:123], v[44:47], a[4:7], v[120:123]
    ds_read_b64_tr_b16 v[58:59], v75 offset:1024
    buffer_load_dwordx4 v[144:147], v1, s[36:39], s15 offen offset:2048 sc1
    v_mfma_f32_16x16x32_bf16 v[124:127], v[44:47], a[12:15], v[124:127]
    ds_read_b64_tr_b16 v[60:61], v75 offset:8192
    v_mfma_f32_16x16x32_bf16 v[124:127], v[40:43], a[8:11], v[124:127]
    ds_read_b64_tr_b16 v[62:63], v75 offset:9216
    s_waitcnt lgkmcnt(4)
    v_mfma_f32_16x16x32_bf16 v[124:127], v[48:51], a[72:75], v[124:127]
    ds_read_b64_tr_b16 v[64:65], v75 offset:16384
    v_mfma_f32_16x16x32_bf16 v[124:127], v[52:55], a[76:79], v[124:127]
    ds_read_b64_tr_b16 v[66:67], v75 offset:17408
    buffer_load_dwordx4 v[208:211], v1, s[36:39], s75 offen offset:2048 sc1
    v_mfma_f32_16x16x32_bf16 v[120:123], v[52:55], a[68:71], v[120:123]
    ds_read_b64_tr_b16 v[68:69], v75 offset:24576
    v_mfma_f32_16x16x32_bf16 v[120:123], v[48:51], a[64:67], v[120:123]
    ds_read_b64_tr_b16 v[70:71], v75 offset:25600
    s_waitcnt lgkmcnt(4)
    v_mfma_f32_16x16x32_bf16 v[120:123], v[56:59], a[96:99], v[120:123]
    v_mfma_f32_16x16x32_bf16 v[120:123], v[60:63], a[100:103], v[120:123]
    buffer_load_dwordx4 v[152:155], v1, s[36:39], s15 offen offset:3072 sc1
    v_mfma_f32_16x16x32_bf16 v[124:127], v[60:63], a[108:111], v[124:127]
    v_mfma_f32_16x16x32_bf16 v[124:127], v[56:59], a[104:107], v[124:127]
    s_waitcnt lgkmcnt(0)
    v_mfma_f32_16x16x32_bf16 v[124:127], v[64:67], a[136:139], v[124:127]
    v_mfma_f32_16x16x32_bf16 v[124:127], v[68:71], a[140:143], v[124:127]
    buffer_load_dwordx4 v[216:219], v1, s[36:39], s75 offen offset:3072 sc1
    v_mfma_f32_16x16x32_bf16 v[120:123], v[68:71], a[132:135], v[120:123]
    v_mfma_f32_16x16x32_bf16 v[120:123], v[64:67], a[128:131], v[120:123]
    v_mov_b32 v5, 0
    buffer_load_dword v25, v5, s[48:51], s67 offen sc1
    v_pk_fma_f32 v[224:225], v[96:97], v[28:29], v[224:225] op_sel_hi:[1,0,1]
    v_pk_fma_f32 v[226:227], v[98:99], v[28:29], v[226:227] op_sel_hi:[1,0,1]
    v_pk_fma_f32 v[228:229], v[100:101], v[28:29], v[228:229] op_sel:[0,1,0]
    v_pk_fma_f32 v[230:231], v[102:103], v[28:29], v[230:231] op_sel:[0,1,0]
    v_pk_fma_f32 v[232:233], v[104:105], v[28:29], v[232:233] op_sel_hi:[1,0,1]
    v_pk_fma_f32 v[234:235], v[106:107], v[28:29], v[234:235] op_sel_hi:[1,0,1]
    v_pk_fma_f32 v[236:237], v[108:109], v[28:29], v[236:237] op_sel:[0,1,0]
    v_pk_fma_f32 v[238:239], v[110:111], v[28:29], v[238:239] op_sel:[0,1,0]
    v_pk_fma_f32 v[240:241], v[112:113], v[28:29], v[240:241] op_sel_hi:[1,0,1]
    v_pk_fma_f32 v[242:243], v[114:115], v[28:29], v[242:243] op_sel_hi:[1,0,1]
    v_pk_fma_f32 v[244:245], v[116:117], v[28:29], v[244:245] op_sel:[0,1,0]
    v_pk_fma_f32 v[246:247], v[118:119], v[28:29], v[246:247] op_sel:[0,1,0]
    v_pk_fma_f32 v[248:249], v[120:121], v[28:29], v[248:249] op_sel_hi:[1,0,1]
    v_pk_fma_f32 v[250:251], v[122:123], v[28:29], v[250:251] op_sel_hi:[1,0,1]
    v_pk_fma_f32 v[252:253], v[124:125], v[28:29], v[252:253] op_sel:[0,1,0]
    v_pk_fma_f32 v[254:255], v[126:127], v[28:29], v[254:255] op_sel:[0,1,0]
    v_lshlrev_b32 v48, 16, v128
    v_and_b32 v49, 0xffff0000, v128
    v_pk_fma_f32 v[224:225], v[48:49], v[28:29], v[224:225] op_sel_hi:[1,0,1]
    v_lshlrev_b32 v50, 16, v129
    v_and_b32 v51, 0xffff0000, v129
    v_pk_fma_f32 v[226:227], v[50:51], v[28:29], v[226:227] op_sel_hi:[1,0,1]
    v_lshlrev_b32 v52, 16, v130
    v_and_b32 v53, 0xffff0000, v130
    v_pk_fma_f32 v[228:229], v[52:53], v[28:29], v[228:229] op_sel:[0,1,0]
    v_lshlrev_b32 v54, 16, v131
    v_and_b32 v55, 0xffff0000, v131
    v_pk_fma_f32 v[230:231], v[54:55], v[28:29], v[230:231] op_sel:[0,1,0]
    v_lshlrev_b32 v48, 16, v192
    v_and_b32 v49, 0xffff0000, v192
    v_pk_fma_f32 v[224:225], v[48:49], v[28:29], v[224:225] op_sel_hi:[1,0,1]
    v_lshlrev_b32 v50, 16, v193
    v_and_b32 v51, 0xffff0000, v193
    v_pk_fma_f32 v[226:227], v[50:51], v[28:29], v[226:227] op_sel_hi:[1,0,1]
    v_lshlrev_b32 v52, 16, v194
    v_and_b32 v53, 0xffff0000, v194
    v_pk_fma_f32 v[228:229], v[52:53], v[28:29], v[228:229] op_sel:[0,1,0]
    v_lshlrev_b32 v54, 16, v195
    v_and_b32 v55, 0xffff0000, v195
    v_pk_fma_f32 v[230:231], v[54:55], v[28:29], v[230:231] op_sel:[0,1,0]
    v_lshlrev_b32 v48, 16, v136
    v_and_b32 v49, 0xffff0000, v136
    v_pk_fma_f32 v[232:233], v[48:49], v[28:29], v[232:233] op_sel_hi:[1,0,1]
    v_lshlrev_b32 v50, 16, v137
    v_and_b32 v51, 0xffff0000, v137
    v_pk_fma_f32 v[234:235], v[50:51], v[28:29], v[234:235] op_sel_hi:[1,0,1]
    v_lshlrev_b32 v52, 16, v138
    v_and_b32 v53, 0xffff0000, v138
    v_pk_fma_f32 v[236:237], v[52:53], v[28:29], v[236:237] op_sel:[0,1,0]
    v_lshlrev_b32 v54, 16, v139
    v_and_b32 v55, 0xffff0000, v139
    v_pk_fma_f32 v[238:239], v[54:55], v[28:29], v[238:239] op_sel:[0,1,0]
    v_lshlrev_b32 v48, 16, v200
    v_and_b32 v49, 0xffff0000, v200
    v_pk_fma_f32 v[232:233], v[48:49], v[28:29], v[232:233] op_sel_hi:[1,0,1]
    v_lshlrev_b32 v50, 16, v201
    v_and_b32 v51, 0xffff0000, v201
    v_pk_fma_f32 v[234:235], v[50:51], v[28:29], v[234:235] op_sel_hi:[1,0,1]
    v_lshlrev_b32 v52, 16, v202
    v_and_b32 v53, 0xffff0000, v202
    v_pk_fma_f32 v[236:237], v[52:53], v[28:29], v[236:237] op_sel:[0,1,0]
    v_lshlrev_b32 v54, 16, v203
    v_and_b32 v55, 0xffff0000, v203
    v_pk_fma_f32 v[238:239], v[54:55], v[28:29], v[238:239] op_sel:[0,1,0]
    s_waitcnt vmcnt(0)
    v_cmp_gt_u32 vcc, 1, v25
    s_nop 0
    s_cbranch_vccnz F_xpoll
F_xpoll_done:
    buffer_load_dwordx4 v[160:163], v1, s[36:39], s74 offen offset:0 sc1
    buffer_load_dwordx4 v[168:171], v1, s[36:39], s74 offen offset:1024 sc1
    buffer_load_dwordx4 v[176:179], v1, s[36:39], s74 offen offset:2048 sc1
    buffer_load_dwordx4 v[184:187], v1, s[36:39], s74 offen offset:3072 sc1
    v_lshlrev_b32 v48, 16, v144
    v_and_b32 v49, 0xffff0000, v144
    v_pk_fma_f32 v[240:241], v[48:49], v[28:29], v[240:241] op_sel_hi:[1,0,1]
    v_lshlrev_b32 v50, 16, v145
    v_and_b32 v51, 0xffff0000, v145
    v_pk_fma_f32 v[242:243], v[50:51], v[28:29], v[242:243] op_sel_hi:[1,0,1]
    v_lshlrev_b32 v52, 16, v146
    v_and_b32 v53, 0xffff0000, v146
    v_pk_fma_f32 v[244:245], v[52:53], v[28:29], v[244:245] op_sel:[0,1,0]
    v_lshlrev_b32 v54, 16, v147
    v_and_b32 v55, 0xffff0000, v147
    v_pk_fma_f32 v[246:247], v[54:55], v[28:29], v[246:247] op_sel:[0,1,0]
    v_lshlrev_b32 v48, 16, v208
    v_and_b32 v49, 0xffff0000, v208
    v_pk_fma_f32 v[240:241], v[48:49], v[28:29], v[240:241] op_sel_hi:[1,0,1]
    v_lshlrev_b32 v50, 16, v209
    v_and_b32 v51, 0xffff0000, v209
    v_pk_fma_f32 v[242:243], v[50:51], v[28:29], v[242:243] op_sel_hi:[1,0,1]
    v_lshlrev_b32 v52, 16, v210
    v_and_b32 v53, 0xffff0000, v210
    v_pk_fma_f32 v[244:245], v[52:53], v[28:29], v[244:245] op_sel:[0,1,0]
    v_lshlrev_b32 v54, 16, v211
    v_and_b32 v55, 0xffff0000, v211
    v_pk_fma_f32 v[246:247], v[54:55], v[28:29], v[246:247] op_sel:[0,1,0]
    v_lshlrev_b32 v48, 16, v152
    v_and_b32 v49, 0xffff0000, v152
    v_pk_fma_f32 v[248:249], v[48:49], v[28:29], v[248:249] op_sel_hi:[1,0,1]
    v_lshlrev_b32 v50, 16, v153
    v_and_b32 v51, 0xffff0000, v153
    v_pk_fma_f32 v[250:251], v[50:51], v[28:29], v[250:251] op_sel_hi:[1,0,1]
    v_lshlrev_b32 v52, 16, v154
    v_and_b32 v53, 0xffff0000, v154
    v_pk_fma_f32 v[252:253], v[52:53], v[28:29], v[252:253] op_sel:[0,1,0]
    v_lshlrev_b32 v54, 16, v155
    v_and_b32 v55, 0xffff0000, v155
    v_pk_fma_f32 v[254:255], v[54:55], v[28:29], v[254:255] op_sel:[0,1,0]
    v_lshlrev_b32 v48, 16, v216
    v_and_b32 v49, 0xffff0000, v216
    v_pk_fma_f32 v[248:249], v[48:49], v[28:29], v[248:249] op_sel_hi:[1,0,1]
    v_lshlrev_b32 v50, 16, v217
    v_and_b32 v51, 0xffff0000, v217
    v_pk_fma_f32 v[250:251], v[50:51], v[28:29], v[250:251] op_sel_hi:[1,0,1]
    v_lshlrev_b32 v52, 16, v218
    v_and_b32 v53, 0xffff0000, v218
    v_pk_fma_f32 v[252:253], v[52:53], v[28:29], v[252:253] op_sel:[0,1,0]
    v_lshlrev_b32 v54, 16, v219
    v_and_b32 v55, 0xffff0000, v219
    v_pk_fma_f32 v[254:255], v[54:55], v[28:29], v[254:255] op_sel:[0,1,0]
    s_waitcnt vmcnt(3)
    v_lshlrev_b32 v40, 16, v160
    v_and_b32 v41, 0xffff0000, v160
    v_pk_fma_f32 v[224:225], v[40:41], v[28:29], v[224:225] op_sel_hi:[1,0,1]
    v_lshlrev_b32 v42, 16, v161
    v_and_b32 v43, 0xffff0000, v161
    v_pk_fma_f32 v[226:227], v[42:43], v[28:29], v[226:227] op_sel_hi:[1,0,1]
    v_lshlrev_b32 v44, 16, v162
    v_and_b32 v45, 0xffff0000, v162
    v_pk_fma_f32 v[228:229], v[44:45], v[28:29], v[228:229] op_sel:[0,1,0]
    v_lshlrev_b32 v46, 16, v163
    v_and_b32 v47, 0xffff0000, v163
    v_pk_fma_f32 v[230:231], v[46:47], v[28:29], v[230:231] op_sel:[0,1,0]
    v_cvt_pk_bf16_f32 v224, v224, v225
    v_cvt_pk_bf16_f32 v225, v226, v227
    ds_write_b64 v30, v[224:225] offset:0
    v_cvt_pk_bf16_f32 v228, v228, v229
    v_cvt_pk_bf16_f32 v229, v230, v231
    ds_write_b64 v30, v[228:229] offset:2304
    s_waitcnt vmcnt(2)
    v_lshlrev_b32 v40, 16, v168
    v_and_b32 v41, 0xffff0000, v168
    v_pk_fma_f32 v[232:233], v[40:41], v[28:29], v[232:233] op_sel_hi:[1,0,1]
    v_lshlrev_b32 v42, 16, v169
    v_and_b32 v43, 0xffff0000, v169
    v_pk_fma_f32 v[234:235], v[42:43], v[28:29], v[234:235] op_sel_hi:[1,0,1]
    v_lshlrev_b32 v44, 16, v170
    v_and_b32 v45, 0xffff0000, v170
    v_pk_fma_f32 v[236:237], v[44:45], v[28:29], v[236:237] op_sel:[0,1,0]
    v_lshlrev_b32 v46, 16, v171
    v_and_b32 v47, 0xffff0000, v171
    v_pk_fma_f32 v[238:239], v[46:47], v[28:29], v[238:239] op_sel:[0,1,0]
    v_cvt_pk_bf16_f32 v232, v232, v233
    v_cvt_pk_bf16_f32 v233, v234, v235
    ds_write_b64 v30, v[232:233] offset:32
    v_cvt_pk_bf16_f32 v236, v236, v237
    v_cvt_pk_bf16_f32 v237, v238, v239
    ds_write_b64 v30, v[236:237] offset:2336
    s_waitcnt vmcnt(1)
    v_lshlrev_b32 v40, 16, v176
    v_and_b32 v41, 0xffff0000, v176
    v_pk_fma_f32 v[240:241], v[40:41], v[28:29], v[240:241] op_sel_hi:[1,0,1]
    v_lshlrev_b32 v42, 16, v177
    v_and_b32 v43, 0xffff0000, v177
    v_pk_fma_f32 v[242:243], v[42:43], v[28:29], v[242:243] op_sel_hi:[1,0,1]
    v_lshlrev_b32 v44, 16, v178
    v_and_b32 v45, 0xffff0000, v178
    v_pk_fma_f32 v[244:245], v[44:45], v[28:29], v[244:245] op_sel:[0,1,0]
    v_lshlrev_b32 v46, 16, v179
    v_and_b32 v47, 0xffff0000, v179
    v_pk_fma_f32 v[246:247], v[46:47], v[28:29], v[246:247] op_sel:[0,1,0]
    v_cvt_pk_bf16_f32 v240, v240, v241
    v_cvt_pk_bf16_f32 v241, v242, v243
    ds_write_b64 v30, v[240:241] offset:64
    v_cvt_pk_bf16_f32 v244, v244, v245
    v_cvt_pk_bf16_f32 v245, v246, v247
    ds_write_b64 v30, v[244:245] offset:2368
    s_waitcnt vmcnt(0)
    v_lshlrev_b32 v40, 16, v184
    v_and_b32 v41, 0xffff0000, v184
    v_pk_fma_f32 v[248:249], v[40:41], v[28:29], v[248:249] op_sel_hi:[1,0,1]
    v_lshlrev_b32 v42, 16, v185
    v_and_b32 v43, 0xffff0000, v185
    v_pk_fma_f32 v[250:251], v[42:43], v[28:29], v[250:251] op_sel_hi:[1,0,1]
    v_lshlrev_b32 v44, 16, v186
    v_and_b32 v45, 0xffff0000, v186
    v_pk_fma_f32 v[252:253], v[44:45], v[28:29], v[252:253] op_sel:[0,1,0]
    v_lshlrev_b32 v46, 16, v187
    v_and_b32 v47, 0xffff0000, v187
    v_pk_fma_f32 v[254:255], v[46:47], v[28:29], v[254:255] op_sel:[0,1,0]
    v_cvt_pk_bf16_f32 v248, v248, v249
    v_cvt_pk_bf16_f32 v249, v250, v251
    ds_write_b64 v30, v[248:249] offset:96
    v_cvt_pk_bf16_f32 v252, v252, v253
    v_cvt_pk_bf16_f32 v253, v254, v255
    ds_write_b64 v30, v[252:253] offset:2400
    ds_read_b128 v[128:131], v31 offset:0
    ds_read_b128 v[132:135], v31 offset:1152
    ds_read_b128 v[136:139], v31 offset:2304
    ds_read_b128 v[140:143], v31 offset:3456
    s_waitcnt lgkmcnt(3)
    buffer_store_dwordx4 v[128:131], v15, s[28:31], s66 offen
    s_add_u32 s66, s66, 16384
    s_waitcnt lgkmcnt(2)
    buffer_store_dwordx4 v[132:135], v15, s[28:31], s66 offen
    s_add_u32 s66, s66, 16384
    s_waitcnt lgkmcnt(1)
    buffer_store_dwordx4 v[136:139], v15, s[28:31], s66 offen
    s_add_u32 s66, s66, 16384
    s_waitcnt lgkmcnt(0)
    buffer_store_dwordx4 v[140:143], v15, s[28:31], s66 offen
F_end:
    s_endpgm
F_opoll:
    s_cmp_eq_u32 s60, 0
    s_cbranch_scc1 F_opoll_done
    s_sub_u32 s60, s60, 1
    buffer_load_dword v30, v31, s[48:51], s63 offen offset:0 sc1
    s_waitcnt vmcnt(0)
    v_cmp_gt_u32 vcc, 8, v30
    s_nop 0
    s_cbranch_vccnz F_opoll
    s_branch F_opoll_done
F_opoll2:
    s_cmp_eq_u32 s60, 0
    s_cbranch_scc1 F_opoll2_done
    s_sub_u32 s60, s60, 1
    buffer_load_dword v30, v31, s[48:51], s63 offen offset:1024 sc1
    s_waitcnt vmcnt(0)
    v_cmp_gt_u32 vcc, 8, v30
    s_nop 0
    s_cbranch_vccnz F_opoll2
    s_branch F_opoll2_done
F_fpoll0:
    s_cmp_eq_u32 s60, 0
    s_cbranch_scc1 F_fpoll0_done
    s_sub_u32 s60, s60, 1
    buffer_load_dword v25, v9, s[48:51], s61 offen sc1
    s_waitcnt vmcnt(0)
    v_cmp_gt_u32 vcc, 1, v25
    s_nop 0
    s_cbranch_vccnz F_fpoll0
    s_branch F_fpoll0_done
F_fpoll1:
    s_cmp_eq_u32 s60, 0
    s_cbranch_scc1 F_fpoll1_done
    s_sub_u32 s60, s60, 1
    buffer_load_dword v25, v9, s[48:51], s61 offen sc1
    s_waitcnt vmcnt(0)
    v_cmp_gt_u32 vcc, 1, v25
    s_nop 0
    s_cbranch_vccnz F_fpoll1
    s_branch F_fpoll1_done
F_fpoll2:
    s_cmp_eq_u32 s60, 0
    s_cbranch_scc1 F_fpoll2_done
    s_sub_u32 s60, s60, 1
    buffer_load_dword v25, v9, s[48:51], s61 offen sc1
    s_waitcnt vmcnt(0)
    v_cmp_gt_u32 vcc, 1, v25
    s_nop 0
    s_cbranch_vccnz F_fpoll2
    s_branch F_fpoll2_done
F_ypoll0:
    s_cmp_eq_u32 s60, 0
    s_cbranch_scc1 F_ypoll0_done
    s_sub_u32 s60, s60, 1
    buffer_load_dword v25, v26, s[48:51], s71 offen sc1
    s_waitcnt vmcnt(0)
    v_cmp_gt_u32 vcc, 1, v25
    s_nop 0
    s_cbranch_vccnz F_ypoll0
    s_branch F_ypoll0_done
F_ypoll1:
    s_cmp_eq_u32 s60, 0
    s_cbranch_scc1 F_ypoll1_done
    s_sub_u32 s60, s60, 1
    buffer_load_dword v25, v26, s[48:51], s71 offen sc1
    s_waitcnt vmcnt(0)
    v_cmp_gt_u32 vcc, 1, v25
    s_nop 0
    s_cbranch_vccnz F_ypoll1
    s_branch F_ypoll1_done
F_xpoll:
    s_cmp_eq_u32 s60, 0
    s_cbranch_scc1 F_xpoll_done
    s_sub_u32 s60, s60, 1
    buffer_load_dword v25, v5, s[48:51], s67 offen sc1
    s_waitcnt vmcnt(0)
    v_cmp_gt_u32 vcc, 1, v25
    s_nop 0
    s_cbranch_vccnz F_xpoll
    s_branch F_xpoll_done
F_rsx:
    s_cmp_eq_u32 s59, 2
    s_cbranch_scc1 F_rs5
    v_mfma_f32_16x16x32_bf16 v[48:51], v[36:39], v[40:43], 0
    v_mfma_f32_16x16x32_bf16 v[48:51], v[36:39], v[44:47], v[48:51]
    s_lshl_b32 s56, s61, 3
    s_add_u32 s56, s56, 393216
    s_lshl_b32 s61, s54, 9
    s_add_u32 s61, s61, 393216
    v_lshlrev_b32 v54, 3, v0
    s_mov_b32 s60, 1048576
    s_nop 2
    v_add_f32_dpp v48, v48, v48 row_ror:8 row_mask:0xf bank_mask:0xf
    s_nop 1
    v_add_f32_dpp v48, v48, v48 row_ror:4 row_mask:0xf bank_mask:0xf
    s_nop 1
    v_add_f32_dpp v48, v48, v48 row_ror:2 row_mask:0xf bank_mask:0xf
    s_nop 1
    v_add_f32_dpp v48, v48, v48 row_ror:1 row_mask:0xf bank_mask:0xf
    s_nop 1
    v_mov_b32 v49, 1
    buffer_store_dwordx2 v[48:49], v2, s[48:51], s56 offen sc1
    s_branch F_rsxback
F_rs5:
    buffer_load_dwordx2 v[52:53], v54, s[48:51], s61 offen sc1
    s_lshl_b32 s56, s52, 13
    s_add_u32 m0, s56, 131072
    s_add_u32 s56, s56, 135168
    s_lshl_b32 s57, s54, 7
    v_lshl_add_u32 v48, v0, 2, s56
    v_xor_b32 v49, 32, v250
    v_xor_b32 v50, 64, v250
    v_xor_b32 v51, 0x60, v250
    v_xor_b32 v55, 128, v247
    buffer_load_dwordx4 v12, s[36:39], s57 offen offset:0 lds
    buffer_load_dwordx4 v13, s[36:39], s57 offen offset:1024 lds
    buffer_load_dwordx4 v14, s[36:39], s57 offen offset:2048 lds
    buffer_load_dwordx4 v15, s[36:39], s57 offen offset:3072 lds
    s_branch F_rsxback
F_rspoll:
    s_sub_u32 s60, s60, 1
    s_cbranch_scc1 F_rsgo
    buffer_load_dwordx2 v[52:53], v54, s[48:51], s61 offen sc1
    s_waitcnt vmcnt(0)
    v_cmp_ne_u32 vcc, 1, v53
    s_nop 0
    s_cbranch_vccnz F_rspoll
    s_branch F_rsgo
F_slow:
    s_waitcnt vmcnt(0) lgkmcnt(0)
    s_nop 15
    v_mov_b32 v144, 0xff800000
    v_mov_b32 v160, 0xff800000
    s_mov_b32 s72, 0
    s_mov_b32 s30, 262144
F_max_loop:
    buffer_load_dwordx4 a[0:3], v1, s[28:31], s72 offen offset:0
    buffer_load_dwordx4 a[4:7], v1, s[28:31], s72 offen offset:1024
    s_waitcnt vmcnt(1)
    v_mfma_f32_32x32x16_bf16 v[64:79], a[0:3], v[16:19], 0
    s_waitcnt vmcnt(0)
    v_mfma_f32_32x32x16_bf16 v[64:79], a[4:7], v[20:23], v[64:79]
    v_mfma_f32_32x32x16_bf16 v[80:95], a[0:3], v[24:27], 0
    v_mfma_f32_32x32x16_bf16 v[80:95], a[4:7], v[28:31], v[80:95]
    s_nop 9
    v_max3_f32 v144, v144, v64, v65
    v_max3_f32 v144, v144, v66, v67
    v_max3_f32 v144, v144, v68, v69
    v_max3_f32 v144, v144, v70, v71
    v_max3_f32 v144, v144, v72, v73
    v_max3_f32 v144, v144, v74, v75
    v_max3_f32 v144, v144, v76, v77
    v_max3_f32 v144, v144, v78, v79
    v_max3_f32 v160, v160, v80, v81
    v_max3_f32 v160, v160, v82, v83
    v_max3_f32 v160, v160, v84, v85
    v_max3_f32 v160, v160, v86, v87
    v_max3_f32 v160, v160, v88, v89
    v_max3_f32 v160, v160, v90, v91
    v_max3_f32 v160, v160, v92, v93
    v_max3_f32 v160, v160, v94, v95
    s_add_u32 s72, s72, 4096
    s_cmp_lg_u32 s72, 262144
    s_cbranch_scc1 F_max_loop
    v_mov_b32 v4, v144
    s_nop 1
    v_permlane32_swap_b32 v144, v4
    v_max_f32 v144, v144, v4
    v_sub_f32 v144, 0, v144
    v_mov_b32 v145, v144
    v_mov_b32 v146, v144
    v_mov_b32 v147, v144
    v_mov_b32 v148, v144
    v_mov_b32 v149, v144
    v_mov_b32 v150, v144
    v_mov_b32 v151, v144
    v_mov_b32 v152, v144
    v_mov_b32 v153, v144
    v_mov_b32 v154, v144
    v_mov_b32 v155, v144
    v_mov_b32 v156, v144
    v_mov_b32 v157, v144
    v_mov_b32 v158, v144
    v_mov_b32 v159, v144
    v_mov_b32 v4, v160
    s_nop 1
    v_permlane32_swap_b32 v160, v4
    v_max_f32 v160, v160, v4
    v_sub_f32 v160, 0, v160
    v_mov_b32 v161, v160
    v_mov_b32 v162, v160
    v_mov_b32 v163, v160
    v_mov_b32 v164, v160
    v_mov_b32 v165, v160
    v_mov_b32 v166, v160
    v_mov_b32 v167, v160
    v_mov_b32 v168, v160
    v_mov_b32 v169, v160
    v_mov_b32 v170, v160
    v_mov_b32 v171, v160
    v_mov_b32 v172, v160
    v_mov_b32 v173, v160
    v_mov_b32 v174, v160
    v_mov_b32 v175, v160
    s_mov_b32 s30, 262144
    s_mov_b32 s72, 0
    s_mov_b32 s73, 0
    buffer_load_dwordx4 a[0:3], v1, s[28:31], s72 offen offset:0
    buffer_load_dwordx4 a[4:7], v1, s[28:31], s72 offen offset:1024
    s_add_u32 s72, s72, 4096
    buffer_load_dwordx4 a[64:67], v1, s[28:31], s73 offen offset:2048
    buffer_load_dwordx4 a[68:71], v1, s[28:31], s73 offen offset:3072
    s_add_u32 s73, s73, 4096
    buffer_load_dwordx4 a[8:11], v1, s[28:31], s72 offen offset:0
    buffer_load_dwordx4 a[12:15], v1, s[28:31], s72 offen offset:1024
    s_add_u32 s72, s72, 4096
    buffer_load_dwordx4 a[72:75], v1, s[28:31], s73 offen offset:2048
    buffer_load_dwordx4 a[76:79], v1, s[28:31], s73 offen offset:3072
    s_add_u32 s73, s73, 4096
    buffer_load_dwordx4 a[16:19], v1, s[28:31], s72 offen offset:0
    buffer_load_dwordx4 a[20:23], v1, s[28:31], s72 offen offset:1024
    s_add_u32 s72, s72, 4096
    buffer_load_dwordx4 a[80:83], v1, s[28:31], s73 offen offset:2048
    buffer_load_dwordx4 a[84:87], v1, s[28:31], s73 offen offset:3072
    s_add_u32 s73, s73, 4096
    buffer_load_dwordx4 a[24:27], v1, s[28:31], s72 offen offset:0
    buffer_load_dwordx4 a[28:31], v1, s[28:31], s72 offen offset:1024
    s_add_u32 s72, s72, 4096
    buffer_load_dwordx4 a[88:91], v1, s[28:31], s73 offen offset:2048
    buffer_load_dwordx4 a[92:95], v1, s[28:31], s73 offen offset:3072
    s_add_u32 s73, s73, 4096
    buffer_load_dwordx4 a[32:35], v1, s[28:31], s72 offen offset:0
    buffer_load_dwordx4 a[36:39], v1, s[28:31], s72 offen offset:1024
    s_add_u32 s72, s72, 4096
    buffer_load_dwordx4 a[96:99], v1, s[28:31], s73 offen offset:2048
    buffer_load_dwordx4 a[100:103], v1, s[28:31], s73 offen offset:3072
    s_add_u32 s73, s73, 4096
    buffer_load_dwordx4 a[40:43], v1, s[28:31], s72 offen offset:0
    buffer_load_dwordx4 a[44:47], v1, s[28:31], s72 offen offset:1024
    s_add_u32 s72, s72, 4096
    buffer_load_dwordx4 a[104:107], v1, s[28:31], s73 offen offset:2048
    buffer_load_dwordx4 a[108:111], v1, s[28:31], s73 offen offset:3072
    s_add_u32 s73, s73, 4096
    buffer_load_dwordx4 a[48:51], v1, s[28:31], s72 offen offset:0
    buffer_load_dwordx4 a[52:55], v1, s[28:31], s72 offen offset:1024
    s_add_u32 s72, s72, 4096
    buffer_load_dwordx4 a[56:59], v1, s[28:31], s72 offen offset:0
    buffer_load_dwordx4 a[60:63], v1, s[28:31], s72 offen offset:1024
    s_add_u32 s72, s72, 4096
    v_pk_mov_b32 v[176:177], 0, 0
    v_pk_mov_b32 v[178:179], 0, 0
    v_pk_mov_b32 v[180:181], 0, 0
    v_pk_mov_b32 v[182:183], 0, 0
    v_pk_mov_b32 v[184:185], 0, 0
    v_pk_mov_b32 v[186:187], 0, 0
    v_pk_mov_b32 v[188:189], 0, 0
    v_pk_mov_b32 v[190:191], 0, 0
    v_pk_mov_b32 v[192:193], 0, 0
    v_pk_mov_b32 v[194:195], 0, 0
    v_pk_mov_b32 v[196:197], 0, 0
    v_pk_mov_b32 v[198:199], 0, 0
    v_pk_mov_b32 v[200:201], 0, 0
    v_pk_mov_b32 v[202:203], 0, 0
    v_pk_mov_b32 v[204:205], 0, 0
    v_pk_mov_b32 v[206:207], 0, 0
    v_pk_mov_b32 v[208:209], 0, 0
    v_pk_mov_b32 v[210:211], 0, 0
    v_pk_mov_b32 v[212:213], 0, 0
    v_pk_mov_b32 v[214:215], 0, 0
    v_pk_mov_b32 v[224:225], 0, 0
    v_pk_mov_b32 v[226:227], 0, 0
    v_pk_mov_b32 v[228:229], 0, 0
    v_pk_mov_b32 v[230:231], 0, 0
    v_accvgpr_write_b32 a120, 0
    v_accvgpr_write_b32 a121, 0
    v_accvgpr_write_b32 a122, 0
    v_accvgpr_write_b32 a123, 0
    v_accvgpr_write_b32 a124, 0
    v_accvgpr_write_b32 a125, 0
    v_accvgpr_write_b32 a126, 0
    v_accvgpr_write_b32 a127, 0
    s_mov_b32 s65, 1
    s_waitcnt vmcnt(27)
    v_mfma_f32_32x32x16_bf16 v[64:79], a[0:3], v[16:19], v[144:159]
    s_waitcnt vmcnt(26)
    v_mfma_f32_32x32x16_bf16 v[64:79], a[4:7], v[20:23], v[64:79]
    s_mov_b32 s59, 8
    s_nop 11
.p2align 6
F_safe_loop:
    v_mfma_f32_32x32x16_bf16 v[80:95], a[0:3], v[24:27], v[160:175]
    buffer_load_dwordx4 a[112:115], v1, s[28:31], s73 offen offset:2048
    v_exp_f32 v64, v64
    v_exp_f32 v65, v65
    v_exp_f32 v66, v66
    v_exp_f32 v67, v67
    v_cvt_pk_bf16_f32 v216, v64, v65
    v_mfma_f32_32x32x16_bf16 v[80:95], a[4:7], v[28:31], v[80:95]
    buffer_load_dwordx4 a[116:119], v1, s[28:31], s73 offen offset:3072
    v_exp_f32 v68, v68
    v_exp_f32 v69, v69
    v_cvt_pk_bf16_f32 v217, v66, v67
    v_exp_f32 v70, v70
    v_exp_f32 v71, v71
    v_mfma_f32_32x32x16_bf16 v[192:207], a[120:123], v[224:227], v[192:207]
    v_cvt_pk_bf16_f32 v218, v68, v69
    v_exp_f32 v72, v72
    v_exp_f32 v73, v73
    v_cvt_pk_bf16_f32 v219, v70, v71
    v_exp_f32 v74, v74
    v_mfma_f32_32x32x16_bf16 v[192:207], a[124:127], v[228:231], v[192:207]
    v_exp_f32 v75, v75
    v_cvt_pk_bf16_f32 v220, v72, v73
    v_exp_f32 v76, v76
    v_exp_f32 v77, v77
    v_cvt_pk_bf16_f32 v221, v74, v75
    v_smfmac_f32_16x16x64_bf16 v[212:215], v[232:235], v[224:231], v252
    s_waitcnt vmcnt(24)
    v_exp_f32 v78, v78
    v_exp_f32 v79, v79
    v_cvt_pk_bf16_f32 v222, v76, v77
    v_cvt_pk_bf16_f32 v223, v78, v79
    v_mfma_f32_32x32x16_bf16 v[64:79], a[8:11], v[16:19], v[144:159]
    buffer_load_dwordx4 a[0:3], v253, s[28:31], s73 offen offset:0
    v_exp_f32 v80, v80
    v_exp_f32 v81, v81
    v_exp_f32 v82, v82
    v_exp_f32 v83, v83
    v_cvt_pk_bf16_f32 v224, v80, v81
    v_mfma_f32_32x32x16_bf16 v[64:79], a[12:15], v[20:23], v[64:79]
    buffer_load_dwordx4 a[4:7], v253, s[28:31], s73 offen offset:1024
    v_exp_f32 v84, v84
    v_exp_f32 v85, v85
    v_cvt_pk_bf16_f32 v225, v82, v83
    v_exp_f32 v86, v86
    v_exp_f32 v87, v87
    v_mfma_f32_32x32x16_bf16 v[176:191], a[64:67], v[216:219], v[176:191]
    s_add_u32 s73, s73, 4096
    v_cvt_pk_bf16_f32 v226, v84, v85
    v_exp_f32 v88, v88
    v_exp_f32 v89, v89
    v_cvt_pk_bf16_f32 v227, v86, v87
    v_exp_f32 v90, v90
    v_mfma_f32_32x32x16_bf16 v[176:191], a[68:71], v[220:223], v[176:191]
    v_exp_f32 v91, v91
    v_cvt_pk_bf16_f32 v228, v88, v89
    v_exp_f32 v92, v92
    v_exp_f32 v93, v93
    v_cvt_pk_bf16_f32 v229, v90, v91
    v_smfmac_f32_16x16x64_bf16 v[208:211], v[232:235], v[216:223], v252
    v_exp_f32 v94, v94
    v_exp_f32 v95, v95
    v_cvt_pk_bf16_f32 v230, v92, v93
    v_cvt_pk_bf16_f32 v231, v94, v95
    v_mfma_f32_32x32x16_bf16 v[80:95], a[8:11], v[24:27], v[160:175]
    buffer_load_dwordx4 a[120:123], v1, s[28:31], s73 offen offset:2048
    v_exp_f32 v64, v64
    v_exp_f32 v65, v65
    v_exp_f32 v66, v66
    v_exp_f32 v67, v67
    v_cvt_pk_bf16_f32 v216, v64, v65
    v_mfma_f32_32x32x16_bf16 v[80:95], a[12:15], v[28:31], v[80:95]
    buffer_load_dwordx4 a[124:127], v1, s[28:31], s73 offen offset:3072
    v_exp_f32 v68, v68
    v_exp_f32 v69, v69
    v_cvt_pk_bf16_f32 v217, v66, v67
    v_exp_f32 v70, v70
    v_exp_f32 v71, v71
    v_mfma_f32_32x32x16_bf16 v[192:207], a[64:67], v[224:227], v[192:207]
    v_cvt_pk_bf16_f32 v218, v68, v69
    v_exp_f32 v72, v72
    v_exp_f32 v73, v73
    v_cvt_pk_bf16_f32 v219, v70, v71
    v_exp_f32 v74, v74
    v_mfma_f32_32x32x16_bf16 v[192:207], a[68:71], v[228:231], v[192:207]
    v_exp_f32 v75, v75
    v_cvt_pk_bf16_f32 v220, v72, v73
    v_exp_f32 v76, v76
    v_exp_f32 v77, v77
    v_cvt_pk_bf16_f32 v221, v74, v75
    v_smfmac_f32_16x16x64_bf16 v[212:215], v[232:235], v[224:231], v252
    s_waitcnt vmcnt(24)
    v_exp_f32 v78, v78
    v_exp_f32 v79, v79
    v_cvt_pk_bf16_f32 v222, v76, v77
    v_cvt_pk_bf16_f32 v223, v78, v79
    v_mfma_f32_32x32x16_bf16 v[64:79], a[16:19], v[16:19], v[144:159]
    buffer_load_dwordx4 a[8:11], v253, s[28:31], s73 offen offset:0
    v_exp_f32 v80, v80
    v_exp_f32 v81, v81
    v_exp_f32 v82, v82
    v_exp_f32 v83, v83
    v_cvt_pk_bf16_f32 v224, v80, v81
    v_mfma_f32_32x32x16_bf16 v[64:79], a[20:23], v[20:23], v[64:79]
    buffer_load_dwordx4 a[12:15], v253, s[28:31], s73 offen offset:1024
    v_exp_f32 v84, v84
    v_exp_f32 v85, v85
    v_cvt_pk_bf16_f32 v225, v82, v83
    v_exp_f32 v86, v86
    v_exp_f32 v87, v87
    v_mfma_f32_32x32x16_bf16 v[176:191], a[72:75], v[216:219], v[176:191]
    s_add_u32 s73, s73, 4096
    v_cvt_pk_bf16_f32 v226, v84, v85
    v_exp_f32 v88, v88
    v_exp_f32 v89, v89
    v_cvt_pk_bf16_f32 v227, v86, v87
    v_exp_f32 v90, v90
    v_mfma_f32_32x32x16_bf16 v[176:191], a[76:79], v[220:223], v[176:191]
    v_exp_f32 v91, v91
    v_cvt_pk_bf16_f32 v228, v88, v89
    v_exp_f32 v92, v92
    v_exp_f32 v93, v93
    v_cvt_pk_bf16_f32 v229, v90, v91
    v_smfmac_f32_16x16x64_bf16 v[208:211], v[232:235], v[216:223], v252
    v_exp_f32 v94, v94
    v_exp_f32 v95, v95
    v_cvt_pk_bf16_f32 v230, v92, v93
    v_cvt_pk_bf16_f32 v231, v94, v95
    v_mfma_f32_32x32x16_bf16 v[80:95], a[16:19], v[24:27], v[160:175]
    buffer_load_dwordx4 a[64:67], v1, s[28:31], s73 offen offset:2048
    v_exp_f32 v64, v64
    v_exp_f32 v65, v65
    v_exp_f32 v66, v66
    v_exp_f32 v67, v67
    v_cvt_pk_bf16_f32 v216, v64, v65
    v_mfma_f32_32x32x16_bf16 v[80:95], a[20:23], v[28:31], v[80:95]
    buffer_load_dwordx4 a[68:71], v1, s[28:31], s73 offen offset:3072
    v_exp_f32 v68, v68
    v_exp_f32 v69, v69
    v_cvt_pk_bf16_f32 v217, v66, v67
    v_exp_f32 v70, v70
    v_exp_f32 v71, v71
    v_mfma_f32_32x32x16_bf16 v[192:207], a[72:75], v[224:227], v[192:207]
    v_cvt_pk_bf16_f32 v218, v68, v69
    v_exp_f32 v72, v72
    v_exp_f32 v73, v73
    v_cvt_pk_bf16_f32 v219, v70, v71
    v_exp_f32 v74, v74
    v_mfma_f32_32x32x16_bf16 v[192:207], a[76:79], v[228:231], v[192:207]
    v_exp_f32 v75, v75
    v_cvt_pk_bf16_f32 v220, v72, v73
    v_exp_f32 v76, v76
    v_exp_f32 v77, v77
    v_cvt_pk_bf16_f32 v221, v74, v75
    v_smfmac_f32_16x16x64_bf16 v[212:215], v[232:235], v[224:231], v252
    s_waitcnt vmcnt(24)
    v_exp_f32 v78, v78
    v_exp_f32 v79, v79
    v_cvt_pk_bf16_f32 v222, v76, v77
    v_cvt_pk_bf16_f32 v223, v78, v79
    v_mfma_f32_32x32x16_bf16 v[64:79], a[24:27], v[16:19], v[144:159]
    buffer_load_dwordx4 a[16:19], v253, s[28:31], s73 offen offset:0
    v_exp_f32 v80, v80
    v_exp_f32 v81, v81
    v_exp_f32 v82, v82
    v_exp_f32 v83, v83
    v_cvt_pk_bf16_f32 v224, v80, v81
    v_mfma_f32_32x32x16_bf16 v[64:79], a[28:31], v[20:23], v[64:79]
    buffer_load_dwordx4 a[20:23], v253, s[28:31], s73 offen offset:1024
    v_exp_f32 v84, v84
    v_exp_f32 v85, v85
    v_cvt_pk_bf16_f32 v225, v82, v83
    v_exp_f32 v86, v86
    v_exp_f32 v87, v87
    v_mfma_f32_32x32x16_bf16 v[176:191], a[80:83], v[216:219], v[176:191]
    s_add_u32 s73, s73, 4096
    v_cvt_pk_bf16_f32 v226, v84, v85
    v_exp_f32 v88, v88
    v_exp_f32 v89, v89
    v_cvt_pk_bf16_f32 v227, v86, v87
    v_exp_f32 v90, v90
    v_mfma_f32_32x32x16_bf16 v[176:191], a[84:87], v[220:223], v[176:191]
    v_exp_f32 v91, v91
    v_cvt_pk_bf16_f32 v228, v88, v89
    v_exp_f32 v92, v92
    v_exp_f32 v93, v93
    v_cvt_pk_bf16_f32 v229, v90, v91
    v_smfmac_f32_16x16x64_bf16 v[208:211], v[232:235], v[216:223], v252
    v_exp_f32 v94, v94
    v_exp_f32 v95, v95
    v_cvt_pk_bf16_f32 v230, v92, v93
    v_cvt_pk_bf16_f32 v231, v94, v95
    v_mfma_f32_32x32x16_bf16 v[80:95], a[24:27], v[24:27], v[160:175]
    buffer_load_dwordx4 a[72:75], v1, s[28:31], s73 offen offset:2048
    v_exp_f32 v64, v64
    v_exp_f32 v65, v65
    v_exp_f32 v66, v66
    v_exp_f32 v67, v67
    v_cvt_pk_bf16_f32 v216, v64, v65
    v_mfma_f32_32x32x16_bf16 v[80:95], a[28:31], v[28:31], v[80:95]
    buffer_load_dwordx4 a[76:79], v1, s[28:31], s73 offen offset:3072
    v_exp_f32 v68, v68
    v_exp_f32 v69, v69
    v_cvt_pk_bf16_f32 v217, v66, v67
    v_exp_f32 v70, v70
    v_exp_f32 v71, v71
    v_mfma_f32_32x32x16_bf16 v[192:207], a[80:83], v[224:227], v[192:207]
    v_cvt_pk_bf16_f32 v218, v68, v69
    v_exp_f32 v72, v72
    v_exp_f32 v73, v73
    v_cvt_pk_bf16_f32 v219, v70, v71
    v_exp_f32 v74, v74
    v_mfma_f32_32x32x16_bf16 v[192:207], a[84:87], v[228:231], v[192:207]
    v_exp_f32 v75, v75
    v_cvt_pk_bf16_f32 v220, v72, v73
    v_exp_f32 v76, v76
    v_exp_f32 v77, v77
    v_cvt_pk_bf16_f32 v221, v74, v75
    v_smfmac_f32_16x16x64_bf16 v[212:215], v[232:235], v[224:231], v252
    s_waitcnt vmcnt(24)
    v_exp_f32 v78, v78
    v_exp_f32 v79, v79
    v_cvt_pk_bf16_f32 v222, v76, v77
    v_cvt_pk_bf16_f32 v223, v78, v79
    v_mfma_f32_32x32x16_bf16 v[64:79], a[32:35], v[16:19], v[144:159]
    buffer_load_dwordx4 a[24:27], v253, s[28:31], s73 offen offset:0
    v_exp_f32 v80, v80
    v_exp_f32 v81, v81
    v_exp_f32 v82, v82
    v_exp_f32 v83, v83
    v_cvt_pk_bf16_f32 v224, v80, v81
    v_mfma_f32_32x32x16_bf16 v[64:79], a[36:39], v[20:23], v[64:79]
    buffer_load_dwordx4 a[28:31], v253, s[28:31], s73 offen offset:1024
    v_exp_f32 v84, v84
    v_exp_f32 v85, v85
    v_cvt_pk_bf16_f32 v225, v82, v83
    v_exp_f32 v86, v86
    v_exp_f32 v87, v87
    v_mfma_f32_32x32x16_bf16 v[176:191], a[88:91], v[216:219], v[176:191]
    s_add_u32 s73, s73, 4096
    v_cvt_pk_bf16_f32 v226, v84, v85
    v_exp_f32 v88, v88
    v_exp_f32 v89, v89
    v_cvt_pk_bf16_f32 v227, v86, v87
    v_exp_f32 v90, v90
    v_mfma_f32_32x32x16_bf16 v[176:191], a[92:95], v[220:223], v[176:191]
    v_exp_f32 v91, v91
    v_cvt_pk_bf16_f32 v228, v88, v89
    v_exp_f32 v92, v92
    v_exp_f32 v93, v93
    v_cvt_pk_bf16_f32 v229, v90, v91
    v_smfmac_f32_16x16x64_bf16 v[208:211], v[232:235], v[216:223], v252
    v_exp_f32 v94, v94
    v_exp_f32 v95, v95
    v_cvt_pk_bf16_f32 v230, v92, v93
    v_cvt_pk_bf16_f32 v231, v94, v95
    v_mfma_f32_32x32x16_bf16 v[80:95], a[32:35], v[24:27], v[160:175]
    buffer_load_dwordx4 a[80:83], v1, s[28:31], s73 offen offset:2048
    v_exp_f32 v64, v64
    v_exp_f32 v65, v65
    v_exp_f32 v66, v66
    v_exp_f32 v67, v67
    v_cvt_pk_bf16_f32 v216, v64, v65
    v_mfma_f32_32x32x16_bf16 v[80:95], a[36:39], v[28:31], v[80:95]
    buffer_load_dwordx4 a[84:87], v1, s[28:31], s73 offen offset:3072
    v_exp_f32 v68, v68
    v_exp_f32 v69, v69
    v_cvt_pk_bf16_f32 v217, v66, v67
    v_exp_f32 v70, v70
    v_exp_f32 v71, v71
    v_mfma_f32_32x32x16_bf16 v[192:207], a[88:91], v[224:227], v[192:207]
    v_cvt_pk_bf16_f32 v218, v68, v69
    v_exp_f32 v72, v72
    v_exp_f32 v73, v73
    v_cvt_pk_bf16_f32 v219, v70, v71
    v_exp_f32 v74, v74
    v_mfma_f32_32x32x16_bf16 v[192:207], a[92:95], v[228:231], v[192:207]
    v_exp_f32 v75, v75
    v_cvt_pk_bf16_f32 v220, v72, v73
    v_exp_f32 v76, v76
    v_exp_f32 v77, v77
    v_cvt_pk_bf16_f32 v221, v74, v75
    v_smfmac_f32_16x16x64_bf16 v[212:215], v[232:235], v[224:231], v252
    s_waitcnt vmcnt(24)
    v_exp_f32 v78, v78
    v_exp_f32 v79, v79
    v_cvt_pk_bf16_f32 v222, v76, v77
    v_cvt_pk_bf16_f32 v223, v78, v79
    v_mfma_f32_32x32x16_bf16 v[64:79], a[40:43], v[16:19], v[144:159]
    buffer_load_dwordx4 a[32:35], v253, s[28:31], s73 offen offset:0
    v_exp_f32 v80, v80
    v_exp_f32 v81, v81
    v_exp_f32 v82, v82
    v_exp_f32 v83, v83
    v_cvt_pk_bf16_f32 v224, v80, v81
    v_mfma_f32_32x32x16_bf16 v[64:79], a[44:47], v[20:23], v[64:79]
    buffer_load_dwordx4 a[36:39], v253, s[28:31], s73 offen offset:1024
    v_exp_f32 v84, v84
    v_exp_f32 v85, v85
    v_cvt_pk_bf16_f32 v225, v82, v83
    v_exp_f32 v86, v86
    v_exp_f32 v87, v87
    v_mfma_f32_32x32x16_bf16 v[176:191], a[96:99], v[216:219], v[176:191]
    s_add_u32 s73, s73, 4096
    v_cvt_pk_bf16_f32 v226, v84, v85
    v_exp_f32 v88, v88
    v_exp_f32 v89, v89
    v_cvt_pk_bf16_f32 v227, v86, v87
    v_exp_f32 v90, v90
    v_mfma_f32_32x32x16_bf16 v[176:191], a[100:103], v[220:223], v[176:191]
    v_exp_f32 v91, v91
    v_cvt_pk_bf16_f32 v228, v88, v89
    v_exp_f32 v92, v92
    v_exp_f32 v93, v93
    v_cvt_pk_bf16_f32 v229, v90, v91
    v_smfmac_f32_16x16x64_bf16 v[208:211], v[232:235], v[216:223], v252
    v_exp_f32 v94, v94
    v_exp_f32 v95, v95
    v_cvt_pk_bf16_f32 v230, v92, v93
    v_cvt_pk_bf16_f32 v231, v94, v95
    v_mfma_f32_32x32x16_bf16 v[80:95], a[40:43], v[24:27], v[160:175]
    buffer_load_dwordx4 a[88:91], v1, s[28:31], s73 offen offset:2048
    v_exp_f32 v64, v64
    v_exp_f32 v65, v65
    v_exp_f32 v66, v66
    v_exp_f32 v67, v67
    v_cvt_pk_bf16_f32 v216, v64, v65
    v_mfma_f32_32x32x16_bf16 v[80:95], a[44:47], v[28:31], v[80:95]
    buffer_load_dwordx4 a[92:95], v1, s[28:31], s73 offen offset:3072
    v_exp_f32 v68, v68
    v_exp_f32 v69, v69
    v_cvt_pk_bf16_f32 v217, v66, v67
    v_exp_f32 v70, v70
    v_exp_f32 v71, v71
    v_mfma_f32_32x32x16_bf16 v[192:207], a[96:99], v[224:227], v[192:207]
    v_cvt_pk_bf16_f32 v218, v68, v69
    v_exp_f32 v72, v72
    v_exp_f32 v73, v73
    v_cvt_pk_bf16_f32 v219, v70, v71
    v_exp_f32 v74, v74
    v_mfma_f32_32x32x16_bf16 v[192:207], a[100:103], v[228:231], v[192:207]
    v_exp_f32 v75, v75
    v_cvt_pk_bf16_f32 v220, v72, v73
    v_exp_f32 v76, v76
    v_exp_f32 v77, v77
    v_cvt_pk_bf16_f32 v221, v74, v75
    v_smfmac_f32_16x16x64_bf16 v[212:215], v[232:235], v[224:231], v252
    s_waitcnt vmcnt(24)
    v_exp_f32 v78, v78
    v_exp_f32 v79, v79
    v_cvt_pk_bf16_f32 v222, v76, v77
    v_cvt_pk_bf16_f32 v223, v78, v79
    v_mfma_f32_32x32x16_bf16 v[64:79], a[48:51], v[16:19], v[144:159]
    buffer_load_dwordx4 a[40:43], v253, s[28:31], s73 offen offset:0
    v_exp_f32 v80, v80
    v_exp_f32 v81, v81
    v_exp_f32 v82, v82
    v_exp_f32 v83, v83
    v_cvt_pk_bf16_f32 v224, v80, v81
    v_mfma_f32_32x32x16_bf16 v[64:79], a[52:55], v[20:23], v[64:79]
    buffer_load_dwordx4 a[44:47], v253, s[28:31], s73 offen offset:1024
    v_exp_f32 v84, v84
    v_exp_f32 v85, v85
    v_cvt_pk_bf16_f32 v225, v82, v83
    v_exp_f32 v86, v86
    v_exp_f32 v87, v87
    v_mfma_f32_32x32x16_bf16 v[176:191], a[104:107], v[216:219], v[176:191]
    s_add_u32 s73, s73, 4096
    v_cvt_pk_bf16_f32 v226, v84, v85
    v_exp_f32 v88, v88
    v_exp_f32 v89, v89
    v_cvt_pk_bf16_f32 v227, v86, v87
    v_exp_f32 v90, v90
    v_mfma_f32_32x32x16_bf16 v[176:191], a[108:111], v[220:223], v[176:191]
    v_exp_f32 v91, v91
    v_cvt_pk_bf16_f32 v228, v88, v89
    v_exp_f32 v92, v92
    v_exp_f32 v93, v93
    v_cvt_pk_bf16_f32 v229, v90, v91
    v_smfmac_f32_16x16x64_bf16 v[208:211], v[232:235], v[216:223], v252
    v_exp_f32 v94, v94
    v_exp_f32 v95, v95
    v_cvt_pk_bf16_f32 v230, v92, v93
    v_cvt_pk_bf16_f32 v231, v94, v95
    v_mfma_f32_32x32x16_bf16 v[80:95], a[48:51], v[24:27], v[160:175]
    buffer_load_dwordx4 a[96:99], v1, s[28:31], s73 offen offset:2048
    v_exp_f32 v64, v64
    v_exp_f32 v65, v65
    v_exp_f32 v66, v66
    v_exp_f32 v67, v67
    v_cvt_pk_bf16_f32 v216, v64, v65
    v_mfma_f32_32x32x16_bf16 v[80:95], a[52:55], v[28:31], v[80:95]
    buffer_load_dwordx4 a[100:103], v1, s[28:31], s73 offen offset:3072
    v_exp_f32 v68, v68
    v_exp_f32 v69, v69
    v_cvt_pk_bf16_f32 v217, v66, v67
    v_exp_f32 v70, v70
    v_exp_f32 v71, v71
    v_mfma_f32_32x32x16_bf16 v[192:207], a[104:107], v[224:227], v[192:207]
    v_cvt_pk_bf16_f32 v218, v68, v69
    v_exp_f32 v72, v72
    v_exp_f32 v73, v73
    v_cvt_pk_bf16_f32 v219, v70, v71
    v_exp_f32 v74, v74
    v_mfma_f32_32x32x16_bf16 v[192:207], a[108:111], v[228:231], v[192:207]
    v_exp_f32 v75, v75
    v_cvt_pk_bf16_f32 v220, v72, v73
    v_exp_f32 v76, v76
    v_exp_f32 v77, v77
    v_cvt_pk_bf16_f32 v221, v74, v75
    v_smfmac_f32_16x16x64_bf16 v[212:215], v[232:235], v[224:231], v252
    s_waitcnt vmcnt(24)
    v_exp_f32 v78, v78
    v_exp_f32 v79, v79
    v_cvt_pk_bf16_f32 v222, v76, v77
    v_cvt_pk_bf16_f32 v223, v78, v79
    v_mfma_f32_32x32x16_bf16 v[64:79], a[56:59], v[16:19], v[144:159]
    buffer_load_dwordx4 a[48:51], v253, s[28:31], s73 offen offset:0
    v_exp_f32 v80, v80
    v_exp_f32 v81, v81
    v_exp_f32 v82, v82
    v_exp_f32 v83, v83
    v_cvt_pk_bf16_f32 v224, v80, v81
    v_mfma_f32_32x32x16_bf16 v[64:79], a[60:63], v[20:23], v[64:79]
    buffer_load_dwordx4 a[52:55], v253, s[28:31], s73 offen offset:1024
    v_exp_f32 v84, v84
    v_exp_f32 v85, v85
    v_cvt_pk_bf16_f32 v225, v82, v83
    v_exp_f32 v86, v86
    v_exp_f32 v87, v87
    v_mfma_f32_32x32x16_bf16 v[176:191], a[112:115], v[216:219], v[176:191]
    s_add_u32 s73, s73, 4096
    v_cvt_pk_bf16_f32 v226, v84, v85
    v_exp_f32 v88, v88
    v_exp_f32 v89, v89
    v_cvt_pk_bf16_f32 v227, v86, v87
    v_exp_f32 v90, v90
    v_mfma_f32_32x32x16_bf16 v[176:191], a[116:119], v[220:223], v[176:191]
    v_exp_f32 v91, v91
    v_cvt_pk_bf16_f32 v228, v88, v89
    v_exp_f32 v92, v92
    v_exp_f32 v93, v93
    v_cvt_pk_bf16_f32 v229, v90, v91
    v_smfmac_f32_16x16x64_bf16 v[208:211], v[232:235], v[216:223], v252
    v_exp_f32 v94, v94
    v_exp_f32 v95, v95
    v_cvt_pk_bf16_f32 v230, v92, v93
    v_cvt_pk_bf16_f32 v231, v94, v95
    v_mfma_f32_32x32x16_bf16 v[80:95], a[56:59], v[24:27], v[160:175]
    buffer_load_dwordx4 a[104:107], v1, s[28:31], s73 offen offset:2048
    v_exp_f32 v64, v64
    v_exp_f32 v65, v65
    v_exp_f32 v66, v66
    v_exp_f32 v67, v67
    v_cvt_pk_bf16_f32 v216, v64, v65
    v_mfma_f32_32x32x16_bf16 v[80:95], a[60:63], v[28:31], v[80:95]
    buffer_load_dwordx4 a[108:111], v1, s[28:31], s73 offen offset:3072
    v_exp_f32 v68, v68
    v_exp_f32 v69, v69
    v_cvt_pk_bf16_f32 v217, v66, v67
    v_exp_f32 v70, v70
    v_exp_f32 v71, v71
    v_mfma_f32_32x32x16_bf16 v[192:207], a[112:115], v[224:227], v[192:207]
    v_cvt_pk_bf16_f32 v218, v68, v69
    v_exp_f32 v72, v72
    v_exp_f32 v73, v73
    v_cvt_pk_bf16_f32 v219, v70, v71
    v_exp_f32 v74, v74
    v_mfma_f32_32x32x16_bf16 v[192:207], a[116:119], v[228:231], v[192:207]
    v_exp_f32 v75, v75
    v_cvt_pk_bf16_f32 v220, v72, v73
    v_exp_f32 v76, v76
    v_exp_f32 v77, v77
    v_cvt_pk_bf16_f32 v221, v74, v75
    v_smfmac_f32_16x16x64_bf16 v[212:215], v[232:235], v[224:231], v252
    s_waitcnt vmcnt(24)
    v_exp_f32 v78, v78
    v_exp_f32 v79, v79
    v_cvt_pk_bf16_f32 v222, v76, v77
    v_cvt_pk_bf16_f32 v223, v78, v79
    v_mfma_f32_32x32x16_bf16 v[64:79], a[0:3], v[16:19], v[144:159]
    buffer_load_dwordx4 a[56:59], v253, s[28:31], s73 offen offset:0
    v_exp_f32 v80, v80
    v_exp_f32 v81, v81
    v_exp_f32 v82, v82
    v_exp_f32 v83, v83
    v_cvt_pk_bf16_f32 v224, v80, v81
    v_mfma_f32_32x32x16_bf16 v[64:79], a[4:7], v[20:23], v[64:79]
    buffer_load_dwordx4 a[60:63], v253, s[28:31], s73 offen offset:1024
    v_exp_f32 v84, v84
    v_exp_f32 v85, v85
    v_cvt_pk_bf16_f32 v225, v82, v83
    v_exp_f32 v86, v86
    v_exp_f32 v87, v87
    v_mfma_f32_32x32x16_bf16 v[176:191], a[120:123], v[216:219], v[176:191]
    s_add_u32 s73, s73, 4096
    v_cvt_pk_bf16_f32 v226, v84, v85
    v_exp_f32 v88, v88
    v_exp_f32 v89, v89
    v_cvt_pk_bf16_f32 v227, v86, v87
    v_exp_f32 v90, v90
    v_mfma_f32_32x32x16_bf16 v[176:191], a[124:127], v[220:223], v[176:191]
    s_sub_u32 s59, s59, 1
    v_exp_f32 v91, v91
    v_cvt_pk_bf16_f32 v228, v88, v89
    v_exp_f32 v92, v92
    v_exp_f32 v93, v93
    v_cvt_pk_bf16_f32 v229, v90, v91
    v_smfmac_f32_16x16x64_bf16 v[208:211], v[232:235], v[216:223], v252
    s_cmp_lg_u32 s59, 0
    v_exp_f32 v94, v94
    v_exp_f32 v95, v95
    v_cvt_pk_bf16_f32 v230, v92, v93
    v_cvt_pk_bf16_f32 v231, v94, v95
    s_cbranch_scc1 F_safe_loop
    v_mfma_f32_32x32x16_bf16 v[192:207], a[120:123], v[224:227], v[192:207]
    v_mfma_f32_32x32x16_bf16 v[192:207], a[124:127], v[228:231], v[192:207]
    v_smfmac_f32_16x16x64_bf16 v[212:215], v[232:235], v[224:231], v252
    s_waitcnt vmcnt(0) lgkmcnt(0)
    s_nop 15
    s_branch F_fin
.section .rodata,"a"
.p2align 6
.amdhsa_kernel sequential_preLN__grouped_kv_mqa__glu_gated_glu__prompt_kernel
  .amdhsa_next_free_vgpr 512
  .amdhsa_next_free_sgpr 76
  .amdhsa_accum_offset 256
  .amdhsa_group_segment_fixed_size 0
  .amdhsa_kernarg_size 96
  .amdhsa_user_sgpr_count 2
  .amdhsa_user_sgpr_kernarg_segment_ptr 1
  .amdhsa_system_sgpr_workgroup_id_x 1
  .amdhsa_float_denorm_mode_32 3
.end_amdhsa_kernel
```
